```python
import torch

def _softmax(x, axis=-1):
    return torch.softmax(x, dim=axis)
def _gelu(x):
    return torch.nn.functional.gelu(x, approximate="tanh")
def _silu(x):
    return torch.nn.functional.silu(x)
def _sigmoid(x):
    return torch.sigmoid(x)
def _layernorm(x, axis=-1, eps=1e-5):
    m = x.mean(dim=axis, keepdim=True)
    v = x.var(dim=axis, keepdim=True, unbiased=False)
    return (x - m) / torch.sqrt(v + eps)
def _scatter_add(tgt, idx, src, axis=0):
    return tgt.clone().index_add_(axis, idx, src)
def _segment_sum(src, seg, n):
    out = torch.zeros((n,) + src.shape[1:], dtype=src.dtype)
    return out.index_add_(0, seg, src)
def _pad(x, pw):
    flat = tuple(v for pair in reversed(pw) for v in pair)
    return torch.nn.functional.pad(x, flat)

kernel_name = 'sequential_preLN__grouped_kv_mqa__moe_arch_mod__prompt'

def setup_inputs():

    _w = (lambda a: (lambda t: t.to(torch.bfloat16) if t.is_floating_point() else t)(torch.as_tensor(a)))
    def _A_setup():
        B, S, D, H = 1, 2048, 576, 32
        Dh = D // H
        return {
            "x": _w((lambda *s: torch.randn(*s, dtype=torch.bfloat16) * 0.05)(B, S, D)),
            "wq": _w((lambda *s: torch.randn(*s, dtype=torch.bfloat16) * 0.05)(D, H * Dh)),
            "wk": _w((lambda *s: torch.randn(*s, dtype=torch.bfloat16) * 0.05)(D, Dh)),
            "wv": _w((lambda *s: torch.randn(*s, dtype=torch.bfloat16) * 0.05)(D, Dh)),
            "wo": _w((lambda *s: torch.randn(*s, dtype=torch.bfloat16) * 0.05)(H * Dh, D)),
        }
    _A_in = _A_setup()

    def _B_setup():
        B, S, D, F, C = 1, 2048, 576, 4608, 8
        return {
            "x": _w((lambda *s: torch.randn(*s, dtype=torch.bfloat16) * 0.05)(B, S, D)),
            "w_r": _w((lambda *s: torch.randn(*s, dtype=torch.bfloat16) * 0.05)(D)),
            "w_gate": _w((lambda *s: torch.randn(*s, dtype=torch.bfloat16) * 0.05)(D, F)),
            "w_up": _w((lambda *s: torch.randn(*s, dtype=torch.bfloat16) * 0.05)(D, F)),
            "w_down": _w((lambda *s: torch.randn(*s, dtype=torch.bfloat16) * 0.05)(F, D)),
        }
    _B_in = _B_setup()

    return {
        "A_x": _A_in["x"],
        "A_wq": _A_in["wq"],
        "A_wk": _A_in["wk"],
        "A_wv": _A_in["wv"],
        "A_wo": _A_in["wo"],
        "B_x": _B_in["x"],
        "B_w_r": _B_in["w_r"],
        "B_w_gate": _B_in["w_gate"],
        "B_w_up": _B_in["w_up"],
        "B_w_down": _B_in["w_down"],
    }

def reference(A_x, A_wq, A_wk, A_wv, A_wo, B_x, B_w_r, B_w_gate, B_w_up, B_w_down):
    def _A_ref(x, wq, wk, wv, wo):
        B, S, D = x.shape
        H = 32
        Dh = D // H
        q = (lambda x, *d: x.permute(*d))((x @ wq).reshape(B, S, H, Dh), 0, 2, 1, 3)
        k = x @ wk
        v = x @ wv
        scores = torch.einsum("bhqd,bkd->bhqk", q, k) * (Dh ** -0.5)
        p = _softmax(scores, axis=-1)
        o = torch.einsum("bhqk,bkd->bhqd", p, v)
        return (lambda x, *d: x.permute(*d))(o, 0, 2, 1, 3).reshape(B, S, H * Dh) @ wo

    def _B_ref(x, w_r, w_gate, w_up, w_down):
        B, S, D = x.shape
        C = 8
        r = x @ w_r
        idx = torch.argsort(-r, axis=-1)[:, :C]
        idx_e = (lambda x, n, axis: torch.repeat_interleave(x, n, dim=axis))(idx.reshape(B, C, 1), D, axis=2)
        x_sel = (lambda x, i, axis: torch.take_along_dim(x, i, dim=axis))(x, idx_e, axis=1)
        g = _silu(x_sel @ w_gate)
        u = x_sel @ w_up
        y = (g * u) @ w_down
        r_sel = _sigmoid((lambda x, i, axis: torch.take_along_dim(x, i, dim=axis))(r, idx, axis=1))
        y = y * r_sel.reshape(B, C, 1)
        b_off = (torch.arange(B) * S).reshape(B, 1)
        flat_idx = (idx + b_off).reshape(B * C)
        zero = (x * 0.0).reshape(B * S, D)
        upd = _scatter_add(zero, flat_idx, y.reshape(B * C, D), axis=0)
        return x + upd.reshape(B, S, D)

    x = A_x
    h = x + _A_ref(_layernorm(x, axis=-1), A_wq, A_wk, A_wv, A_wo)
    h2 = h + _B_ref(_layernorm(h, axis=-1), B_w_r, B_w_gate, B_w_up, B_w_down)
    return h2
```

```asm
; @launch grid=(256,1,1) block=(256,1,1) lds=160896
.amdgcn_target "amdgcn-amd-amdhsa--gfx950"
.text
.p2align 12
.globl sequential_preLN__grouped_kv_mqa__moe_arch_mod__prompt_kernel
.p2align 8
.type sequential_preLN__grouped_kv_mqa__moe_arch_mod__prompt_kernel,@function
sequential_preLN__grouped_kv_mqa__moe_arch_mod__prompt_kernel:
    s_cmp_ge_u32 s2, 256
    s_cbranch_scc1 L_k2_end
    s_load_dwordx8 s[4:11], s[0:1], 0
    s_load_dwordx2 s[16:17], s[0:1], 96
    s_load_dwordx2 s[24:25], s[0:1], 88
    s_load_dwordx2 s[68:69], s[0:1], 32
    s_getpc_b64 s[40:41]
L_pc0:
    s_bfe_u32 s42, s2, 0x30003
    s_lshl_b32 s42, s42, 7
    v_lshl_add_u32 v18, v0, 10, s42
    v_cmp_gt_u32 vcc, L_k2_end-L_pc0, v18
    s_and_saveexec_b64 s[42:43], vcc
    s_cbranch_execz L_nopf0
    global_load_dword v128, v18, s[40:41]
L_nopf0:
    s_mov_b64 exec, -1
    v_lshrrev_b32 v1, 6, v0
    v_and_b32 v0, 63, v0
    v_readfirstlane_b32 s32, v1
    v_and_b32 v16, 15, v0
    v_lshrrev_b32 v17, 4, v0
    s_mov_b32 s18, 16777216
    s_mov_b32 s19, 0x20000
    s_mov_b32 s22, 2359296
    s_mov_b32 s23, 0x20000
    s_mov_b32 s26, 256
    s_mov_b32 s27, 0x20000
    s_mov_b32 s31, 0x20000
    s_mov_b32 s71, 0x20000
    s_and_b32 s33, s2, 7
    s_lshr_b32 s34, s2, 3
    s_cmp_ge_u32 s34, 24
    s_cbranch_scc1 L_pa_kv
    s_mul_i32 s35, s34, 43
    s_lshr_b32 s35, s35, 8
    s_mul_i32 s36, s35, 6
    s_sub_u32 s36, s34, s36
    v_lshrrev_b32 v22, 3, v0
    v_mul_u32_u24 v22, 1152, v22
    v_and_b32 v23, 7, v0
    v_xor_b32 v19, v23, v17
    v_lshl_add_u32 v120, v19, 4, v22
    v_xor_b32 v121, 64, v120
    v_add_u32 v121, 8192, v121
    v_lshrrev_b32 v18, 2, v0
    v_mul_u32_u24 v18, 1152, v18
    v_and_b32 v19, 3, v0
    v_and_b32 v20, 2, v17
    v_xor_b32 v19, v19, v20
    v_lshl_add_u32 v122, v19, 4, v18
    s_lshl_b32 s39, s33, 2
    s_add_u32 s39, s39, s35
    s_lshl_b32 s15, s39, 2
    s_add_u32 s15, s15, s32
    s_mul_i32 s37, s15, 18432
    s_mul_i32 s73, s32, 18432
    s_lshl_b32 s38, s36, 6
    s_add_u32 s38, s38, s73
    s_lshl_b32 s40, s35, 2
    s_lshr_b32 s42, 1584, s40
    s_lshl_b32 s40, s36, 2
    s_lshr_b32 s41, 6489648, s40
    s_and_b32 s42, s42, 15
    s_and_b32 s41, s41, 15
    s_add_u32 s42, s42, s41
    s_sub_u32 s40, s42, 9
    s_cmp_ge_u32 s42, 9
    s_cselect_b32 s42, s40, s42
    s_lshl_b32 s12, s32, 11
    s_add_u32 s12, s12, 36864
    s_lshl_b32 s13, s32, 10
    s_lshl_b32 s50, s42, 7
    s_mul_i32 s51, s42, 73728
    s_add_u32 s50, s50, s37
    s_add_u32 s51, s51, s38
    s_add_u32 s42, s42, 1
    s_cmp_eq_u32 s42, 9
    s_cselect_b32 s42, 0, s42
    s_lshl_b32 s52, s42, 7
    s_mul_i32 s53, s42, 73728
    s_add_u32 s52, s52, s37
    s_add_u32 s53, s53, s38
    s_add_u32 s42, s42, 1
    s_cmp_eq_u32 s42, 9
    s_cselect_b32 s42, 0, s42
    s_lshl_b32 s54, s42, 7
    s_mul_i32 s55, s42, 73728
    s_add_u32 s54, s54, s37
    s_add_u32 s55, s55, s38
    s_add_u32 s42, s42, 1
    s_cmp_eq_u32 s42, 9
    s_cselect_b32 s42, 0, s42
    s_mov_b32 s30, 663552
    s_waitcnt lgkmcnt(0)
    s_mov_b32 s20, s4
    s_mov_b32 s21, s5
    s_mov_b32 s28, s6
    s_mov_b32 s29, s7
    s_add_u32 m0, s12, 0
    s_nop 0
    buffer_load_dwordx4 v120, s[20:23], s50 offen lds
    buffer_load_dwordx4 v121, s[20:23], s50 offen offset:1024 lds
    s_add_u32 m0, s13, 0
    s_nop 0
    buffer_load_dwordx4 v122, s[28:31], s51 offen lds
    s_add_u32 m0, s12, 8192
    s_nop 0
    buffer_load_dwordx4 v120, s[20:23], s52 offen lds
    buffer_load_dwordx4 v121, s[20:23], s52 offen offset:1024 lds
    s_add_u32 m0, s13, 4096
    s_nop 0
    buffer_load_dwordx4 v122, s[28:31], s53 offen lds
    s_add_u32 m0, s12, 16384
    s_nop 0
    buffer_load_dwordx4 v120, s[20:23], s54 offen lds
    buffer_load_dwordx4 v121, s[20:23], s54 offen offset:1024 lds
    s_add_u32 m0, s13, 8192
    s_nop 0
    buffer_load_dwordx4 v122, s[28:31], s55 offen lds
    s_branch L_pa_q2
L_pa_kv:
    s_sub_u32 s34, s34, 24
    s_lshl_b32 s39, s33, 3
    s_add_u32 s39, s39, s34
    s_and_b32 s35, s32, 1
    s_lshr_b32 s36, s32, 1
    v_lshrrev_b32 v22, 3, v0
    v_mul_u32_u24 v18, 1152, v22
    v_and_b32 v23, 7, v0
    s_lshl_b32 s37, s35, 2
    v_add_u32 v20, s37, v17
    v_xor_b32 v19, v23, v20
    v_lshl_add_u32 v120, v19, 4, v18
    v_lshrrev_b32 v18, 2, v0
    v_mul_u32_u24 v18, 36, v18
    v_and_b32 v19, 3, v0
    v_and_b32 v20, 2, v17
    v_xor_b32 v19, v19, v20
    v_lshl_add_u32 v18, v19, 4, v18
    v_add_u32 v121, 1024, v18
    v_add_u32 v122, 576, v18
    s_lshl_b32 s38, s39, 2
    s_add_u32 s38, s38, s32
    s_mul_i32 s37, s38, 9216
    s_lshl_b32 s12, s32, 10
    s_mul_i32 s13, s35, 36864
    s_lshl_b32 s40, s36, 11
    s_add_u32 s13, s13, s40
    s_add_u32 s13, s13, 36864
    s_mul_i32 s43, s36, 1152
    s_mov_b32 s42, s34
    s_lshl_b32 s44, s42, 7
    s_mul_i32 s45, s42, 2304
    s_add_u32 s44, s44, s37
    s_add_u32 s45, s45, s43
    s_add_u32 s42, s42, 1
    s_cmp_eq_u32 s42, 9
    s_cselect_b32 s42, 0, s42
    s_lshl_b32 s46, s42, 7
    s_mul_i32 s47, s42, 2304
    s_add_u32 s46, s46, s37
    s_add_u32 s47, s47, s43
    s_add_u32 s42, s42, 1
    s_cmp_eq_u32 s42, 9
    s_cselect_b32 s42, 0, s42
    s_lshl_b32 s48, s42, 7
    s_mul_i32 s49, s42, 2304
    s_add_u32 s48, s48, s37
    s_add_u32 s49, s49, s43
    s_add_u32 s42, s42, 1
    s_cmp_eq_u32 s42, 9
    s_cselect_b32 s42, 0, s42
    s_mov_b32 s30, 21760
    s_cmp_eq_u32 s35, 0
    s_waitcnt lgkmcnt(0)
    s_cselect_b32 s28, s8, s10
    s_cselect_b32 s29, s9, s11
    s_mov_b32 s20, s4
    s_mov_b32 s21, s5
    s_sub_u32 s28, s28, 1024
    s_subb_u32 s29, s29, 0
    s_cmp_ge_u32 s2, 194
    s_cbranch_scc1 L_pa_noclr
    s_lshl_b32 s64, s33, 2
    s_add_u32 s64, s64, s32
    s_lshl_b32 s65, s64, 11
    s_add_u32 s65, s65, 8962048
    s_lshl_b32 s66, s64, 9
    s_add_u32 s66, s66, 8978432
    v_mov_b32 v26, 0
    v_mov_b32 v27, 0
    v_mov_b32 v28, 0
    v_mov_b32 v29, 0
    v_lshlrev_b32 v24, 4, v0
    v_lshlrev_b32 v25, 3, v0
    buffer_store_dwordx4 v[26:29], v24, s[16:19], s65 offen sc1
    buffer_store_dwordx4 v[26:29], v24, s[16:19], s65 offen offset:1024 sc1
    buffer_store_dwordx2 v[26:27], v25, s[16:19], s66 offen sc1
    s_lshl_b32 s66, s64, 10
    s_add_u32 s66, s66, 8982528
    buffer_store_dwordx4 v[26:29], v24, s[16:19], s66 offen sc1
    s_add_u32 s66, s66, 8192
    buffer_store_dwordx4 v[26:29], v24, s[16:19], s66 offen sc1
L_pa_noclr:
    s_add_u32 m0, s12, 0
    s_nop 0
    buffer_load_dwordx4 v120, s[20:23], s44 offen lds
    s_add_u32 m0, s13, 0
    s_nop 0
    buffer_load_dwordx4 v121, s[28:31], s45 offen offset:0 lds
    buffer_load_dwordx4 v122, s[28:31], s45 offen offset:1024 lds
    s_add_u32 m0, s12, 4096
    s_nop 0
    buffer_load_dwordx4 v120, s[20:23], s46 offen lds
    s_add_u32 m0, s13, 4096
    s_nop 0
    buffer_load_dwordx4 v121, s[28:31], s47 offen offset:0 lds
    buffer_load_dwordx4 v122, s[28:31], s47 offen offset:1024 lds
    s_add_u32 m0, s12, 8192
    s_nop 0
    buffer_load_dwordx4 v120, s[20:23], s48 offen lds
    s_add_u32 m0, s13, 8192
    s_nop 0
    buffer_load_dwordx4 v121, s[28:31], s49 offen offset:0 lds
    buffer_load_dwordx4 v122, s[28:31], s49 offen offset:1024 lds
    s_branch L_pa_kv2
L_pa_q2:
    s_load_dwordx2 s[8:9], s[0:1], 48
    v_and_b32 v19, 1, v17
    v_lshrrev_b32 v20, 1, v17
    v_lshrrev_b32 v18, 3, v16
    v_mul_u32_u24 v18, 9216, v18
    v_lshl_add_u32 v18, v20, 7, v18
    v_and_b32 v21, 7, v16
    v_lshl_add_u32 v18, v21, 4, v18
    s_lshl_b32 s40, s36, 9
    s_add_u32 s40, s40, s37
    v_lshl_add_u32 v165, v19, 8, v18
    v_add_u32 v165, s40, v165
    v_mov_b32 v228, -1
    v_mov_b32 v229, -1
    v_mov_b32 v230, -1
    v_mov_b32 v231, -1
    buffer_store_dwordx4 v[228:231], v165, s[16:19], 0 offen sc1
    s_lshl_b32 s56, s42, 7
    s_mul_i32 s57, s42, 73728
    s_add_u32 s56, s56, s37
    s_add_u32 s57, s57, s38
    s_add_u32 s42, s42, 1
    s_cmp_eq_u32 s42, 9
    s_cselect_b32 s42, 0, s42
    s_lshl_b32 s58, s42, 7
    s_mul_i32 s59, s42, 73728
    s_add_u32 s58, s58, s37
    s_add_u32 s59, s59, s38
    s_add_u32 s42, s42, 1
    s_cmp_eq_u32 s42, 9
    s_cselect_b32 s42, 0, s42
    s_lshl_b32 s60, s42, 7
    s_mul_i32 s61, s42, 73728
    s_add_u32 s60, s60, s37
    s_add_u32 s61, s61, s38
    s_add_u32 s42, s42, 1
    s_cmp_eq_u32 s42, 9
    s_cselect_b32 s42, 0, s42
    s_lshl_b32 s62, s42, 7
    s_mul_i32 s63, s42, 73728
    s_add_u32 s62, s62, s37
    s_add_u32 s63, s63, s38
    s_add_u32 s42, s42, 1
    s_cmp_eq_u32 s42, 9
    s_cselect_b32 s42, 0, s42
    s_lshl_b32 s64, s42, 7
    s_mul_i32 s65, s42, 73728
    s_add_u32 s64, s64, s37
    s_add_u32 s65, s65, s38
    s_add_u32 s42, s42, 1
    s_cmp_eq_u32 s42, 9
    s_cselect_b32 s42, 0, s42
    s_lshl_b32 s66, s42, 7
    s_mul_i32 s67, s42, 73728
    s_add_u32 s66, s66, s37
    s_add_u32 s67, s67, s38
    s_add_u32 s42, s42, 1
    s_cmp_eq_u32 s42, 9
    s_cselect_b32 s42, 0, s42
    s_mov_b32 s72, s42
    s_lshl_b32 s40, s36, 7
    s_add_u32 s73, s73, s40
    s_add_u32 s73, s73, 384
    s_lshl_b32 s11, s32, 11
    s_add_u32 s11, s11, 110592
    s_lshr_b32 s37, s32, 1
    s_and_b32 s38, s32, 1
    v_xor_b32 v21, s15, v19
    v_mul_u32_u24 v21, 18432, v21
    s_lshl_b32 s41, s38, 1
    s_add_u32 s41, s41, s37
    s_lshl_b32 s40, s36, 2
    s_add_u32 s40, s40, s41
    s_lshl_b32 s40, s40, 8
    s_add_u32 s40, s40, 3072
    v_add3_u32 v173, v21, v18, s40
    v_xor_b32 v174, 0x100, v173
    v_lshlrev_b32 v21, 1, v19
    v_xor_b32 v21, v21, v23
    v_lshl_add_u32 v123, v21, 4, v22
    v_xor_b32 v124, 64, v123
    v_add_u32 v124, 8192, v124
    v_lshrrev_b32 v18, 1, v16
    v_xor_b32 v18, v18, v17
    v_lshlrev_b32 v18, 4, v18
    v_lshl_add_u32 v18, v16, 7, v18
    v_add_u32 v140, s12, v18
    v_xor_b32 v141, 64, v140
    v_add_u32 v146, 57344, v140
    v_add_u32 v147, 57344, v141
    v_lshrrev_b32 v20, 2, v16
    v_lshl_add_u32 v18, v17, 3, v20
    v_and_b32 v21, 3, v16
    v_lshlrev_b32 v21, 3, v21
    v_lshl_add_u32 v142, v18, 6, v21
    v_lshl_add_u32 v142, v19, 5, v142
    v_xor_b32 v143, 32, v142
    v_lshl_add_u32 v18, v18, 7, v21
    v_lshrrev_b32 v20, 1, v20
    v_lshl_add_u32 v20, v19, 1, v20
    v_xor_b32 v20, s41, v20
    v_lshl_add_u32 v18, v20, 5, v18
    v_add_u32 v144, 110592, v18
    v_xor_b32 v145, 32, v144
    v_lshl_add_u32 v161, v0, 4, s13
    v_xor_b32 v162, 0x800, v161
    v_lshrrev_b32 v163, 1, v161
    v_xor_b32 v164, 0x200, v163
    s_lshl_b32 s40, s39, 7
    s_lshl_b32 s41, s36, 4
    s_add_u32 s40, s40, s41
    s_add_u32 s40, s40, 8978432
    v_or_b32 v18, s32, v0
    v_cmp_eq_u32 vcc, 0, v18
    v_mov_b32 v134, 2130706432
    v_mov_b32 v19, s40
    v_cndmask_b32 v127, v134, v19, vcc
    s_lshr_b32 s40, s15, 1
    s_lshl_b32 s40, s40, 7
    s_lshl_b32 s41, s36, 1
    s_add_u32 s41, s41, s38
    s_lshl_b32 s41, s41, 3
    s_add_u32 s40, s40, s41
    v_cmp_eq_u32 vcc, 0, v0
    s_add_u32 s40, s40, 8990720
    v_mov_b32 v19, s40
    v_cndmask_b32 v175, v134, v19, vcc
    s_lshl_b32 s40, s33, 11
    s_add_u32 s40, s40, 8962048
    v_lshl_add_u32 v133, v0, 5, s40
    v_and_b32 v18, 7, v0
    v_lshlrev_b32 v129, 5, v18
    s_lshl_b32 s40, s33, 2
    s_lshr_b32 s41, s2, 6
    s_add_u32 s40, s40, s41
    s_lshl_b32 s40, s40, 7
    s_add_u32 s40, s40, 8978432
    v_min_u32 v18, 5, v0
    v_lshl_add_u32 v131, v18, 4, s40
    v_and_b32 v18, 3, v16
    v_lshrrev_b32 v19, 2, v16
    v_cmp_eq_u32 s[44:45], 1, v18
    v_cmp_eq_u32 s[46:47], 2, v18
    v_cmp_eq_u32 s[48:49], 3, v18
    v_cmp_eq_u32 s[14:15], v17, v19
    v_mov_b32 v32, 0x3f803f80
    v_mov_b32 v33, 0x3f803f80
    v_mov_b32 v34, 0x3f803f80
    v_mov_b32 v35, 0x3f803f80
    s_mov_b32 s43, 0x3727c5ac
    v_lshlrev_b32 v12, 4, v0
    v_bfe_u32 v212, v0, 2, 2
    s_mul_i32 s5, s32, 18432
    v_lshl_add_u32 v6, v212, 8, s5
    v_and_b32 v213, 1, v0
    v_lshl_add_u32 v212, v212, 1, v213
    v_mul_u32_u24 v212, 1168, v212
    v_add_u32 v212, 20480, v212
    v_bfe_u32 v213, v0, 4, 1
    v_bfe_u32 v214, v0, 1, 1
    v_lshl_add_u32 v213, v213, 1, v214
    v_mad_u32_u24 v212, v213, 36, v212
    v_lshrrev_b32 v215, 5, v0
    v_cmp_eq_u32 vcc, 0, v215
    v_lshl_add_u32 v4, v215, 4, v212
    v_add_u32 v5, 32, v212
    v_mov_b32 v216, 11264
    v_cndmask_b32 v5, v216, v5, vcc
    v_mul_u32_u24 v3, 0xaaaa, v214
    v_add_u32 v3, 0x4444, v3
    v_mov_b32 v2, 0xdddd
    v_mov_b32 v13, 0
    v_mov_b32 v14, 0
    v_mov_b32 v15, 0
    v_accvgpr_write_b32 a249, 0
    v_accvgpr_write_b32 a250, 0
    v_accvgpr_write_b32 a253, 0
    v_accvgpr_write_b32 a254, 0
    v_mfma_f32_32x32x8_bf16 a[208:223], v[14:15], v[14:15], 0
    v_lshrrev_b32 v212, 4, v0
    s_waitcnt lgkmcnt(0)
    s_mov_b32 s75, 0
    s_mov_b64 exec, 0
    s_cmp_eq_u32 s32, 0
    s_cbranch_scc1 L_pad0
    s_cmp_eq_u32 s32, 1
    s_cbranch_scc1 L_pad1
    s_cmp_eq_u32 s32, 2
    s_cbranch_scc1 L_pad2
    s_branch L_pad3
L_warm_done:
    s_mov_b64 exec, -1
    s_cmp_eq_u32 s75, 1
    s_cbranch_scc1 L_warm_kv
L_warm_from:
    s_waitcnt vmcnt(7)
    s_barrier
    ds_read_b128 a[128:131], v140 offset:0
    ds_read_b64_tr_b16 v[80:81], v142 offset:0
    ds_read_b64_tr_b16 v[82:83], v142 offset:256
    ds_read_b64_tr_b16 v[84:85], v143 offset:0
    ds_read_b64_tr_b16 v[86:87], v143 offset:256
    s_add_u32 m0, s12, 24576
    s_nop 0
    buffer_load_dwordx4 v120, s[20:23], s56 offen lds
    buffer_load_dwordx4 v121, s[20:23], s56 offen offset:1024 lds
    s_add_u32 m0, s13, 12288
    s_nop 0
    buffer_load_dwordx4 v122, s[28:31], s57 offen lds
    s_waitcnt lgkmcnt(4)
    v_mfma_f32_16x16x32_bf16 v[36:39], v[32:35], a[128:131], 0
    ds_read_b128 a[132:135], v141 offset:0
    v_mfma_f32_16x16x32_bf16 v[40:43], a[128:131], a[128:131], 0
    ds_read_b64_tr_b16 v[92:93], v142 offset:2048
    s_waitcnt lgkmcnt(4)
    v_mfma_f32_16x16x32_bf16 v[44:47], v[80:83], v[32:35], 0
    ds_read_b64_tr_b16 v[94:95], v142 offset:2304
    v_mfma_f32_16x16x32_bf16 v[56:59], v[80:83], a[128:131], 0
    ds_read_b64_tr_b16 v[96:97], v143 offset:2048
    s_waitcnt lgkmcnt(4)
    v_mfma_f32_16x16x32_bf16 v[48:51], v[84:87], v[32:35], 0
    ds_read_b64_tr_b16 v[98:99], v143 offset:2304
    v_mfma_f32_16x16x32_bf16 v[60:63], v[84:87], a[128:131], 0
    s_waitcnt vmcnt(7)
    s_barrier
    s_waitcnt lgkmcnt(4)
    v_mfma_f32_16x16x32_bf16 v[36:39], v[32:35], a[132:135], v[36:39]
    s_add_u32 m0, s12, 32768
    ds_read_b128 a[136:139], v140 offset:8192
    v_mfma_f32_16x16x32_bf16 v[40:43], a[132:135], a[132:135], v[40:43]
    buffer_load_dwordx4 v120, s[20:23], s58 offen lds
    ds_read_b64_tr_b16 v[80:81], v142 offset:4096
    s_waitcnt lgkmcnt(4)
    v_mfma_f32_16x16x32_bf16 v[44:47], v[92:95], v[32:35], v[44:47]
    buffer_load_dwordx4 v121, s[20:23], s58 offen offset:1024 lds
    ds_read_b64_tr_b16 v[82:83], v142 offset:4352
    v_mfma_f32_16x16x32_bf16 v[56:59], v[92:95], a[132:135], v[56:59]
    s_add_u32 m0, s13, 16384
    ds_read_b64_tr_b16 v[84:85], v143 offset:4096
    s_waitcnt lgkmcnt(4)
    v_mfma_f32_16x16x32_bf16 v[48:51], v[96:99], v[32:35], v[48:51]
    buffer_load_dwordx4 v122, s[28:31], s59 offen lds
    ds_read_b64_tr_b16 v[86:87], v143 offset:4352
    v_mfma_f32_16x16x32_bf16 v[60:63], v[96:99], a[132:135], v[60:63]
    s_waitcnt lgkmcnt(4)
    v_mfma_f32_16x16x32_bf16 v[36:39], v[32:35], a[136:139], v[36:39]
    ds_read_b128 a[140:143], v141 offset:8192
    v_mfma_f32_16x16x32_bf16 v[40:43], a[136:139], a[136:139], v[40:43]
    ds_read_b64_tr_b16 v[92:93], v142 offset:6144
    s_waitcnt lgkmcnt(4)
    v_mfma_f32_16x16x32_bf16 v[44:47], v[80:83], v[32:35], v[44:47]
    ds_read_b64_tr_b16 v[94:95], v142 offset:6400
    v_mfma_f32_16x16x32_bf16 v[56:59], v[80:83], a[136:139], v[56:59]
    ds_read_b64_tr_b16 v[96:97], v143 offset:6144
    s_waitcnt lgkmcnt(4)
    v_mfma_f32_16x16x32_bf16 v[48:51], v[84:87], v[32:35], v[48:51]
    ds_read_b64_tr_b16 v[98:99], v143 offset:6400
    v_mfma_f32_16x16x32_bf16 v[60:63], v[84:87], a[136:139], v[60:63]
    v_lshl_add_u32 v6, v212, 6, v6
    v_and_b32 v212, 3, v0
    v_lshl_add_u32 v6, v212, 4, v6
    s_mul_i32 s5, s32, 2560
    v_add_u32 v7, s5, v12
    v_lshlrev_b32 v10, 3, v0
    s_add_u32 s5, s5, 2048
    v_add_u32 v8, s5, v10
    v_mfma_f32_32x32x8_bf16 a[224:239], v[14:15], v[14:15], 0
    s_lshr_b32 s5, s32, 1
    s_lshl_b32 s5, s5, 10
    s_and_b32 s6, s32, 1
    s_lshl_b32 s6, s6, 3
    s_add_u32 s5, s5, s6
    v_add_u32 v9, s5, v12
    s_lshl_b32 s5, s32, 2
    s_add_u32 s5, s5, 10240
    v_add_u32 v11, s5, v12
    v_mov_b32 v178, 0
    v_mov_b32 v179, 0
    v_mov_b32 v182, 0
    v_mov_b32 v183, 0
    v_mov_b32 v186, 0
    v_mov_b32 v187, 0
    v_mov_b32 v190, 0
    v_mov_b32 v191, 0
    v_mov_b32 v194, 0
    v_mov_b32 v195, 0
    v_mov_b32 v198, 0
    v_mov_b32 v199, 0
    v_mov_b32 v202, 0
    v_mov_b32 v203, 0
    v_mov_b32 v206, 0
    v_mov_b32 v207, 0
    v_mov_b32 v210, 0
    v_mov_b32 v211, 0
    v_mov_b32 v228, -1
    v_mov_b32 v229, -1
    v_mov_b32 v230, -1
    v_mov_b32 v231, -1
    v_and_b32 v214, 31, v0
    v_lshrrev_b32 v215, 5, v0
    v_cmp_gt_u32 vcc, 18, v214
    v_and_b32 v217, 30, v214
    v_cmp_eq_u32 s[6:7], 20, v217
    v_mov_b32 v217, 133169152
    v_subrev_u32 v216, 2, v214
    v_cndmask_b32 v217, v217, v214, vcc
    v_cndmask_b32 v217, v217, v216, s[6:7]
    v_mul_u32_u24 v216, 320, v215
    v_lshl_add_u32 v136, v217, 4, v216
    v_add_u32 v137, 2560, v136
    v_add_u32 v138, 5120, v12
    v_add_u32 v139, 9216, v12
    s_lshl_b32 s5, s33, 10
    s_add_u32 s5, s5, 8982528
    v_add_u32 v220, s5, v12
    s_lshl_b32 s4, s33, 5
    s_lshr_b32 s5, s2, 3
    s_add_u32 s4, s4, s5
    s_mul_i32 s5, s4, 9216
    v_lshrrev_b32 v212, 4, v0
    v_mul_u32_u24 v212, 2304, v212
    v_add_u32 v212, s5, v212
    v_and_b32 v213, 15, v0
    s_lshl_b32 s5, s32, 8
    v_lshl_add_u32 v251, v213, 4, s5
    s_lshl_b32 s5, s32, 5
    s_add_u32 s5, s5, 1024
    v_lshl_add_u32 v253, v213, 1, s5
    v_add_u32 v1, v212, v251
    v_add_u32 v247, v212, v253
    s_lshr_b32 s5, s4, 2
    s_lshl_b32 s5, s5, 7
    s_add_u32 s5, s5, 8990720
    v_min_u32 v212, 11, v0
    v_lshl_add_u32 v255, v212, 3, s5
    s_cmp_lt_u32 s32, 3
    s_cselect_b32 s5, 0, 2130706432
    v_add_u32 v227, s5, v12
    s_cmp_lt_u32 s32, 2
    s_cselect_b32 s5, 0, 2130706432
    s_cselect_b32 s6, 0, 119936
    v_add_u32 v221, s5, v12
    v_and_b32 v212, 7, v0
    v_mul_u32_u24 v224, 144, v212
    v_mul_u32_u24 v212, 1168, v212
    v_lshrrev_b32 v213, 3, v0
    v_lshl_add_u32 v212, v213, 4, v212
    s_lshl_b32 s5, s32, 7
    v_add_u32 v223, s5, v212
    v_add_u32 v226, s6, v223
    v_mov_b32 v225, 0xc240
    s_lshr_b32 s5, s2, 3
    s_lshl_b32 s5, s5, 2
    s_add_u32 s5, s5, s32
    s_sub_u32 s5, s5, 72
    s_mul_i32 s5, s5, 24
    v_add_u32 v215, s5, v0
    v_cmp_gt_u32 s[6:7], 24, v0
    v_cmp_gt_u32 vcc, 1296, v215
    v_mul_u32_u24 v216, 7282, v215
    v_lshrrev_b32 v216, 16, v216
    v_mul_u32_u24 v216, 8064, v216
    v_lshl_add_u32 v215, v215, 7, v216
    s_and_b64 vcc, vcc, s[6:7]
    v_mov_b32 v216, 2130706432
    v_cndmask_b32 v215, v216, v215, vcc
    v_lshrrev_b32 v212, 2, v0
    v_and_b32 v213, 3, v0
    v_bfe_u32 v214, v0, 5, 1
    v_lshlrev_b32 v214, 1, v214
    v_xor_b32 v213, v213, v214
    v_mul_u32_u24 v212, 9216, v212
    s_cmp_lt_u32 s2, 144
    s_cselect_b64 vcc, -1, 0
L_pad0:
    s_cbranch_execz L_pad4
    v_lshl_add_u32 v212, v213, 4, v212
    v_cndmask_b32 v248, v215, v212, vcc
    v_add_u32 v252, 589824, v248
    s_lshl_b32 s5, s32, 8
    s_add_u32 s5, s5, s2
    s_cmp_lt_u32 s5, 672
    s_cselect_b32 s5, 0, 2130706432
    v_add_u32 v249, s5, v12
    s_waitcnt vmcnt(7)
    s_barrier
    s_waitcnt lgkmcnt(4)
    v_mfma_f32_16x16x32_bf16 v[36:39], v[32:35], a[140:143], v[36:39]
    s_add_u32 m0, s12, 40960
    ds_read_b128 a[144:147], v140 offset:16384
    v_mfma_f32_16x16x32_bf16 v[40:43], a[140:143], a[140:143], v[40:43]
    buffer_load_dwordx4 v120, s[20:23], s60 offen lds
    ds_read_b64_tr_b16 v[80:81], v142 offset:8192
    s_waitcnt lgkmcnt(4)
    v_mfma_f32_16x16x32_bf16 v[44:47], v[92:95], v[32:35], v[44:47]
    buffer_load_dwordx4 v121, s[20:23], s60 offen offset:1024 lds
    ds_read_b64_tr_b16 v[82:83], v142 offset:8448
    v_mfma_f32_16x16x32_bf16 v[56:59], v[92:95], a[140:143], v[56:59]
    s_add_u32 m0, s13, 20480
    ds_read_b64_tr_b16 v[84:85], v143 offset:8192
    s_waitcnt lgkmcnt(4)
    v_mfma_f32_16x16x32_bf16 v[48:51], v[96:99], v[32:35], v[48:51]
    buffer_load_dwordx4 v122, s[28:31], s61 offen lds
    ds_read_b64_tr_b16 v[86:87], v143 offset:8448
    v_mfma_f32_16x16x32_bf16 v[60:63], v[96:99], a[140:143], v[60:63]
    s_waitcnt lgkmcnt(4)
    v_mfma_f32_16x16x32_bf16 v[36:39], v[32:35], a[144:147], v[36:39]
    ds_read_b128 a[148:151], v141 offset:16384
    v_mfma_f32_16x16x32_bf16 v[40:43], a[144:147], a[144:147], v[40:43]
    ds_read_b64_tr_b16 v[92:93], v142 offset:10240
    s_waitcnt lgkmcnt(4)
    v_mfma_f32_16x16x32_bf16 v[44:47], v[80:83], v[32:35], v[44:47]
    ds_read_b64_tr_b16 v[94:95], v142 offset:10496
    v_mfma_f32_16x16x32_bf16 v[56:59], v[80:83], a[144:147], v[56:59]
    ds_read_b64_tr_b16 v[96:97], v143 offset:10240
    s_waitcnt lgkmcnt(4)
    v_mfma_f32_16x16x32_bf16 v[48:51], v[84:87], v[32:35], v[48:51]
    ds_read_b64_tr_b16 v[98:99], v143 offset:10496
    v_mfma_f32_16x16x32_bf16 v[60:63], v[84:87], a[144:147], v[60:63]
    s_mov_b64 exec, 0
    s_cmp_eq_u32 s32, 0
    s_cbranch_scc1 L_padb0
    s_cmp_eq_u32 s32, 1
    s_cbranch_scc1 L_padb1
    s_cmp_eq_u32 s32, 2
    s_cbranch_scc1 L_padb2
    s_branch L_padb3
L_warm2_done:
    s_mov_b64 exec, -1
    s_cmp_eq_u32 s75, 1
    s_cbranch_scc1 L_warm2_kv
    s_waitcnt vmcnt(6)
    s_barrier
    buffer_load_dword v126, v129, s[24:27], 0 offen sc1
    s_waitcnt lgkmcnt(4)
    v_mfma_f32_16x16x32_bf16 v[36:39], v[32:35], a[148:151], v[36:39]
    s_add_u32 m0, s12, 49152
    ds_read_b128 a[152:155], v140 offset:24576
    v_mfma_f32_16x16x32_bf16 v[40:43], a[148:151], a[148:151], v[40:43]
    buffer_load_dwordx4 v120, s[20:23], s62 offen lds
    ds_read_b64_tr_b16 v[80:81], v142 offset:12288
    s_waitcnt lgkmcnt(4)
    v_mfma_f32_16x16x32_bf16 v[44:47], v[92:95], v[32:35], v[44:47]
    buffer_load_dwordx4 v121, s[20:23], s62 offen offset:1024 lds
    ds_read_b64_tr_b16 v[82:83], v142 offset:12544
    v_mfma_f32_16x16x32_bf16 v[56:59], v[92:95], a[148:151], v[56:59]
    s_add_u32 m0, s13, 24576
    ds_read_b64_tr_b16 v[84:85], v143 offset:12288
    s_waitcnt lgkmcnt(4)
    v_mfma_f32_16x16x32_bf16 v[48:51], v[96:99], v[32:35], v[48:51]
    buffer_load_dwordx4 v122, s[28:31], s63 offen lds
    ds_read_b64_tr_b16 v[86:87], v143 offset:12544
    v_mfma_f32_16x16x32_bf16 v[60:63], v[96:99], a[148:151], v[60:63]
    s_waitcnt lgkmcnt(4)
    v_mfma_f32_16x16x32_bf16 v[36:39], v[32:35], a[152:155], v[36:39]
    ds_read_b128 a[156:159], v141 offset:24576
    v_mfma_f32_16x16x32_bf16 v[40:43], a[152:155], a[152:155], v[40:43]
    ds_read_b64_tr_b16 v[92:93], v142 offset:14336
    s_waitcnt lgkmcnt(4)
    v_mfma_f32_16x16x32_bf16 v[44:47], v[80:83], v[32:35], v[44:47]
    ds_read_b64_tr_b16 v[94:95], v142 offset:14592
    v_mfma_f32_16x16x32_bf16 v[56:59], v[80:83], a[152:155], v[56:59]
    ds_read_b64_tr_b16 v[96:97], v143 offset:14336
    s_waitcnt lgkmcnt(4)
    v_mfma_f32_16x16x32_bf16 v[48:51], v[84:87], v[32:35], v[48:51]
    ds_read_b64_tr_b16 v[98:99], v143 offset:14592
    v_mfma_f32_16x16x32_bf16 v[60:63], v[84:87], a[152:155], v[60:63]
    s_waitcnt vmcnt(7)
    s_barrier
    s_waitcnt lgkmcnt(4)
    v_mfma_f32_16x16x32_bf16 v[36:39], v[32:35], a[156:159], v[36:39]
    s_add_u32 m0, s12, 57344
    ds_read_b128 a[160:163], v140 offset:32768
    v_mfma_f32_16x16x32_bf16 v[40:43], a[156:159], a[156:159], v[40:43]
    buffer_load_dwordx4 v120, s[20:23], s64 offen lds
    ds_read_b64_tr_b16 v[80:81], v142 offset:16384
    s_waitcnt lgkmcnt(4)
    v_mfma_f32_16x16x32_bf16 v[44:47], v[92:95], v[32:35], v[44:47]
    buffer_load_dwordx4 v121, s[20:23], s64 offen offset:1024 lds
    ds_read_b64_tr_b16 v[82:83], v142 offset:16640
    v_mfma_f32_16x16x32_bf16 v[56:59], v[92:95], a[156:159], v[56:59]
    s_add_u32 m0, s13, 28672
    ds_read_b64_tr_b16 v[84:85], v143 offset:16384
    s_waitcnt lgkmcnt(4)
    v_mfma_f32_16x16x32_bf16 v[48:51], v[96:99], v[32:35], v[48:51]
    buffer_load_dwordx4 v122, s[28:31], s65 offen lds
    ds_read_b64_tr_b16 v[86:87], v143 offset:16640
    v_mfma_f32_16x16x32_bf16 v[60:63], v[96:99], a[156:159], v[60:63]
    s_waitcnt lgkmcnt(4)
    v_mfma_f32_16x16x32_bf16 v[36:39], v[32:35], a[160:163], v[36:39]
    ds_read_b128 a[164:167], v141 offset:32768
    v_mfma_f32_16x16x32_bf16 v[40:43], a[160:163], a[160:163], v[40:43]
    ds_read_b64_tr_b16 v[92:93], v142 offset:18432
    s_waitcnt lgkmcnt(4)
    v_mfma_f32_16x16x32_bf16 v[44:47], v[80:83], v[32:35], v[44:47]
    ds_read_b64_tr_b16 v[94:95], v142 offset:18688
    v_mfma_f32_16x16x32_bf16 v[56:59], v[80:83], a[160:163], v[56:59]
    ds_read_b64_tr_b16 v[96:97], v143 offset:18432
    s_waitcnt lgkmcnt(4)
    v_mfma_f32_16x16x32_bf16 v[48:51], v[84:87], v[32:35], v[48:51]
    ds_read_b64_tr_b16 v[98:99], v143 offset:18688
    v_mfma_f32_16x16x32_bf16 v[60:63], v[84:87], a[160:163], v[60:63]
    s_waitcnt vmcnt(7)
    s_barrier
    s_waitcnt lgkmcnt(4)
    v_mfma_f32_16x16x32_bf16 v[36:39], v[32:35], a[164:167], v[36:39]
    s_add_u32 m0, s12, 65536
    ds_read_b128 a[168:171], v140 offset:40960
    v_mfma_f32_16x16x32_bf16 v[40:43], a[164:167], a[164:167], v[40:43]
    buffer_load_dwordx4 v120, s[20:23], s66 offen lds
    ds_read_b64_tr_b16 v[80:81], v142 offset:20480
    s_waitcnt lgkmcnt(4)
    v_mfma_f32_16x16x32_bf16 v[44:47], v[92:95], v[32:35], v[44:47]
    buffer_load_dwordx4 v121, s[20:23], s66 offen offset:1024 lds
    ds_read_b64_tr_b16 v[82:83], v142 offset:20736
    v_mfma_f32_16x16x32_bf16 v[56:59], v[92:95], a[164:167], v[56:59]
    s_add_u32 m0, s13, 32768
    ds_read_b64_tr_b16 v[84:85], v143 offset:20480
    s_waitcnt lgkmcnt(4)
    v_mfma_f32_16x16x32_bf16 v[48:51], v[96:99], v[32:35], v[48:51]
    buffer_load_dwordx4 v122, s[28:31], s67 offen lds
    ds_read_b64_tr_b16 v[86:87], v143 offset:20736
    v_mfma_f32_16x16x32_bf16 v[60:63], v[96:99], a[164:167], v[60:63]
    s_waitcnt lgkmcnt(4)
    v_mfma_f32_16x16x32_bf16 v[36:39], v[32:35], a[168:171], v[36:39]
    ds_read_b128 a[172:175], v141 offset:40960
    v_mfma_f32_16x16x32_bf16 v[40:43], a[168:171], a[168:171], v[40:43]
    ds_read_b64_tr_b16 v[92:93], v142 offset:22528
    s_waitcnt lgkmcnt(4)
    v_mfma_f32_16x16x32_bf16 v[44:47], v[80:83], v[32:35], v[44:47]
    ds_read_b64_tr_b16 v[94:95], v142 offset:22784
    v_mfma_f32_16x16x32_bf16 v[56:59], v[80:83], a[168:171], v[56:59]
    ds_read_b64_tr_b16 v[96:97], v143 offset:22528
    s_waitcnt lgkmcnt(4)
    v_mfma_f32_16x16x32_bf16 v[48:51], v[84:87], v[32:35], v[48:51]
    ds_read_b64_tr_b16 v[98:99], v143 offset:22784
    v_mfma_f32_16x16x32_bf16 v[60:63], v[84:87], a[168:171], v[60:63]
    s_waitcnt vmcnt(6)
    v_cmp_eq_u32 vcc, 0, v126
    s_cbranch_vccz L_set_goq
    s_mov_b32 s40, 0
L_spin_goq:
    s_sleep 2
    s_mov_b64 exec, vcc
    buffer_load_dword v126, v129, s[24:27], 0 offen sc1
    s_mov_b64 exec, -1
    s_waitcnt vmcnt(0)
    v_cmp_eq_u32 vcc, 0, v126
    s_cbranch_vccz L_set_goq
    s_add_u32 s40, s40, 1
    s_cmp_lt_u32 s40, 200000
    s_cbranch_scc1 L_spin_goq
L_set_goq:
    s_barrier
    buffer_store_dword v32, v127, s[16:19], 0 offen sc1
    s_waitcnt lgkmcnt(4)
    v_mfma_f32_16x16x32_bf16 v[36:39], v[32:35], a[172:175], v[36:39]
    buffer_load_dwordx4 v[212:215], v1, s[20:23], 0 offen
    ds_read_b128 a[176:179], v140 offset:49152
    v_mfma_f32_16x16x32_bf16 v[40:43], a[172:175], a[172:175], v[40:43]
    buffer_load_dwordx4 v[216:219], v1, s[20:23], 0 offen offset:1152
    ds_read_b64_tr_b16 v[80:81], v142 offset:24576
    s_waitcnt lgkmcnt(4)
    v_mfma_f32_16x16x32_bf16 v[44:47], v[92:95], v[32:35], v[44:47]
    buffer_load_ushort v30, v247, s[20:23], 0 offen
    ds_read_b64_tr_b16 v[82:83], v142 offset:24832
    v_mfma_f32_16x16x32_bf16 v[56:59], v[92:95], a[172:175], v[56:59]
    buffer_load_ushort v31, v247, s[20:23], 0 offen offset:1152
    ds_read_b64_tr_b16 v[84:85], v143 offset:24576
    s_waitcnt lgkmcnt(4)
    v_mfma_f32_16x16x32_bf16 v[48:51], v[96:99], v[32:35], v[48:51]
    global_load_dwordx4 v[232:235], v251, s[8:9]
    ds_read_b64_tr_b16 v[86:87], v143 offset:24832
    v_mfma_f32_16x16x32_bf16 v[60:63], v[96:99], a[172:175], v[60:63]
    global_load_ushort v236, v253, s[8:9]
    s_waitcnt lgkmcnt(4)
    v_mfma_f32_16x16x32_bf16 v[36:39], v[32:35], a[176:179], v[36:39]
    s_mul_i32 s35, s72, 73728
    s_add_u32 m0, s11, 0
    s_add_u32 s35, s35, s73
    ds_read_b128 a[180:183], v141 offset:49152
    v_mfma_f32_16x16x32_bf16 v[40:43], a[176:179], a[176:179], v[40:43]
    buffer_load_dwordx4 v123, s[28:31], s35 offen lds
    ds_read_b64_tr_b16 v[92:93], v142 offset:26624
    s_waitcnt lgkmcnt(4)
    v_mfma_f32_16x16x32_bf16 v[44:47], v[80:83], v[32:35], v[44:47]
    buffer_load_dwordx4 v124, s[28:31], s35 offen offset:1024 lds
    ds_read_b64_tr_b16 v[94:95], v142 offset:26880
    v_mfma_f32_16x16x32_bf16 v[56:59], v[80:83], a[176:179], v[56:59]
    s_add_u32 s72, s72, 1
    s_cmp_eq_u32 s72, 9
    s_cselect_b32 s72, 0, s72
    ds_read_b64_tr_b16 v[96:97], v143 offset:26624
    s_waitcnt lgkmcnt(4)
    v_mfma_f32_16x16x32_bf16 v[48:51], v[84:87], v[32:35], v[48:51]
    ds_read_b64_tr_b16 v[98:99], v143 offset:26880
    v_mfma_f32_16x16x32_bf16 v[60:63], v[84:87], a[176:179], v[60:63]
    s_waitcnt vmcnt(12)
    s_barrier
    s_waitcnt lgkmcnt(4)
    v_mfma_f32_16x16x32_bf16 v[36:39], v[32:35], a[180:183], v[36:39]
    s_mul_i32 s35, s72, 73728
    s_add_u32 m0, s11, 8192
    s_add_u32 s35, s35, s73
    ds_read_b128 a[184:187], v146 offset:0
    v_mfma_f32_16x16x32_bf16 v[40:43], a[180:183], a[180:183], v[40:43]
    buffer_load_dwordx4 v123, s[28:31], s35 offen lds
    ds_read_b64_tr_b16 v[80:81], v142 offset:28672
    s_waitcnt lgkmcnt(4)
    v_mfma_f32_16x16x32_bf16 v[44:47], v[92:95], v[32:35], v[44:47]
    buffer_load_dwordx4 v124, s[28:31], s35 offen offset:1024 lds
    ds_read_b64_tr_b16 v[82:83], v142 offset:28928
    v_mfma_f32_16x16x32_bf16 v[56:59], v[92:95], a[180:183], v[56:59]
    s_add_u32 s72, s72, 1
    s_cmp_eq_u32 s72, 9
    s_cselect_b32 s72, 0, s72
    ds_read_b64_tr_b16 v[84:85], v143 offset:28672
    s_waitcnt lgkmcnt(4)
    v_mfma_f32_16x16x32_bf16 v[48:51], v[96:99], v[32:35], v[48:51]
    s_mul_i32 s35, s72, 73728
    s_add_u32 m0, s11, 16384
    s_add_u32 s35, s35, s73
    ds_read_b64_tr_b16 v[86:87], v143 offset:28928
    v_mfma_f32_16x16x32_bf16 v[60:63], v[96:99], a[180:183], v[60:63]
    buffer_load_dwordx4 v123, s[28:31], s35 offen lds
    s_waitcnt lgkmcnt(4)
    v_mfma_f32_16x16x32_bf16 v[36:39], v[32:35], a[184:187], v[36:39]
    buffer_load_dwordx4 v124, s[28:31], s35 offen offset:1024 lds
    ds_read_b128 a[188:191], v147 offset:0
    v_mfma_f32_16x16x32_bf16 v[40:43], a[184:187], a[184:187], v[40:43]
    s_add_u32 s72, s72, 1
    s_cmp_eq_u32 s72, 9
    s_cselect_b32 s72, 0, s72
    ds_read_b64_tr_b16 v[92:93], v142 offset:30720
    s_waitcnt lgkmcnt(4)
    v_mfma_f32_16x16x32_bf16 v[44:47], v[80:83], v[32:35], v[44:47]
    s_mul_i32 s35, s72, 73728
    s_add_u32 m0, s11, 24576
    s_add_u32 s35, s35, s73
    ds_read_b64_tr_b16 v[94:95], v142 offset:30976
    v_mfma_f32_16x16x32_bf16 v[56:59], v[80:83], a[184:187], v[56:59]
    buffer_load_dwordx4 v123, s[28:31], s35 offen lds
    ds_read_b64_tr_b16 v[96:97], v143 offset:30720
    s_waitcnt lgkmcnt(4)
    v_mfma_f32_16x16x32_bf16 v[48:51], v[84:87], v[32:35], v[48:51]
    buffer_load_dwordx4 v124, s[28:31], s35 offen offset:1024 lds
    ds_read_b64_tr_b16 v[98:99], v143 offset:30976
    v_mfma_f32_16x16x32_bf16 v[60:63], v[84:87], a[184:187], v[60:63]
    s_add_u32 s72, s72, 1
    s_cmp_eq_u32 s72, 9
    s_cselect_b32 s72, 0, s72
    s_waitcnt vmcnt(15)
    s_barrier
    s_waitcnt lgkmcnt(4)
    v_mfma_f32_16x16x32_bf16 v[36:39], v[32:35], a[188:191], v[36:39]
    ds_read_b128 a[192:195], v146 offset:8192
    v_mfma_f32_16x16x32_bf16 v[40:43], a[188:191], a[188:191], v[40:43]
    ds_read_b64_tr_b16 v[80:81], v142 offset:32768
    s_waitcnt lgkmcnt(4)
    v_mfma_f32_16x16x32_bf16 v[44:47], v[92:95], v[32:35], v[44:47]
    ds_read_b64_tr_b16 v[82:83], v142 offset:33024
    v_mfma_f32_16x16x32_bf16 v[56:59], v[92:95], a[188:191], v[56:59]
    ds_read_b64_tr_b16 v[84:85], v143 offset:32768
    s_waitcnt lgkmcnt(4)
    v_mfma_f32_16x16x32_bf16 v[48:51], v[96:99], v[32:35], v[48:51]
    ds_read_b64_tr_b16 v[86:87], v143 offset:33024
    v_mfma_f32_16x16x32_bf16 v[60:63], v[96:99], a[188:191], v[60:63]
    s_waitcnt lgkmcnt(4)
    v_mfma_f32_16x16x32_bf16 v[36:39], v[32:35], a[192:195], v[36:39]
    ds_read_b128 a[196:199], v147 offset:8192
    v_mfma_f32_16x16x32_bf16 v[40:43], a[192:195], a[192:195], v[40:43]
    ds_read_b64_tr_b16 v[92:93], v142 offset:34816
    s_waitcnt lgkmcnt(4)
    v_mfma_f32_16x16x32_bf16 v[44:47], v[80:83], v[32:35], v[44:47]
    ds_read_b64_tr_b16 v[94:95], v142 offset:35072
    v_mfma_f32_16x16x32_bf16 v[56:59], v[80:83], a[192:195], v[56:59]
    ds_read_b64_tr_b16 v[96:97], v143 offset:34816
    s_waitcnt lgkmcnt(4)
    v_mfma_f32_16x16x32_bf16 v[48:51], v[84:87], v[32:35], v[48:51]
    ds_read_b64_tr_b16 v[98:99], v143 offset:35072
    v_mfma_f32_16x16x32_bf16 v[60:63], v[84:87], a[192:195], v[60:63]
    s_waitcnt lgkmcnt(4)
    v_mfma_f32_16x16x32_bf16 v[36:39], v[32:35], a[196:199], v[36:39]
    v_mfma_f32_16x16x32_bf16 v[40:43], a[196:199], a[196:199], v[40:43]
    s_waitcnt lgkmcnt(2)
    v_mfma_f32_16x16x32_bf16 v[44:47], v[92:95], v[32:35], v[44:47]
    v_mfma_f32_16x16x32_bf16 v[56:59], v[92:95], a[196:199], v[56:59]
    s_waitcnt lgkmcnt(0)
    v_mfma_f32_16x16x32_bf16 v[48:51], v[96:99], v[32:35], v[48:51]
    v_mfma_f32_16x16x32_bf16 v[60:63], v[96:99], a[196:199], v[60:63]
    s_load_dwordx2 s[38:39], s[0:1], 72
    s_load_dwordx2 s[24:25], s[0:1], 80
    s_load_dwordx2 s[12:13], s[0:1], 56
    s_load_dwordx2 s[68:69], s[0:1], 64
    v_xor_b32 v140, 0x800, v140
    v_xor_b32 v141, 0x800, v141
    v_xor_b32 v146, 0x800, v146
    v_xor_b32 v147, 0x800, v147
    v_cndmask_b32 v18, v40, v41, s[44:45]
    v_cndmask_b32 v18, v18, v42, s[46:47]
    v_cndmask_b32 v18, v18, v43, s[48:49]
    v_cndmask_b32 v18, 0, v18, s[14:15]
    v_mov_b32 v19, v18
    v_mul_f32 v166, 0x3ae38e39, v36
    v_fma_f32 v20, -v166, v166, s43
    v_permlane16_swap_b32 v19, v18
    s_nop 0
    v_add_f32 v18, v18, v19
    v_mov_b32 v19, v18
    s_nop 1
    v_permlane32_swap_b32 v19, v18
    s_nop 0
    v_add_f32 v18, v18, v19
    v_fmac_f32 v20, 0x3ae38e39, v18
    v_max_f32 v20, s43, v20
    v_rsq_f32 v167, v20
    s_nop 0
    v_mul_f32 v167, 0x3eae1a93, v167
    v_pk_fma_f32 v[56:57], v[44:45], v[166:167], v[56:57] op_sel_hi:[1,0,1] neg_lo:[1,0,0] neg_hi:[1,0,0]
    v_pk_fma_f32 v[58:59], v[46:47], v[166:167], v[58:59] op_sel_hi:[1,0,1] neg_lo:[1,0,0] neg_hi:[1,0,0]
    v_pk_fma_f32 v[60:61], v[48:49], v[166:167], v[60:61] op_sel_hi:[1,0,1] neg_lo:[1,0,0] neg_hi:[1,0,0]
    v_pk_fma_f32 v[62:63], v[50:51], v[166:167], v[62:63] op_sel_hi:[1,0,1] neg_lo:[1,0,0] neg_hi:[1,0,0]
    v_pk_mul_f32 v[56:57], v[56:57], v[166:167] op_sel:[0,1] op_sel_hi:[1,1]
    v_pk_mul_f32 v[58:59], v[58:59], v[166:167] op_sel:[0,1] op_sel_hi:[1,1]
    v_pk_mul_f32 v[60:61], v[60:61], v[166:167] op_sel:[0,1] op_sel_hi:[1,1]
    v_pk_mul_f32 v[62:63], v[62:63], v[166:167] op_sel:[0,1] op_sel_hi:[1,1]
    v_cvt_pk_bf16_f32 v104, v56, v57
    v_cvt_pk_bf16_f32 v106, v60, v61
    v_cvt_pk_bf16_f32 v105, v58, v59
    v_cvt_pk_bf16_f32 v107, v62, v63
    v_permlane16_swap_b32 v104, v106
    s_nop 0
    v_permlane16_swap_b32 v105, v107
    v_min_u32 v104, -2, v104
    buffer_store_dwordx4 v[104:107], v165, s[16:19], 0 offen sc1
    s_waitcnt lgkmcnt(0)
    s_waitcnt vmcnt(9)
    s_lshl_b32 s34, s32, 2
    s_bfe_u32 s46, s2, 0x20003
    s_add_u32 s47, s46, 0
    s_and_b32 s47, s47, 3
    s_add_u32 s47, s47, s34
    s_mul_i32 s47, s47, 10240
    s_add_u32 s47, s47, 2359296
    s_add_u32 s52, s16, s47
    s_addc_u32 s53, s17, 0
    s_movk_i32 s54, 10240
    s_mov_b32 s55, 0x20000
    s_add_u32 s47, s46, 1
    s_and_b32 s47, s47, 3
    s_add_u32 s47, s47, s34
    s_mul_i32 s47, s47, 10240
    s_add_u32 s47, s47, 2359296
    s_add_u32 s56, s16, s47
    s_addc_u32 s57, s17, 0
    s_movk_i32 s58, 10240
    s_mov_b32 s59, 0x20000
    s_add_u32 s47, s46, 2
    s_and_b32 s47, s47, 3
    s_add_u32 s47, s47, s34
    s_mul_i32 s47, s47, 10240
    s_add_u32 s47, s47, 2359296
    s_add_u32 s60, s16, s47
    s_addc_u32 s61, s17, 0
    s_movk_i32 s62, 10240
    s_mov_b32 s63, 0x20000
    s_add_u32 s47, s46, 3
    s_and_b32 s47, s47, 3
    s_add_u32 s47, s47, s34
    s_mul_i32 s47, s47, 10240
    s_add_u32 s47, s47, 2359296
    s_add_u32 s64, s16, s47
    s_addc_u32 s65, s17, 0
    s_movk_i32 s66, 10240
    s_mov_b32 s67, 0x20000
    s_mul_i32 s33, s4, 9216
    s_lshl_b32 s5, s32, 10
    s_add_u32 s5, s33, s5
    s_add_u32 s6, s5, 4096
    s_mov_b32 s26, 2359296
    s_mov_b32 s43, 0xffff0000
    s_mov_b32 s42, 0xf800000
    s_mov_b32 s14, 5308416
    s_mov_b32 s70, 5309440
    s_mov_b32 s15, 0x20000
    s_sub_u32 s68, s68, 1024
    s_subb_u32 s69, s69, 0
    s_and_b32 s10, s2, 7
    s_mul_i32 s10, s10, 18
    s_lshr_b32 s47, s2, 3
    s_add_u32 s3, s10, s47
    s_min_u32 s3, s3, 143
    s_mul_i32 s48, s32, 147456
    s_lshl_b32 s47, s3, 6
    s_add_u32 s48, s48, s47
    s_lshl_b32 s10, s10, 6
    s_cmp_lt_u32 s2, 144
    s_cselect_b32 s48, s48, s10
    s_cselect_b32 s9, 0, 1327104
    s_cselect_b32 s8, 1179648, 0
    s_mul_i32 s49, s3, 36864
    s_mul_i32 s51, s32, 9216
    s_add_u32 s49, s49, s51
    s_add_u32 s51, s51, 103552
    s_add_u32 s12, s12, s48
    s_addc_u32 s13, s13, 0
    s_add_u32 s68, s68, s48
    s_addc_u32 s69, s69, 0
    s_add_u32 s38, s38, s49
    s_addc_u32 s39, s39, 0
    s_lshl_b32 s50, s32, 11
    s_add_u32 s50, s50, 29824
    s_add_u32 s36, s5, 3190784
    s_add_u32 s37, s5, 3194880
    s_add_u32 s47, s33, 3198976
    s_lshl_b32 s44, s2, 2
    s_add_u32 s44, s44, s32
    s_lshl_b32 s44, s44, 10
    s_add_u32 s44, s44, 5816320
    s_lshl_b32 s45, s32, 8
    s_add_u32 s45, s45, s2
    s_lshl_b32 s45, s45, 10
    s_add_u32 s45, s45, 6602752
    s_cmp_eq_u32 s32, 0
    s_cselect_b32 s45, s47, s45
    v_lshlrev_b32 v238, 16, v232
    v_and_b32 v239, s43, v232
    v_lshlrev_b32 v240, 16, v233
    v_and_b32 v241, s43, v233
    v_lshlrev_b32 v242, 16, v234
    v_and_b32 v243, s43, v234
    v_lshlrev_b32 v244, 16, v235
    v_and_b32 v245, s43, v235
    v_lshlrev_b32 v246, 16, v236
    v_add_f32 v254, v238, v239
    v_add_f32 v254, v254, v240
    v_add_f32 v254, v254, v241
    v_add_f32 v254, v254, v242
    v_add_f32 v254, v254, v243
    v_add_f32 v254, v254, v244
    v_add_f32 v254, v254, v245
    v_add_f32 v254, v254, v246
    v_lshlrev_b32 v176, 16, v212
    v_lshlrev_b32 v177, 16, v216
    v_and_b32 v180, s43, v212
    v_add_f32_dpp v254, v254, v254 row_ror:8 row_mask:0xf bank_mask:0xf
    v_and_b32 v181, s43, v216
    v_lshlrev_b32 v184, 16, v213
    v_lshlrev_b32 v185, 16, v217
    v_add_f32_dpp v254, v254, v254 row_ror:4 row_mask:0xf bank_mask:0xf
    v_and_b32 v188, s43, v213
    v_and_b32 v189, s43, v217
    v_lshlrev_b32 v192, 16, v214
    v_add_f32_dpp v254, v254, v254 row_ror:2 row_mask:0xf bank_mask:0xf
    v_lshlrev_b32 v193, 16, v218
    v_and_b32 v196, s43, v214
    v_and_b32 v197, s43, v218
    v_add_f32_dpp v254, v254, v254 row_ror:1 row_mask:0xf bank_mask:0xf
    v_lshlrev_b32 v200, 16, v215
    v_lshlrev_b32 v201, 16, v219
    v_and_b32 v204, s43, v215
    v_and_b32 v205, s43, v219
    v_lshlrev_b32 v208, 16, v30
    v_lshlrev_b32 v209, 16, v31
    s_waitcnt vmcnt(7)
    s_barrier
    ds_read_b64_tr_b16 v[80:81], v144 offset:0
    ds_read_b64_tr_b16 v[82:83], v144 offset:512
    ds_read_b128 v[88:91], v140 offset:0
    ds_read_b64_tr_b16 v[84:85], v145 offset:0
    ds_read_b64_tr_b16 v[86:87], v145 offset:512
    ds_write_b64 v163, v[166:167] offset:4096
    ds_write_b32 v224, v225 offset:11264
    s_mul_i32 s35, s72, 73728
    s_add_u32 m0, s11, 32768
    s_add_u32 s35, s35, s73
    buffer_load_dwordx4 v123, s[28:31], s35 offen lds
    buffer_load_dwordx4 v124, s[28:31], s35 offen offset:1024 lds
    s_add_u32 s72, s72, 1
    s_cmp_eq_u32 s72, 9
    s_cselect_b32 s72, 0, s72
    s_waitcnt lgkmcnt(5)
    v_mfma_f32_16x16x32_bf16 v[44:47], v[80:83], v[32:35], 0
    ds_read_b64_tr_b16 v[92:93], v144 offset:4096
    v_mfma_f32_16x16x32_bf16 v[56:59], v[80:83], a[128:131], 0
    ds_read_b64_tr_b16 v[94:95], v144 offset:4608
    s_waitcnt lgkmcnt(6)
    v_mfma_f32_16x16x32_bf16 v[60:63], v[80:83], v[88:91], 0
    ds_read_b128 v[100:103], v141 offset:0
    s_waitcnt lgkmcnt(5)
    v_mfma_f32_16x16x32_bf16 v[64:67], v[84:87], a[128:131], 0
    ds_read_b64_tr_b16 v[96:97], v145 offset:4096
    v_mfma_f32_16x16x32_bf16 v[68:71], v[84:87], v[88:91], 0
    ds_read_b64_tr_b16 v[98:99], v145 offset:4608
    s_waitcnt vmcnt(7)
    s_barrier
    s_waitcnt lgkmcnt(3)
    v_mfma_f32_16x16x32_bf16 v[44:47], v[92:95], v[32:35], v[44:47]
    s_mul_i32 s35, s72, 73728
    s_add_u32 m0, s11, 40960
    s_add_u32 s35, s35, s73
    ds_read_b64_tr_b16 v[80:81], v144 offset:8192
    v_mfma_f32_16x16x32_bf16 v[56:59], v[92:95], a[132:135], v[56:59]
    buffer_load_dwordx4 v123, s[28:31], s35 offen lds
    ds_read_b64_tr_b16 v[82:83], v144 offset:8704
    s_waitcnt lgkmcnt(4)
    v_mfma_f32_16x16x32_bf16 v[60:63], v[92:95], v[100:103], v[60:63]
    buffer_load_dwordx4 v124, s[28:31], s35 offen offset:1024 lds
    ds_read_b128 v[88:91], v140 offset:8192
    s_waitcnt lgkmcnt(3)
    v_mfma_f32_16x16x32_bf16 v[64:67], v[96:99], a[132:135], v[64:67]
    s_add_u32 s72, s72, 1
    s_cmp_eq_u32 s72, 9
    s_cselect_b32 s72, 0, s72
    ds_read_b64_tr_b16 v[84:85], v145 offset:8192
    v_mfma_f32_16x16x32_bf16 v[68:71], v[96:99], v[100:103], v[68:71]
    ds_read_b64_tr_b16 v[86:87], v145 offset:8704
    s_waitcnt lgkmcnt(3)
    v_mfma_f32_16x16x32_bf16 v[44:47], v[80:83], v[32:35], v[44:47]
    ds_read_b64_tr_b16 v[92:93], v144 offset:12288
    v_mfma_f32_16x16x32_bf16 v[56:59], v[80:83], a[136:139], v[56:59]
    ds_read_b64_tr_b16 v[94:95], v144 offset:12800
    s_waitcnt lgkmcnt(4)
    v_mfma_f32_16x16x32_bf16 v[60:63], v[80:83], v[88:91], v[60:63]
    ds_read_b128 v[100:103], v141 offset:8192
    s_waitcnt lgkmcnt(3)
    v_mfma_f32_16x16x32_bf16 v[64:67], v[84:87], a[136:139], v[64:67]
    ds_read_b64_tr_b16 v[96:97], v145 offset:12288
    v_mfma_f32_16x16x32_bf16 v[68:71], v[84:87], v[88:91], v[68:71]
    ds_read_b64_tr_b16 v[98:99], v145 offset:12800
    s_waitcnt vmcnt(7)
    s_barrier
    s_waitcnt lgkmcnt(3)
    v_mfma_f32_16x16x32_bf16 v[44:47], v[92:95], v[32:35], v[44:47]
    s_mul_i32 s35, s72, 73728
    s_add_u32 m0, s11, 0
    s_add_u32 s35, s35, s73
    ds_read_b64_tr_b16 v[80:81], v144 offset:16384
    v_mfma_f32_16x16x32_bf16 v[56:59], v[92:95], a[140:143], v[56:59]
    buffer_load_dwordx4 v123, s[28:31], s35 offen lds
    ds_read_b64_tr_b16 v[82:83], v144 offset:16896
    s_waitcnt lgkmcnt(4)
    v_mfma_f32_16x16x32_bf16 v[60:63], v[92:95], v[100:103], v[60:63]
    buffer_load_dwordx4 v124, s[28:31], s35 offen offset:1024 lds
    ds_read_b128 v[88:91], v140 offset:16384
    s_waitcnt lgkmcnt(3)
    v_mfma_f32_16x16x32_bf16 v[64:67], v[96:99], a[140:143], v[64:67]
    s_add_u32 s72, s72, 1
    s_cmp_eq_u32 s72, 9
    s_cselect_b32 s72, 0, s72
    ds_read_b64_tr_b16 v[84:85], v145 offset:16384
    v_mfma_f32_16x16x32_bf16 v[68:71], v[96:99], v[100:103], v[68:71]
    ds_read_b64_tr_b16 v[86:87], v145 offset:16896
    s_waitcnt lgkmcnt(3)
    v_mfma_f32_16x16x32_bf16 v[44:47], v[80:83], v[32:35], v[44:47]
    ds_read_b64_tr_b16 v[92:93], v144 offset:20480
    v_mfma_f32_16x16x32_bf16 v[56:59], v[80:83], a[144:147], v[56:59]
    ds_read_b64_tr_b16 v[94:95], v144 offset:20992
    s_waitcnt lgkmcnt(4)
    v_mfma_f32_16x16x32_bf16 v[60:63], v[80:83], v[88:91], v[60:63]
    ds_read_b128 v[100:103], v141 offset:16384
    s_waitcnt lgkmcnt(3)
    v_mfma_f32_16x16x32_bf16 v[64:67], v[84:87], a[144:147], v[64:67]
    ds_read_b64_tr_b16 v[96:97], v145 offset:20480
    v_mfma_f32_16x16x32_bf16 v[68:71], v[84:87], v[88:91], v[68:71]
    ds_read_b64_tr_b16 v[98:99], v145 offset:20992
    s_waitcnt vmcnt(7)
    s_barrier
    s_waitcnt lgkmcnt(3)
    v_mfma_f32_16x16x32_bf16 v[44:47], v[92:95], v[32:35], v[44:47]
    s_mul_i32 s35, s72, 73728
    s_add_u32 m0, s11, 8192
    s_add_u32 s35, s35, s73
    ds_read_b64_tr_b16 v[80:81], v144 offset:24576
    v_mfma_f32_16x16x32_bf16 v[56:59], v[92:95], a[148:151], v[56:59]
    buffer_load_dwordx4 v123, s[28:31], s35 offen lds
    ds_read_b64_tr_b16 v[82:83], v144 offset:25088
    s_waitcnt lgkmcnt(4)
    v_mfma_f32_16x16x32_bf16 v[60:63], v[92:95], v[100:103], v[60:63]
    buffer_load_dwordx4 v124, s[28:31], s35 offen offset:1024 lds
    ds_read_b128 v[88:91], v140 offset:24576
    s_waitcnt lgkmcnt(3)
    v_mfma_f32_16x16x32_bf16 v[64:67], v[96:99], a[148:151], v[64:67]
    s_add_u32 s72, s72, 1
    s_cmp_eq_u32 s72, 9
    s_cselect_b32 s72, 0, s72
    ds_read_b64_tr_b16 v[84:85], v145 offset:24576
    v_mfma_f32_16x16x32_bf16 v[68:71], v[96:99], v[100:103], v[68:71]
    ds_read_b64_tr_b16 v[86:87], v145 offset:25088
    s_waitcnt lgkmcnt(3)
    v_mfma_f32_16x16x32_bf16 v[44:47], v[80:83], v[32:35], v[44:47]
    ds_read_b64_tr_b16 v[92:93], v144 offset:28672
    v_mfma_f32_16x16x32_bf16 v[56:59], v[80:83], a[152:155], v[56:59]
    ds_read_b64_tr_b16 v[94:95], v144 offset:29184
    s_waitcnt lgkmcnt(4)
    v_mfma_f32_16x16x32_bf16 v[60:63], v[80:83], v[88:91], v[60:63]
    ds_read_b128 v[100:103], v141 offset:24576
    s_waitcnt lgkmcnt(3)
    v_mfma_f32_16x16x32_bf16 v[64:67], v[84:87], a[152:155], v[64:67]
    ds_read_b64_tr_b16 v[96:97], v145 offset:28672
    v_mfma_f32_16x16x32_bf16 v[68:71], v[84:87], v[88:91], v[68:71]
    ds_read_b64_tr_b16 v[98:99], v145 offset:29184
    s_waitcnt vmcnt(6)
    s_barrier
    s_waitcnt lgkmcnt(3)
    v_mfma_f32_16x16x32_bf16 v[44:47], v[92:95], v[32:35], v[44:47]
    s_mul_i32 s35, s72, 73728
    s_add_u32 m0, s11, 16384
    s_add_u32 s35, s35, s73
    ds_read_b64_tr_b16 v[80:81], v144 offset:32768
    v_mfma_f32_16x16x32_bf16 v[56:59], v[92:95], a[156:159], v[56:59]
    buffer_load_dwordx4 v123, s[28:31], s35 offen lds
    ds_read_b64_tr_b16 v[82:83], v144 offset:33280
    s_waitcnt lgkmcnt(4)
    v_mfma_f32_16x16x32_bf16 v[60:63], v[92:95], v[100:103], v[60:63]
    buffer_load_dwordx4 v124, s[28:31], s35 offen offset:1024 lds
    ds_read_b128 v[88:91], v140 offset:32768
    s_waitcnt lgkmcnt(3)
    v_mfma_f32_16x16x32_bf16 v[64:67], v[96:99], a[156:159], v[64:67]
    s_add_u32 s72, s72, 1
    s_cmp_eq_u32 s72, 9
L_pad1:
    s_cbranch_execz L_pad5
    s_cselect_b32 s72, 0, s72
    ds_read_b64_tr_b16 v[84:85], v145 offset:32768
    v_mfma_f32_16x16x32_bf16 v[68:71], v[96:99], v[100:103], v[68:71]
    ds_read_b64_tr_b16 v[86:87], v145 offset:33280
    s_waitcnt lgkmcnt(3)
    v_mfma_f32_16x16x32_bf16 v[44:47], v[80:83], v[32:35], v[44:47]
    ds_read_b64_tr_b16 v[92:93], v144 offset:36864
    v_mfma_f32_16x16x32_bf16 v[56:59], v[80:83], a[160:163], v[56:59]
    ds_read_b64_tr_b16 v[94:95], v144 offset:37376
    s_waitcnt lgkmcnt(4)
    v_mfma_f32_16x16x32_bf16 v[60:63], v[80:83], v[88:91], v[60:63]
    ds_read_b128 v[100:103], v141 offset:32768
    s_waitcnt lgkmcnt(3)
    v_mfma_f32_16x16x32_bf16 v[64:67], v[84:87], a[160:163], v[64:67]
    ds_read_b64_tr_b16 v[96:97], v145 offset:36864
    v_mfma_f32_16x16x32_bf16 v[68:71], v[84:87], v[88:91], v[68:71]
    ds_read_b64_tr_b16 v[98:99], v145 offset:37376
    s_waitcnt vmcnt(6)
    s_barrier
    s_waitcnt lgkmcnt(3)
    v_mfma_f32_16x16x32_bf16 v[44:47], v[92:95], v[32:35], v[44:47]
    ds_read_b64_tr_b16 v[80:81], v144 offset:40960
    v_mfma_f32_16x16x32_bf16 v[56:59], v[92:95], a[164:167], v[56:59]
    ds_read_b64_tr_b16 v[82:83], v144 offset:41472
    s_waitcnt lgkmcnt(4)
    v_mfma_f32_16x16x32_bf16 v[60:63], v[92:95], v[100:103], v[60:63]
    ds_read_b128 v[88:91], v140 offset:40960
    s_waitcnt lgkmcnt(3)
    v_mfma_f32_16x16x32_bf16 v[64:67], v[96:99], a[164:167], v[64:67]
    ds_read_b64_tr_b16 v[84:85], v145 offset:40960
    v_mfma_f32_16x16x32_bf16 v[68:71], v[96:99], v[100:103], v[68:71]
    ds_read_b64_tr_b16 v[86:87], v145 offset:41472
    s_waitcnt lgkmcnt(3)
    v_mfma_f32_16x16x32_bf16 v[44:47], v[80:83], v[32:35], v[44:47]
    ds_read_b64_tr_b16 v[92:93], v144 offset:45056
    v_mfma_f32_16x16x32_bf16 v[56:59], v[80:83], a[168:171], v[56:59]
    ds_read_b64_tr_b16 v[94:95], v144 offset:45568
    s_waitcnt lgkmcnt(4)
    v_mfma_f32_16x16x32_bf16 v[60:63], v[80:83], v[88:91], v[60:63]
    ds_read_b128 v[100:103], v141 offset:40960
    s_waitcnt lgkmcnt(3)
    v_mfma_f32_16x16x32_bf16 v[64:67], v[84:87], a[168:171], v[64:67]
    ds_read_b64_tr_b16 v[96:97], v145 offset:45056
    v_mfma_f32_16x16x32_bf16 v[68:71], v[84:87], v[88:91], v[68:71]
    ds_read_b64_tr_b16 v[98:99], v145 offset:45568
    s_waitcnt vmcnt(4)
    s_barrier
    s_waitcnt lgkmcnt(3)
    v_mfma_f32_16x16x32_bf16 v[44:47], v[92:95], v[32:35], v[44:47]
    buffer_load_dword v130, v131, s[16:19], 0 offen sc1
    ds_read_b64_tr_b16 v[80:81], v144 offset:0
    v_mfma_f32_16x16x32_bf16 v[56:59], v[92:95], a[172:175], v[56:59]
    buffer_load_dword v132, v133, s[16:19], 0 offen sc1
    ds_read_b64_tr_b16 v[82:83], v144 offset:512
    s_waitcnt lgkmcnt(4)
    v_mfma_f32_16x16x32_bf16 v[60:63], v[92:95], v[100:103], v[60:63]
    ds_read_b128 v[88:91], v140 offset:49152
    s_waitcnt lgkmcnt(3)
    v_mfma_f32_16x16x32_bf16 v[64:67], v[96:99], a[172:175], v[64:67]
    ds_read_b64_tr_b16 v[84:85], v145 offset:0
    v_mfma_f32_16x16x32_bf16 v[68:71], v[96:99], v[100:103], v[68:71]
    ds_read_b64_tr_b16 v[86:87], v145 offset:512
    s_waitcnt lgkmcnt(3)
    v_mfma_f32_16x16x32_bf16 v[44:47], v[80:83], v[32:35], v[44:47]
    ds_read_b64_tr_b16 v[92:93], v144 offset:4096
    v_mfma_f32_16x16x32_bf16 v[56:59], v[80:83], a[176:179], v[56:59]
    ds_read_b64_tr_b16 v[94:95], v144 offset:4608
    s_waitcnt lgkmcnt(4)
    v_mfma_f32_16x16x32_bf16 v[60:63], v[80:83], v[88:91], v[60:63]
    ds_read_b128 v[100:103], v141 offset:49152
    s_waitcnt lgkmcnt(3)
    v_mfma_f32_16x16x32_bf16 v[64:67], v[84:87], a[176:179], v[64:67]
    ds_read_b64_tr_b16 v[96:97], v145 offset:4096
    v_mfma_f32_16x16x32_bf16 v[68:71], v[84:87], v[88:91], v[68:71]
    ds_read_b64_tr_b16 v[98:99], v145 offset:4608
    s_waitcnt vmcnt(4)
    s_barrier
    s_waitcnt lgkmcnt(3)
    v_mfma_f32_16x16x32_bf16 v[44:47], v[92:95], v[32:35], v[44:47]
    ds_read_b64_tr_b16 v[80:81], v144 offset:8192
    v_mfma_f32_16x16x32_bf16 v[56:59], v[92:95], a[180:183], v[56:59]
    ds_read_b64_tr_b16 v[82:83], v144 offset:8704
    s_waitcnt lgkmcnt(4)
    v_mfma_f32_16x16x32_bf16 v[60:63], v[92:95], v[100:103], v[60:63]
    ds_read_b128 v[88:91], v146 offset:0
    s_waitcnt lgkmcnt(3)
    v_mfma_f32_16x16x32_bf16 v[64:67], v[96:99], a[180:183], v[64:67]
    ds_read_b64_tr_b16 v[84:85], v145 offset:8192
    v_mfma_f32_16x16x32_bf16 v[68:71], v[96:99], v[100:103], v[68:71]
    ds_read_b64_tr_b16 v[86:87], v145 offset:8704
    s_waitcnt lgkmcnt(3)
    v_mfma_f32_16x16x32_bf16 v[44:47], v[80:83], v[32:35], v[44:47]
    ds_read_b64_tr_b16 v[92:93], v144 offset:12288
    v_mfma_f32_16x16x32_bf16 v[56:59], v[80:83], a[184:187], v[56:59]
    ds_read_b64_tr_b16 v[94:95], v144 offset:12800
    s_waitcnt lgkmcnt(4)
    v_mfma_f32_16x16x32_bf16 v[60:63], v[80:83], v[88:91], v[60:63]
    ds_read_b128 v[100:103], v147 offset:0
    s_waitcnt lgkmcnt(3)
    v_mfma_f32_16x16x32_bf16 v[64:67], v[84:87], a[184:187], v[64:67]
    ds_read_b64_tr_b16 v[96:97], v145 offset:12288
    v_mfma_f32_16x16x32_bf16 v[68:71], v[84:87], v[88:91], v[68:71]
    ds_read_b64_tr_b16 v[98:99], v145 offset:12800
    s_waitcnt vmcnt(2)
    s_barrier
    s_waitcnt vmcnt(0)
    v_cmp_eq_u32 vcc, 0, v132
    s_cbranch_vccz L_set_kvq
    s_mov_b32 s40, 0
L_spin_kvq:
    s_sleep 2
    s_mov_b64 exec, vcc
    buffer_load_dword v132, v133, s[16:19], 0 offen sc1
    s_mov_b64 exec, -1
    s_waitcnt vmcnt(0)
    v_cmp_eq_u32 vcc, 0, v132
    s_cbranch_vccz L_set_kvq
    s_add_u32 s40, s40, 1
    s_cmp_lt_u32 s40, 200000
    s_cbranch_scc1 L_spin_kvq
L_set_kvq:
    v_cmp_eq_u32 vcc, 0, v130
    s_cbranch_vccz L_set_cfq
    s_mov_b32 s40, 0
L_spin_cfq:
    s_sleep 2
    s_mov_b64 exec, vcc
    buffer_load_dword v130, v131, s[16:19], 0 offen sc1
    s_mov_b64 exec, -1
    s_waitcnt vmcnt(0)
    v_cmp_eq_u32 vcc, 0, v130
    s_cbranch_vccz L_set_cfq
    s_add_u32 s40, s40, 1
    s_cmp_lt_u32 s40, 200000
    s_cbranch_scc1 L_spin_cfq
L_set_cfq:
    s_waitcnt lgkmcnt(3)
    v_mfma_f32_16x16x32_bf16 v[44:47], v[92:95], v[32:35], v[44:47]
    buffer_load_dwordx4 v[112:115], v227, s[16:19], s5 offen sc1
    ds_read_b64_tr_b16 v[80:81], v144 offset:16384
    v_mfma_f32_16x16x32_bf16 v[56:59], v[92:95], a[188:191], v[56:59]
    buffer_load_dwordx4 a[64:67], v139, s[52:55], 0 offen sc1
    ds_read_b64_tr_b16 v[82:83], v144 offset:16896
    s_waitcnt lgkmcnt(4)
    v_mfma_f32_16x16x32_bf16 v[60:63], v[92:95], v[100:103], v[60:63]
    buffer_load_dwordx4 a[0:3], v138, s[52:55], 0 offen offset:0 sc1
    ds_read_b128 v[88:91], v146 offset:8192
    s_waitcnt lgkmcnt(3)
    v_mfma_f32_16x16x32_bf16 v[64:67], v[96:99], a[188:191], v[64:67]
    buffer_load_dwordx4 a[4:7], v138, s[52:55], 0 offen offset:1024 sc1
    ds_read_b64_tr_b16 v[84:85], v145 offset:16384
    v_mfma_f32_16x16x32_bf16 v[68:71], v[96:99], v[100:103], v[68:71]
    buffer_load_dwordx4 a[80:83], v136, s[52:55], 0 offen offset:0 sc1
    ds_read_b64_tr_b16 v[86:87], v145 offset:16896
    s_waitcnt lgkmcnt(3)
    v_mfma_f32_16x16x32_bf16 v[44:47], v[80:83], v[32:35], v[44:47]
    buffer_load_dwordx4 a[84:87], v136, s[52:55], 0 offen offset:640 sc1
    ds_read_b64_tr_b16 v[92:93], v144 offset:20480
    v_mfma_f32_16x16x32_bf16 v[56:59], v[80:83], a[192:195], v[56:59]
    buffer_load_dwordx4 a[8:11], v138, s[52:55], 0 offen offset:2048 sc1
    ds_read_b64_tr_b16 v[94:95], v144 offset:20992
    s_waitcnt lgkmcnt(4)
    v_mfma_f32_16x16x32_bf16 v[60:63], v[80:83], v[88:91], v[60:63]
    buffer_load_dwordx4 a[88:91], v136, s[52:55], 0 offen offset:1280 sc1
    ds_read_b128 v[100:103], v147 offset:8192
    s_waitcnt lgkmcnt(3)
    v_mfma_f32_16x16x32_bf16 v[64:67], v[84:87], a[192:195], v[64:67]
    buffer_load_dwordx4 a[92:95], v136, s[52:55], 0 offen offset:1920 sc1
    ds_read_b64_tr_b16 v[96:97], v145 offset:20480
    v_mfma_f32_16x16x32_bf16 v[68:71], v[84:87], v[88:91], v[68:71]
    ds_read_b64_tr_b16 v[98:99], v145 offset:20992
    s_waitcnt lgkmcnt(3)
    v_mfma_f32_16x16x32_bf16 v[44:47], v[92:95], v[32:35], v[44:47]
    v_mfma_f32_16x16x32_bf16 v[56:59], v[92:95], a[196:199], v[56:59]
    s_waitcnt lgkmcnt(2)
    v_mfma_f32_16x16x32_bf16 v[60:63], v[92:95], v[100:103], v[60:63]
    s_waitcnt lgkmcnt(0)
    v_mfma_f32_16x16x32_bf16 v[64:67], v[96:99], a[196:199], v[64:67]
    v_mfma_f32_16x16x32_bf16 v[68:71], v[96:99], v[100:103], v[68:71]
    ds_read_b64 v[168:169], v164 offset:4096
    s_nop 2
    ds_write_b128 v161, v[44:47]
    s_waitcnt lgkmcnt(1)
    v_pk_fma_f32 v[56:57], v[44:45], v[166:167], v[56:57] op_sel_hi:[1,0,1] neg_lo:[1,0,0] neg_hi:[1,0,0]
    v_pk_fma_f32 v[58:59], v[46:47], v[166:167], v[58:59] op_sel_hi:[1,0,1] neg_lo:[1,0,0] neg_hi:[1,0,0]
    v_pk_fma_f32 v[60:61], v[44:45], v[168:169], v[60:61] op_sel_hi:[1,0,1] neg_lo:[1,0,0] neg_hi:[1,0,0]
    v_pk_fma_f32 v[62:63], v[46:47], v[168:169], v[62:63] op_sel_hi:[1,0,1] neg_lo:[1,0,0] neg_hi:[1,0,0]
    v_pk_mul_f32 v[56:57], v[56:57], v[166:167] op_sel:[0,1] op_sel_hi:[1,1]
    v_pk_mul_f32 v[58:59], v[58:59], v[166:167] op_sel:[0,1] op_sel_hi:[1,1]
    v_pk_mul_f32 v[60:61], v[60:61], v[168:169] op_sel:[0,1] op_sel_hi:[1,1]
    v_pk_mul_f32 v[62:63], v[62:63], v[168:169] op_sel:[0,1] op_sel_hi:[1,1]
    s_waitcnt lgkmcnt(0)
    s_barrier
    ds_read_b128 v[48:51], v162
    v_cvt_pk_bf16_f32 v104, v56, v57
    v_cvt_pk_bf16_f32 v106, v60, v61
    v_cvt_pk_bf16_f32 v105, v58, v59
    v_cvt_pk_bf16_f32 v107, v62, v63
    v_permlane16_swap_b32 v104, v106
    s_nop 0
    v_permlane16_swap_b32 v105, v107
    s_waitcnt lgkmcnt(0)
    v_pk_fma_f32 v[64:65], v[48:49], v[166:167], v[64:65] op_sel_hi:[1,0,1] neg_lo:[1,0,0] neg_hi:[1,0,0]
    v_pk_fma_f32 v[66:67], v[50:51], v[166:167], v[66:67] op_sel_hi:[1,0,1] neg_lo:[1,0,0] neg_hi:[1,0,0]
    v_pk_fma_f32 v[68:69], v[48:49], v[168:169], v[68:69] op_sel_hi:[1,0,1] neg_lo:[1,0,0] neg_hi:[1,0,0]
    v_pk_fma_f32 v[70:71], v[50:51], v[168:169], v[70:71] op_sel_hi:[1,0,1] neg_lo:[1,0,0] neg_hi:[1,0,0]
    v_pk_mul_f32 v[64:65], v[64:65], v[166:167] op_sel:[0,1] op_sel_hi:[1,1]
    v_pk_mul_f32 v[66:67], v[66:67], v[166:167] op_sel:[0,1] op_sel_hi:[1,1]
    v_pk_mul_f32 v[68:69], v[68:69], v[168:169] op_sel:[0,1] op_sel_hi:[1,1]
    v_pk_mul_f32 v[70:71], v[70:71], v[168:169] op_sel:[0,1] op_sel_hi:[1,1]
    v_cvt_pk_bf16_f32 v108, v64, v65
    v_cvt_pk_bf16_f32 v110, v68, v69
    v_cvt_pk_bf16_f32 v109, v66, v67
    v_cvt_pk_bf16_f32 v111, v70, v71
    v_permlane16_swap_b32 v108, v110
    s_nop 0
    v_permlane16_swap_b32 v109, v111
    s_branch L_join
L_pa_kv2:
    s_cmp_ge_u32 s2, 194
    s_cbranch_scc1 L_pa_nogo
    s_lshl_b32 s64, s64, 5
    v_mov_b32 v18, 1
    s_waitcnt vmcnt(9)
    s_mov_b64 exec, 1
    buffer_store_dword v18, off, s[24:27], s64 sc1
    s_mov_b64 exec, -1
L_pa_nogo:
    s_lshl_b32 s50, s42, 7
    s_mul_i32 s51, s42, 2304
    s_add_u32 s50, s50, s37
    s_add_u32 s51, s51, s43
    s_add_u32 s42, s42, 1
    s_cmp_eq_u32 s42, 9
    s_cselect_b32 s42, 0, s42
    s_lshl_b32 s52, s42, 7
    s_mul_i32 s53, s42, 2304
    s_add_u32 s52, s52, s37
    s_add_u32 s53, s53, s43
    s_add_u32 s42, s42, 1
    s_cmp_eq_u32 s42, 9
    s_cselect_b32 s42, 0, s42
    s_lshl_b32 s54, s42, 7
    s_mul_i32 s55, s42, 2304
    s_add_u32 s54, s54, s37
    s_add_u32 s55, s55, s43
    s_add_u32 s42, s42, 1
    s_cmp_eq_u32 s42, 9
    s_cselect_b32 s42, 0, s42
    s_lshl_b32 s56, s42, 7
    s_mul_i32 s57, s42, 2304
    s_add_u32 s56, s56, s37
    s_add_u32 s57, s57, s43
    s_add_u32 s42, s42, 1
    s_cmp_eq_u32 s42, 9
    s_cselect_b32 s42, 0, s42
    s_lshl_b32 s58, s42, 7
    s_mul_i32 s59, s42, 2304
    s_add_u32 s58, s58, s37
    s_add_u32 s59, s59, s43
    s_add_u32 s42, s42, 1
    s_cmp_eq_u32 s42, 9
    s_cselect_b32 s42, 0, s42
    s_lshl_b32 s64, s42, 7
    s_mul_i32 s65, s42, 2304
    s_add_u32 s64, s64, s37
    s_add_u32 s65, s65, s43
    s_lshl_b32 s67, s32, 6
    s_add_u32 s67, s67, s39
    s_min_u32 s4, s67, 161
    s_mul_i32 s5, s4, 7282
    s_lshr_b32 s5, s5, 16
    s_mul_i32 s6, s5, 9
    s_sub_u32 s6, s4, s6
    s_lshr_b32 s7, s5, 1
    s_and_b32 s8, s5, 1
    s_mul_i32 s14, s7, 72
    s_lshl_b32 s9, s8, 3
    s_add_u32 s14, s14, s9
    s_add_u32 s9, s8, 16
    s_cmp_eq_u32 s7, 8
    s_cselect_b32 s14, s9, s14
    s_cselect_b32 s9, 72, 1
    s_mul_i32 s9, s9, 1152
    s_mul_i32 s14, s14, 1152
    s_lshl_b32 s10, s6, 7
    s_add_u32 s14, s14, s10
    v_mul_u32_u24 v18, s9, v22
    v_lshl_add_u32 v124, v23, 4, v18
    s_lshl_b32 s15, s32, 12
    s_add_u32 s15, s15, 110592
    s_cmp_lt_u32 s67, 162
    s_cselect_b32 s70, 663552, 0
    v_lshrrev_b32 v18, 1, v16
    v_xor_b32 v18, v18, v17
    v_lshlrev_b32 v18, 4, v18
    v_lshl_add_u32 v18, v16, 7, v18
    s_lshl_b32 s40, s36, 11
    v_add_u32 v140, s40, v18
    v_xor_b32 v141, 64, v140
    v_lshrrev_b32 v20, 2, v16
    v_lshl_add_u32 v18, v17, 3, v20
    v_lshlrev_b32 v18, 6, v18
    v_and_b32 v19, 3, v16
    v_lshl_add_u32 v18, v19, 3, v18
    v_and_b32 v21, 1, v17
    v_lshl_add_u32 v18, v21, 5, v18
    s_mul_i32 s40, s35, 36864
    s_add_u32 s40, s40, 36864
    v_add_u32 v146, s40, v18
    v_xor_b32 v147, 32, v146
    v_and_b32 v18, 2, v17
    v_lshrrev_b32 v21, 1, v20
    v_add_u32 v18, v18, v21
    v_lshlrev_b32 v18, 10, v18
    v_and_b32 v21, 1, v17
    v_lshl_add_u32 v18, v21, 9, v18
    v_and_b32 v21, 1, v20
    v_lshl_add_u32 v18, v21, 7, v18
    v_add_u32 v18, s15, v18
    s_cmp_eq_u32 s6, 8
    s_cselect_b32 s40, 3, 4
    s_cselect_b32 s41, 32, 8
    v_lshl_add_u32 v143, v19, s40, v18
    v_add_u32 v144, s41, v143
    s_cselect_b32 s40, 4, 11
    s_cselect_b32 s41, 8, 4
    v_lshlrev_b32 v18, 6, v17
    v_lshl_add_u32 v18, v19, s40, v18
    v_lshl_add_u32 v18, v20, s41, v18
    s_cselect_b32 s9, 9, 4
    s_cselect_b32 s10, 144, 1
    s_lshr_b32 s40, s6, 1
    s_mul_i32 s40, s40, 9
    s_cmp_eq_u32 s6, 8
    s_cselect_b32 s40, 8, s40
    s_mul_i32 s41, s7, 36
    s_add_u32 s40, s40, s41
    s_lshl_b32 s40, s40, 1
    s_add_u32 s40, s40, s8
    s_lshl_b32 s40, s40, 1
    s_and_b32 s41, s6, 1
    s_add_u32 s40, s40, s41
    s_lshl_b32 s40, s40, 9
    s_add_u32 s60, s40, 2527232
    s_lshl_b32 s9, s9, 11
    s_lshl_b32 s10, s10, 8
    s_add_u32 s61, s60, s9
    s_add_u32 s62, s60, s10
    s_add_u32 s63, s61, s10
    s_cmp_lt_u32 s67, 162
    s_cselect_b32 s40, 0, 2130706432
    v_add_u32 v145, s40, v18
    s_lshl_b32 s40, s39, 5
    s_add_u32 s40, s40, 8962048
    s_lshl_b32 s41, s32, 6
    v_or_b32 v19, s41, v0
    v_cmp_gt_u32 vcc, 8, v19
    v_mov_b32 v18, 2130706432
    v_lshl_add_u32 v19, v0, 11, s40
    v_cndmask_b32 v127, v18, v19, vcc
    s_lshl_b32 s40, s39, 4
    s_add_u32 s40, s40, 8982528
    v_lshl_add_u32 v19, v0, 10, s40
    v_cndmask_b32 v134, v18, v19, vcc
    v_mov_b32 v25, -1
    v_lshlrev_b32 v24, 13, v22
    v_lshl_add_u32 v24, v23, 2, v24
    s_lshl_b32 s11, s38, 5
    s_add_u32 s11, s11, 5550080
    s_lshl_b32 s40, s33, 11
    s_add_u32 s40, s40, 8962048
    v_lshl_add_u32 v133, v0, 5, s40
    v_and_b32 v18, 7, v0
    v_lshlrev_b32 v129, 5, v18
    s_lshl_b32 s40, s33, 2
    s_lshr_b32 s41, s2, 6
    s_add_u32 s40, s40, s41
    s_lshl_b32 s40, s40, 7
    s_add_u32 s40, s40, 8978432
    v_min_u32 v18, 5, v0
    v_lshl_add_u32 v131, v18, 4, s40
    v_and_b32 v18, 3, v16
    v_lshrrev_b32 v19, 2, v16
    v_cmp_eq_u32 s[44:45], 1, v18
    v_cmp_eq_u32 s[46:47], 2, v18
    v_cmp_eq_u32 s[48:49], 3, v18
    v_cmp_eq_u32 s[72:73], v17, v19
    v_mov_b32 v32, 0x3f803f80
    v_mov_b32 v33, 0x3f803f80
    v_mov_b32 v34, 0x3f803f80
    v_mov_b32 v35, 0x3f803f80
    s_mov_b32 s75, 1
    s_mov_b64 exec, 0
    s_cmp_eq_u32 s32, 0
    s_cbranch_scc1 L_pad0
    s_cmp_eq_u32 s32, 1
    s_cbranch_scc1 L_pad1
    s_cmp_eq_u32 s32, 2
    s_cbranch_scc1 L_pad2
    s_branch L_pad3
L_warm_kv:
    s_mov_b64 exec, -1
    s_waitcnt vmcnt(6)
    s_barrier
    s_lshl_b32 s38, s39, 1
    s_add_u32 s38, s38, s36
    s_cmp_eq_u32 s35, 1
    s_cbranch_scc1 L_pa_v
    ds_read_b128 v[80:83], v140 offset:0
    ds_read_b64_tr_b16 v[84:85], v146 offset:0
    ds_read_b64_tr_b16 v[86:87], v146 offset:256
    ds_read_b64_tr_b16 v[88:89], v147 offset:0
    ds_read_b64_tr_b16 v[90:91], v147 offset:256
    s_add_u32 m0, s12, 12288
    s_nop 0
    buffer_load_dwordx4 v120, s[20:23], s50 offen lds
    s_add_u32 m0, s13, 12288
    s_nop 0
    buffer_load_dwordx4 v121, s[28:31], s51 offen offset:0 lds
    buffer_load_dwordx4 v122, s[28:31], s51 offen offset:1024 lds
    s_waitcnt lgkmcnt(4)
    v_mfma_f32_16x16x32_bf16 v[36:39], v[32:35], v[80:83], 0
    ds_read_b128 v[92:95], v141 offset:0
    v_mfma_f32_16x16x32_bf16 v[40:43], v[80:83], v[80:83], 0
    ds_read_b64_tr_b16 v[96:97], v146 offset:2048
    s_waitcnt lgkmcnt(4)
    v_mfma_f32_16x16x32_bf16 v[44:47], v[84:87], v[32:35], 0
    ds_read_b64_tr_b16 v[98:99], v146 offset:2304
    v_mfma_f32_16x16x32_bf16 v[56:59], v[84:87], v[80:83], 0
    ds_read_b64_tr_b16 v[100:101], v147 offset:2048
    s_waitcnt lgkmcnt(4)
    v_mfma_f32_16x16x32_bf16 v[48:51], v[88:91], v[32:35], 0
    ds_read_b64_tr_b16 v[102:103], v147 offset:2304
    v_mfma_f32_16x16x32_bf16 v[60:63], v[88:91], v[80:83], 0
    s_waitcnt vmcnt(6)
    s_barrier
    s_waitcnt lgkmcnt(4)
    v_mfma_f32_16x16x32_bf16 v[36:39], v[32:35], v[92:95], v[36:39]
    s_add_u32 m0, s12, 16384
    ds_read_b128 v[80:83], v140 offset:4096
    v_mfma_f32_16x16x32_bf16 v[40:43], v[92:95], v[92:95], v[40:43]
    buffer_load_dwordx4 v120, s[20:23], s52 offen lds
    ds_read_b64_tr_b16 v[84:85], v146 offset:4096
    s_waitcnt lgkmcnt(4)
    v_mfma_f32_16x16x32_bf16 v[44:47], v[96:99], v[32:35], v[44:47]
    s_add_u32 m0, s13, 16384
    ds_read_b64_tr_b16 v[86:87], v146 offset:4352
    v_mfma_f32_16x16x32_bf16 v[56:59], v[96:99], v[92:95], v[56:59]
    buffer_load_dwordx4 v121, s[28:31], s53 offen offset:0 lds
    ds_read_b64_tr_b16 v[88:89], v147 offset:4096
    s_waitcnt lgkmcnt(4)
    v_mfma_f32_16x16x32_bf16 v[48:51], v[100:103], v[32:35], v[48:51]
    buffer_load_dwordx4 v122, s[28:31], s53 offen offset:1024 lds
    ds_read_b64_tr_b16 v[90:91], v147 offset:4352
    v_mfma_f32_16x16x32_bf16 v[60:63], v[100:103], v[92:95], v[60:63]
    s_waitcnt lgkmcnt(4)
    v_mfma_f32_16x16x32_bf16 v[36:39], v[32:35], v[80:83], v[36:39]
    ds_read_b128 v[92:95], v141 offset:4096
    v_mfma_f32_16x16x32_bf16 v[40:43], v[80:83], v[80:83], v[40:43]
    ds_read_b64_tr_b16 v[96:97], v146 offset:6144
    s_waitcnt lgkmcnt(4)
    v_mfma_f32_16x16x32_bf16 v[44:47], v[84:87], v[32:35], v[44:47]
    ds_read_b64_tr_b16 v[98:99], v146 offset:6400
    v_mfma_f32_16x16x32_bf16 v[56:59], v[84:87], v[80:83], v[56:59]
    ds_read_b64_tr_b16 v[100:101], v147 offset:6144
    s_waitcnt lgkmcnt(4)
    v_mfma_f32_16x16x32_bf16 v[48:51], v[88:91], v[32:35], v[48:51]
    ds_read_b64_tr_b16 v[102:103], v147 offset:6400
    v_mfma_f32_16x16x32_bf16 v[60:63], v[88:91], v[80:83], v[60:63]
    s_waitcnt vmcnt(6)
    s_barrier
    s_waitcnt lgkmcnt(4)
    v_mfma_f32_16x16x32_bf16 v[36:39], v[32:35], v[92:95], v[36:39]
    s_add_u32 m0, s12, 20480
    ds_read_b128 v[80:83], v140 offset:8192
    v_mfma_f32_16x16x32_bf16 v[40:43], v[92:95], v[92:95], v[40:43]
    buffer_load_dwordx4 v120, s[20:23], s54 offen lds
    ds_read_b64_tr_b16 v[84:85], v146 offset:8192
    s_waitcnt lgkmcnt(4)
    v_mfma_f32_16x16x32_bf16 v[44:47], v[96:99], v[32:35], v[44:47]
    s_add_u32 m0, s13, 20480
    ds_read_b64_tr_b16 v[86:87], v146 offset:8448
    v_mfma_f32_16x16x32_bf16 v[56:59], v[96:99], v[92:95], v[56:59]
    buffer_load_dwordx4 v121, s[28:31], s55 offen offset:0 lds
    ds_read_b64_tr_b16 v[88:89], v147 offset:8192
    s_waitcnt lgkmcnt(4)
    v_mfma_f32_16x16x32_bf16 v[48:51], v[100:103], v[32:35], v[48:51]
    buffer_load_dwordx4 v122, s[28:31], s55 offen offset:1024 lds
    ds_read_b64_tr_b16 v[90:91], v147 offset:8448
    v_mfma_f32_16x16x32_bf16 v[60:63], v[100:103], v[92:95], v[60:63]
    s_waitcnt lgkmcnt(4)
    v_mfma_f32_16x16x32_bf16 v[36:39], v[32:35], v[80:83], v[36:39]
    ds_read_b128 v[92:95], v141 offset:8192
    v_mfma_f32_16x16x32_bf16 v[40:43], v[80:83], v[80:83], v[40:43]
    ds_read_b64_tr_b16 v[96:97], v146 offset:10240
    s_waitcnt lgkmcnt(4)
    v_mfma_f32_16x16x32_bf16 v[44:47], v[84:87], v[32:35], v[44:47]
    ds_read_b64_tr_b16 v[98:99], v146 offset:10496
    v_mfma_f32_16x16x32_bf16 v[56:59], v[84:87], v[80:83], v[56:59]
    ds_read_b64_tr_b16 v[100:101], v147 offset:10240
    s_waitcnt lgkmcnt(4)
    v_mfma_f32_16x16x32_bf16 v[48:51], v[88:91], v[32:35], v[48:51]
    ds_read_b64_tr_b16 v[102:103], v147 offset:10496
    v_mfma_f32_16x16x32_bf16 v[60:63], v[88:91], v[80:83], v[60:63]
    s_waitcnt vmcnt(6)
    s_barrier
    s_waitcnt lgkmcnt(4)
    v_mfma_f32_16x16x32_bf16 v[36:39], v[32:35], v[92:95], v[36:39]
    s_add_u32 m0, s12, 24576
    ds_read_b128 v[80:83], v140 offset:12288
    v_mfma_f32_16x16x32_bf16 v[40:43], v[92:95], v[92:95], v[40:43]
    buffer_load_dwordx4 v120, s[20:23], s56 offen lds
    ds_read_b64_tr_b16 v[84:85], v146 offset:12288
    s_waitcnt lgkmcnt(4)
    v_mfma_f32_16x16x32_bf16 v[44:47], v[96:99], v[32:35], v[44:47]
    s_add_u32 m0, s13, 24576
    ds_read_b64_tr_b16 v[86:87], v146 offset:12544
    v_mfma_f32_16x16x32_bf16 v[56:59], v[96:99], v[92:95], v[56:59]
    buffer_load_dwordx4 v121, s[28:31], s57 offen offset:0 lds
    ds_read_b64_tr_b16 v[88:89], v147 offset:12288
    s_waitcnt lgkmcnt(4)
    v_mfma_f32_16x16x32_bf16 v[48:51], v[100:103], v[32:35], v[48:51]
    buffer_load_dwordx4 v122, s[28:31], s57 offen offset:1024 lds
    ds_read_b64_tr_b16 v[90:91], v147 offset:12544
    v_mfma_f32_16x16x32_bf16 v[60:63], v[100:103], v[92:95], v[60:63]
    s_waitcnt lgkmcnt(4)
    v_mfma_f32_16x16x32_bf16 v[36:39], v[32:35], v[80:83], v[36:39]
    ds_read_b128 v[92:95], v141 offset:12288
    v_mfma_f32_16x16x32_bf16 v[40:43], v[80:83], v[80:83], v[40:43]
    ds_read_b64_tr_b16 v[96:97], v146 offset:14336
    s_waitcnt lgkmcnt(4)
    v_mfma_f32_16x16x32_bf16 v[44:47], v[84:87], v[32:35], v[44:47]
    ds_read_b64_tr_b16 v[98:99], v146 offset:14592
    v_mfma_f32_16x16x32_bf16 v[56:59], v[84:87], v[80:83], v[56:59]
    ds_read_b64_tr_b16 v[100:101], v147 offset:14336
    s_waitcnt lgkmcnt(4)
    v_mfma_f32_16x16x32_bf16 v[48:51], v[88:91], v[32:35], v[48:51]
    ds_read_b64_tr_b16 v[102:103], v147 offset:14592
    v_mfma_f32_16x16x32_bf16 v[60:63], v[88:91], v[80:83], v[60:63]
    s_waitcnt vmcnt(6)
    s_barrier
    s_waitcnt lgkmcnt(4)
    v_mfma_f32_16x16x32_bf16 v[36:39], v[32:35], v[92:95], v[36:39]
    s_add_u32 m0, s12, 28672
    ds_read_b128 v[80:83], v140 offset:16384
    v_mfma_f32_16x16x32_bf16 v[40:43], v[92:95], v[92:95], v[40:43]
    buffer_load_dwordx4 v120, s[20:23], s58 offen lds
    ds_read_b64_tr_b16 v[84:85], v146 offset:16384
    s_waitcnt lgkmcnt(4)
    v_mfma_f32_16x16x32_bf16 v[44:47], v[96:99], v[32:35], v[44:47]
    s_add_u32 m0, s13, 28672
    ds_read_b64_tr_b16 v[86:87], v146 offset:16640
    v_mfma_f32_16x16x32_bf16 v[56:59], v[96:99], v[92:95], v[56:59]
    buffer_load_dwordx4 v121, s[28:31], s59 offen offset:0 lds
    ds_read_b64_tr_b16 v[88:89], v147 offset:16384
    s_waitcnt lgkmcnt(4)
    v_mfma_f32_16x16x32_bf16 v[48:51], v[100:103], v[32:35], v[48:51]
    buffer_load_dwordx4 v122, s[28:31], s59 offen offset:1024 lds
    ds_read_b64_tr_b16 v[90:91], v147 offset:16640
    v_mfma_f32_16x16x32_bf16 v[60:63], v[100:103], v[92:95], v[60:63]
    s_waitcnt lgkmcnt(4)
    v_mfma_f32_16x16x32_bf16 v[36:39], v[32:35], v[80:83], v[36:39]
    ds_read_b128 v[92:95], v141 offset:16384
    v_mfma_f32_16x16x32_bf16 v[40:43], v[80:83], v[80:83], v[40:43]
    ds_read_b64_tr_b16 v[96:97], v146 offset:18432
    s_waitcnt lgkmcnt(4)
    v_mfma_f32_16x16x32_bf16 v[44:47], v[84:87], v[32:35], v[44:47]
    ds_read_b64_tr_b16 v[98:99], v146 offset:18688
    v_mfma_f32_16x16x32_bf16 v[56:59], v[84:87], v[80:83], v[56:59]
    ds_read_b64_tr_b16 v[100:101], v147 offset:18432
    s_waitcnt lgkmcnt(4)
    v_mfma_f32_16x16x32_bf16 v[48:51], v[88:91], v[32:35], v[48:51]
    ds_read_b64_tr_b16 v[102:103], v147 offset:18688
    v_mfma_f32_16x16x32_bf16 v[60:63], v[88:91], v[80:83], v[60:63]
    s_waitcnt vmcnt(6)
    s_barrier
    s_waitcnt lgkmcnt(4)
    v_mfma_f32_16x16x32_bf16 v[36:39], v[32:35], v[92:95], v[36:39]
    s_add_u32 m0, s12, 32768
    ds_read_b128 v[80:83], v140 offset:20480
    v_mfma_f32_16x16x32_bf16 v[40:43], v[92:95], v[92:95], v[40:43]
    buffer_load_dwordx4 v120, s[20:23], s64 offen lds
    ds_read_b64_tr_b16 v[84:85], v146 offset:20480
    s_waitcnt lgkmcnt(4)
    v_mfma_f32_16x16x32_bf16 v[44:47], v[96:99], v[32:35], v[44:47]
    s_add_u32 m0, s13, 32768
    ds_read_b64_tr_b16 v[86:87], v146 offset:20736
    v_mfma_f32_16x16x32_bf16 v[56:59], v[96:99], v[92:95], v[56:59]
    buffer_load_dwordx4 v121, s[28:31], s65 offen offset:0 lds
    ds_read_b64_tr_b16 v[88:89], v147 offset:20480
    s_waitcnt lgkmcnt(4)
    v_mfma_f32_16x16x32_bf16 v[48:51], v[100:103], v[32:35], v[48:51]
    buffer_load_dwordx4 v122, s[28:31], s65 offen offset:1024 lds
    ds_read_b64_tr_b16 v[90:91], v147 offset:20736
    v_mfma_f32_16x16x32_bf16 v[60:63], v[100:103], v[92:95], v[60:63]
    s_waitcnt lgkmcnt(4)
    v_mfma_f32_16x16x32_bf16 v[36:39], v[32:35], v[80:83], v[36:39]
    ds_read_b128 v[92:95], v141 offset:20480
    v_mfma_f32_16x16x32_bf16 v[40:43], v[80:83], v[80:83], v[40:43]
    ds_read_b64_tr_b16 v[96:97], v146 offset:22528
    s_waitcnt lgkmcnt(4)
    v_mfma_f32_16x16x32_bf16 v[44:47], v[84:87], v[32:35], v[44:47]
    ds_read_b64_tr_b16 v[98:99], v146 offset:22784
    v_mfma_f32_16x16x32_bf16 v[56:59], v[84:87], v[80:83], v[56:59]
    ds_read_b64_tr_b16 v[100:101], v147 offset:22528
    s_waitcnt lgkmcnt(4)
    v_mfma_f32_16x16x32_bf16 v[48:51], v[88:91], v[32:35], v[48:51]
    ds_read_b64_tr_b16 v[102:103], v147 offset:22784
    v_mfma_f32_16x16x32_bf16 v[60:63], v[88:91], v[80:83], v[60:63]
    s_waitcnt vmcnt(6)
    s_barrier
    s_waitcnt lgkmcnt(4)
    v_mfma_f32_16x16x32_bf16 v[36:39], v[32:35], v[92:95], v[36:39]
    buffer_load_dword v126, v129, s[24:27], 0 offen sc1
    ds_read_b128 v[80:83], v140 offset:24576
    v_mfma_f32_16x16x32_bf16 v[40:43], v[92:95], v[92:95], v[40:43]
    s_add_u32 m0, s15, 0
    s_add_u32 s41, s14, 0
    ds_read_b64_tr_b16 v[84:85], v146 offset:24576
    s_waitcnt lgkmcnt(4)
    v_mfma_f32_16x16x32_bf16 v[44:47], v[96:99], v[32:35], v[44:47]
    buffer_load_dwordx4 v124, s[68:71], s41 offen lds
    ds_read_b64_tr_b16 v[86:87], v146 offset:24832
    v_mfma_f32_16x16x32_bf16 v[56:59], v[96:99], v[92:95], v[56:59]
    s_add_u32 m0, s15, 1024
    s_add_u32 s41, s14, 20736
    ds_read_b64_tr_b16 v[88:89], v147 offset:24576
    s_waitcnt lgkmcnt(4)
    v_mfma_f32_16x16x32_bf16 v[48:51], v[100:103], v[32:35], v[48:51]
    buffer_load_dwordx4 v124, s[68:71], s41 offen lds
    ds_read_b64_tr_b16 v[90:91], v147 offset:24832
    v_mfma_f32_16x16x32_bf16 v[60:63], v[100:103], v[92:95], v[60:63]
    s_add_u32 m0, s15, 2048
    s_add_u32 s41, s14, 41472
    s_waitcnt lgkmcnt(4)
    v_mfma_f32_16x16x32_bf16 v[36:39], v[32:35], v[80:83], v[36:39]
    buffer_load_dwordx4 v124, s[68:71], s41 offen lds
    ds_read_b128 v[92:95], v141 offset:24576
    v_mfma_f32_16x16x32_bf16 v[40:43], v[80:83], v[80:83], v[40:43]
    s_add_u32 m0, s15, 3072
    s_add_u32 s41, s14, 62208
    ds_read_b64_tr_b16 v[96:97], v146 offset:26624
    s_waitcnt lgkmcnt(4)
    v_mfma_f32_16x16x32_bf16 v[44:47], v[84:87], v[32:35], v[44:47]
    buffer_load_dwordx4 v124, s[68:71], s41 offen lds
    ds_read_b64_tr_b16 v[98:99], v146 offset:26880
    v_mfma_f32_16x16x32_bf16 v[56:59], v[84:87], v[80:83], v[56:59]
    buffer_store_dword v25, v24, s[16:19], s11 offen sc1
    ds_read_b64_tr_b16 v[100:101], v147 offset:26624
    s_waitcnt lgkmcnt(4)
L_pad2:
    s_cbranch_execz L_pad6
    v_mfma_f32_16x16x32_bf16 v[48:51], v[88:91], v[32:35], v[48:51]
    ds_read_b64_tr_b16 v[102:103], v147 offset:26880
    v_mfma_f32_16x16x32_bf16 v[60:63], v[88:91], v[80:83], v[60:63]
    s_waitcnt vmcnt(9)
    s_barrier
    s_waitcnt lgkmcnt(4)
    v_mfma_f32_16x16x32_bf16 v[36:39], v[32:35], v[92:95], v[36:39]
    ds_read_b128 v[80:83], v140 offset:28672
    v_mfma_f32_16x16x32_bf16 v[40:43], v[92:95], v[92:95], v[40:43]
    ds_read_b64_tr_b16 v[84:85], v146 offset:28672
    s_waitcnt lgkmcnt(4)
    v_mfma_f32_16x16x32_bf16 v[44:47], v[96:99], v[32:35], v[44:47]
    ds_read_b64_tr_b16 v[86:87], v146 offset:28928
    v_mfma_f32_16x16x32_bf16 v[56:59], v[96:99], v[92:95], v[56:59]
    ds_read_b64_tr_b16 v[88:89], v147 offset:28672
    s_waitcnt lgkmcnt(4)
    v_mfma_f32_16x16x32_bf16 v[48:51], v[100:103], v[32:35], v[48:51]
    ds_read_b64_tr_b16 v[90:91], v147 offset:28928
    v_mfma_f32_16x16x32_bf16 v[60:63], v[100:103], v[92:95], v[60:63]
    s_waitcnt lgkmcnt(4)
    v_mfma_f32_16x16x32_bf16 v[36:39], v[32:35], v[80:83], v[36:39]
    ds_read_b128 v[92:95], v141 offset:28672
    v_mfma_f32_16x16x32_bf16 v[40:43], v[80:83], v[80:83], v[40:43]
    ds_read_b64_tr_b16 v[96:97], v146 offset:30720
    s_waitcnt lgkmcnt(4)
    v_mfma_f32_16x16x32_bf16 v[44:47], v[84:87], v[32:35], v[44:47]
    ds_read_b64_tr_b16 v[98:99], v146 offset:30976
    v_mfma_f32_16x16x32_bf16 v[56:59], v[84:87], v[80:83], v[56:59]
    ds_read_b64_tr_b16 v[100:101], v147 offset:30720
    s_waitcnt lgkmcnt(4)
    v_mfma_f32_16x16x32_bf16 v[48:51], v[88:91], v[32:35], v[48:51]
    ds_read_b64_tr_b16 v[102:103], v147 offset:30976
    v_mfma_f32_16x16x32_bf16 v[60:63], v[88:91], v[80:83], v[60:63]
    s_waitcnt vmcnt(6)
    s_barrier
    s_waitcnt lgkmcnt(4)
    v_mfma_f32_16x16x32_bf16 v[36:39], v[32:35], v[92:95], v[36:39]
    ds_read_b128 v[80:83], v140 offset:32768
    v_mfma_f32_16x16x32_bf16 v[40:43], v[92:95], v[92:95], v[40:43]
    ds_read_b64_tr_b16 v[84:85], v146 offset:32768
    s_waitcnt lgkmcnt(4)
    v_mfma_f32_16x16x32_bf16 v[44:47], v[96:99], v[32:35], v[44:47]
    ds_read_b64_tr_b16 v[86:87], v146 offset:33024
    v_mfma_f32_16x16x32_bf16 v[56:59], v[96:99], v[92:95], v[56:59]
    ds_read_b64_tr_b16 v[88:89], v147 offset:32768
    s_waitcnt lgkmcnt(4)
    v_mfma_f32_16x16x32_bf16 v[48:51], v[100:103], v[32:35], v[48:51]
    ds_read_b64_tr_b16 v[90:91], v147 offset:33024
    v_mfma_f32_16x16x32_bf16 v[60:63], v[100:103], v[92:95], v[60:63]
    s_waitcnt lgkmcnt(4)
    v_mfma_f32_16x16x32_bf16 v[36:39], v[32:35], v[80:83], v[36:39]
    ds_read_b128 v[92:95], v141 offset:32768
    v_mfma_f32_16x16x32_bf16 v[40:43], v[80:83], v[80:83], v[40:43]
    ds_read_b64_tr_b16 v[96:97], v146 offset:34816
    s_waitcnt lgkmcnt(4)
    v_mfma_f32_16x16x32_bf16 v[44:47], v[84:87], v[32:35], v[44:47]
    ds_read_b64_tr_b16 v[98:99], v146 offset:35072
    v_mfma_f32_16x16x32_bf16 v[56:59], v[84:87], v[80:83], v[56:59]
    ds_read_b64_tr_b16 v[100:101], v147 offset:34816
    s_waitcnt lgkmcnt(4)
    v_mfma_f32_16x16x32_bf16 v[48:51], v[88:91], v[32:35], v[48:51]
    ds_read_b64_tr_b16 v[102:103], v147 offset:35072
    v_mfma_f32_16x16x32_bf16 v[60:63], v[88:91], v[80:83], v[60:63]
    s_waitcnt lgkmcnt(4)
    v_mfma_f32_16x16x32_bf16 v[36:39], v[32:35], v[92:95], v[36:39]
    v_mfma_f32_16x16x32_bf16 v[40:43], v[92:95], v[92:95], v[40:43]
    s_waitcnt lgkmcnt(2)
    v_mfma_f32_16x16x32_bf16 v[44:47], v[96:99], v[32:35], v[44:47]
    v_mfma_f32_16x16x32_bf16 v[56:59], v[96:99], v[92:95], v[56:59]
    s_waitcnt lgkmcnt(0)
    v_mfma_f32_16x16x32_bf16 v[48:51], v[100:103], v[32:35], v[48:51]
    v_mfma_f32_16x16x32_bf16 v[60:63], v[100:103], v[92:95], v[60:63]
    s_mov_b32 s43, 0x3727c5ac
    v_lshrrev_b32 v162, 1, v17
    v_lshlrev_b32 v162, 9, v162
    v_and_b32 v163, 1, v17
    v_lshl_add_u32 v162, v163, 3, v162
    v_lshl_add_u32 v162, v16, 4, v162
    v_cndmask_b32 v18, v40, v41, s[44:45]
    v_cndmask_b32 v18, v18, v42, s[46:47]
    v_cndmask_b32 v18, v18, v43, s[48:49]
    v_cndmask_b32 v18, 0, v18, s[72:73]
    v_mov_b32 v19, v18
    v_mul_f32 v160, 0x3ae38e39, v36
    v_fma_f32 v20, -v160, v160, s43
    v_permlane16_swap_b32 v19, v18
    s_nop 0
    v_add_f32 v18, v18, v19
    v_mov_b32 v19, v18
    s_nop 1
    v_permlane32_swap_b32 v19, v18
    s_nop 0
    v_add_f32 v18, v18, v19
    v_fmac_f32 v20, 0x3ae38e39, v18
    v_max_f32 v20, s43, v20
    v_rsq_f32 v161, v20
    s_nop 0
    s_lshr_b32 s41, s39, 2
    s_mul_i32 s41, s41, 10240
    s_lshl_b32 s42, s36, 8
    s_add_u32 s41, s41, s42
    s_and_b32 s42, s39, 3
    s_lshl_b32 s37, s42, 10
    v_lshlrev_b32 v163, 4, v16
    v_lshl_add_u32 v163, v17, 9, v163
    v_mov_b32 v164, 2130706432
    v_cmp_gt_u32 vcc, 2, v17
    s_add_u32 s37, s37, s41
    s_add_u32 s37, s37, 2364416
    v_cndmask_b32 v163, v164, v163, vcc
    s_lshl_b32 s42, s42, 2
    s_add_u32 s41, s41, s42
    s_add_u32 s41, s41, 2368512
    v_cmp_eq_u32 vcc, 0, v17
    v_fma_f32 v56, -v44, v160, v56
    v_fma_f32 v57, -v45, v160, v57
    v_fma_f32 v58, -v46, v160, v58
    v_fma_f32 v59, -v47, v160, v59
    v_fma_f32 v60, -v48, v160, v60
    v_fma_f32 v61, -v49, v160, v61
    v_mul_f32 v56, v56, v161
    v_mul_f32 v57, v57, v161
    v_mul_f32 v58, v58, v161
    v_mul_f32 v59, v59, v161
    v_mul_f32 v60, v60, v161
    v_mul_f32 v61, v61, v161
    v_cvt_pk_bf16_f32 v56, v56, v57
    v_cvt_pk_bf16_f32 v57, v58, v59
    v_cvt_pk_bf16_f32 v60, v60, v61
    v_mov_b32 v164, 0x3f80
    v_cndmask_b32 v60, v164, v60, vcc
    buffer_store_dwordx2 v[56:57], v162, s[16:19], s37 offen sc1
    buffer_store_dword v60, v163, s[16:19], s41 offen sc1
    s_waitcnt vmcnt(7)
    v_cmp_eq_u32 vcc, 0, v126
    s_cbranch_vccz L_set_gok
    s_mov_b32 s40, 0
L_spin_gok:
    s_sleep 2
    s_mov_b64 exec, vcc
    buffer_load_dword v126, v129, s[24:27], 0 offen sc1
    s_mov_b64 exec, -1
    s_waitcnt vmcnt(0)
    v_cmp_eq_u32 vcc, 0, v126
    s_cbranch_vccz L_set_gok
    s_add_u32 s40, s40, 1
    s_cmp_lt_u32 s40, 200000
    s_cbranch_scc1 L_spin_gok
L_set_gok:
    s_branch L_pa_kvend
L_pa_v:
L_pad3:
    s_cbranch_execz L_warm_done
    ds_read_b128 v[80:83], v140 offset:0
    ds_read_b64_tr_b16 v[84:85], v146 offset:0
    ds_read_b64_tr_b16 v[86:87], v146 offset:256
    ds_read_b64_tr_b16 v[88:89], v147 offset:0
    ds_read_b64_tr_b16 v[90:91], v147 offset:256
    s_add_u32 m0, s12, 12288
    s_nop 0
    buffer_load_dwordx4 v120, s[20:23], s50 offen lds
    s_add_u32 m0, s13, 12288
    s_nop 0
    buffer_load_dwordx4 v121, s[28:31], s51 offen offset:0 lds
    buffer_load_dwordx4 v122, s[28:31], s51 offen offset:1024 lds
    s_waitcnt lgkmcnt(4)
    v_mfma_f32_16x16x32_bf16 v[36:39], v[80:83], v[32:35], 0
    ds_read_b128 v[92:95], v141 offset:0
    v_mfma_f32_16x16x32_bf16 v[40:43], v[80:83], v[80:83], 0
    ds_read_b64_tr_b16 v[96:97], v146 offset:2048
    s_waitcnt lgkmcnt(4)
    v_mfma_f32_16x16x32_bf16 v[44:47], v[32:35], v[84:87], 0
    ds_read_b64_tr_b16 v[98:99], v146 offset:2304
    v_mfma_f32_16x16x32_bf16 v[56:59], v[80:83], v[84:87], 0
    ds_read_b64_tr_b16 v[100:101], v147 offset:2048
    s_waitcnt lgkmcnt(4)
    v_mfma_f32_16x16x32_bf16 v[48:51], v[32:35], v[88:91], 0
    ds_read_b64_tr_b16 v[102:103], v147 offset:2304
    v_mfma_f32_16x16x32_bf16 v[60:63], v[80:83], v[88:91], 0
    s_waitcnt vmcnt(6)
    s_barrier
    s_waitcnt lgkmcnt(4)
    v_mfma_f32_16x16x32_bf16 v[36:39], v[92:95], v[32:35], v[36:39]
    s_add_u32 m0, s12, 16384
    ds_read_b128 v[80:83], v140 offset:4096
    v_mfma_f32_16x16x32_bf16 v[40:43], v[92:95], v[92:95], v[40:43]
    buffer_load_dwordx4 v120, s[20:23], s52 offen lds
    ds_read_b64_tr_b16 v[84:85], v146 offset:4096
    s_waitcnt lgkmcnt(4)
    v_mfma_f32_16x16x32_bf16 v[44:47], v[32:35], v[96:99], v[44:47]
    s_add_u32 m0, s13, 16384
    ds_read_b64_tr_b16 v[86:87], v146 offset:4352
    v_mfma_f32_16x16x32_bf16 v[56:59], v[92:95], v[96:99], v[56:59]
    buffer_load_dwordx4 v121, s[28:31], s53 offen offset:0 lds
    ds_read_b64_tr_b16 v[88:89], v147 offset:4096
    s_waitcnt lgkmcnt(4)
    v_mfma_f32_16x16x32_bf16 v[48:51], v[32:35], v[100:103], v[48:51]
    buffer_load_dwordx4 v122, s[28:31], s53 offen offset:1024 lds
    ds_read_b64_tr_b16 v[90:91], v147 offset:4352
    v_mfma_f32_16x16x32_bf16 v[60:63], v[92:95], v[100:103], v[60:63]
    s_waitcnt lgkmcnt(4)
    v_mfma_f32_16x16x32_bf16 v[36:39], v[80:83], v[32:35], v[36:39]
    ds_read_b128 v[92:95], v141 offset:4096
    v_mfma_f32_16x16x32_bf16 v[40:43], v[80:83], v[80:83], v[40:43]
    ds_read_b64_tr_b16 v[96:97], v146 offset:6144
    s_waitcnt lgkmcnt(4)
    v_mfma_f32_16x16x32_bf16 v[44:47], v[32:35], v[84:87], v[44:47]
    ds_read_b64_tr_b16 v[98:99], v146 offset:6400
    v_mfma_f32_16x16x32_bf16 v[56:59], v[80:83], v[84:87], v[56:59]
    ds_read_b64_tr_b16 v[100:101], v147 offset:6144
    s_waitcnt lgkmcnt(4)
    v_mfma_f32_16x16x32_bf16 v[48:51], v[32:35], v[88:91], v[48:51]
    ds_read_b64_tr_b16 v[102:103], v147 offset:6400
    v_mfma_f32_16x16x32_bf16 v[60:63], v[80:83], v[88:91], v[60:63]
    s_waitcnt vmcnt(6)
    s_barrier
    s_waitcnt lgkmcnt(4)
    v_mfma_f32_16x16x32_bf16 v[36:39], v[92:95], v[32:35], v[36:39]
    s_add_u32 m0, s12, 20480
    ds_read_b128 v[80:83], v140 offset:8192
    v_mfma_f32_16x16x32_bf16 v[40:43], v[92:95], v[92:95], v[40:43]
    buffer_load_dwordx4 v120, s[20:23], s54 offen lds
    ds_read_b64_tr_b16 v[84:85], v146 offset:8192
    s_waitcnt lgkmcnt(4)
    v_mfma_f32_16x16x32_bf16 v[44:47], v[32:35], v[96:99], v[44:47]
    s_add_u32 m0, s13, 20480
    ds_read_b64_tr_b16 v[86:87], v146 offset:8448
    v_mfma_f32_16x16x32_bf16 v[56:59], v[92:95], v[96:99], v[56:59]
    buffer_load_dwordx4 v121, s[28:31], s55 offen offset:0 lds
    ds_read_b64_tr_b16 v[88:89], v147 offset:8192
    s_waitcnt lgkmcnt(4)
    v_mfma_f32_16x16x32_bf16 v[48:51], v[32:35], v[100:103], v[48:51]
    buffer_load_dwordx4 v122, s[28:31], s55 offen offset:1024 lds
    ds_read_b64_tr_b16 v[90:91], v147 offset:8448
    v_mfma_f32_16x16x32_bf16 v[60:63], v[92:95], v[100:103], v[60:63]
    s_waitcnt lgkmcnt(4)
    v_mfma_f32_16x16x32_bf16 v[36:39], v[80:83], v[32:35], v[36:39]
    ds_read_b128 v[92:95], v141 offset:8192
    v_mfma_f32_16x16x32_bf16 v[40:43], v[80:83], v[80:83], v[40:43]
    ds_read_b64_tr_b16 v[96:97], v146 offset:10240
    s_waitcnt lgkmcnt(4)
    v_mfma_f32_16x16x32_bf16 v[44:47], v[32:35], v[84:87], v[44:47]
    ds_read_b64_tr_b16 v[98:99], v146 offset:10496
    v_mfma_f32_16x16x32_bf16 v[56:59], v[80:83], v[84:87], v[56:59]
    ds_read_b64_tr_b16 v[100:101], v147 offset:10240
    s_waitcnt lgkmcnt(4)
    v_mfma_f32_16x16x32_bf16 v[48:51], v[32:35], v[88:91], v[48:51]
    ds_read_b64_tr_b16 v[102:103], v147 offset:10496
    v_mfma_f32_16x16x32_bf16 v[60:63], v[80:83], v[88:91], v[60:63]
    s_waitcnt vmcnt(6)
    s_barrier
    s_waitcnt lgkmcnt(4)
    v_mfma_f32_16x16x32_bf16 v[36:39], v[92:95], v[32:35], v[36:39]
    s_add_u32 m0, s12, 24576
    ds_read_b128 v[80:83], v140 offset:12288
    v_mfma_f32_16x16x32_bf16 v[40:43], v[92:95], v[92:95], v[40:43]
    buffer_load_dwordx4 v120, s[20:23], s56 offen lds
    ds_read_b64_tr_b16 v[84:85], v146 offset:12288
    s_waitcnt lgkmcnt(4)
    v_mfma_f32_16x16x32_bf16 v[44:47], v[32:35], v[96:99], v[44:47]
    s_add_u32 m0, s13, 24576
    ds_read_b64_tr_b16 v[86:87], v146 offset:12544
    v_mfma_f32_16x16x32_bf16 v[56:59], v[92:95], v[96:99], v[56:59]
    buffer_load_dwordx4 v121, s[28:31], s57 offen offset:0 lds
    ds_read_b64_tr_b16 v[88:89], v147 offset:12288
    s_waitcnt lgkmcnt(4)
    v_mfma_f32_16x16x32_bf16 v[48:51], v[32:35], v[100:103], v[48:51]
    buffer_load_dwordx4 v122, s[28:31], s57 offen offset:1024 lds
    ds_read_b64_tr_b16 v[90:91], v147 offset:12544
    v_mfma_f32_16x16x32_bf16 v[60:63], v[92:95], v[100:103], v[60:63]
    s_waitcnt lgkmcnt(4)
    v_mfma_f32_16x16x32_bf16 v[36:39], v[80:83], v[32:35], v[36:39]
    ds_read_b128 v[92:95], v141 offset:12288
    v_mfma_f32_16x16x32_bf16 v[40:43], v[80:83], v[80:83], v[40:43]
    ds_read_b64_tr_b16 v[96:97], v146 offset:14336
    s_waitcnt lgkmcnt(4)
    v_mfma_f32_16x16x32_bf16 v[44:47], v[32:35], v[84:87], v[44:47]
    ds_read_b64_tr_b16 v[98:99], v146 offset:14592
    v_mfma_f32_16x16x32_bf16 v[56:59], v[80:83], v[84:87], v[56:59]
    ds_read_b64_tr_b16 v[100:101], v147 offset:14336
    s_waitcnt lgkmcnt(4)
    v_mfma_f32_16x16x32_bf16 v[48:51], v[32:35], v[88:91], v[48:51]
    ds_read_b64_tr_b16 v[102:103], v147 offset:14592
    v_mfma_f32_16x16x32_bf16 v[60:63], v[80:83], v[88:91], v[60:63]
    s_waitcnt vmcnt(6)
    s_barrier
    s_waitcnt lgkmcnt(4)
    v_mfma_f32_16x16x32_bf16 v[36:39], v[92:95], v[32:35], v[36:39]
    s_add_u32 m0, s12, 28672
    ds_read_b128 v[80:83], v140 offset:16384
    v_mfma_f32_16x16x32_bf16 v[40:43], v[92:95], v[92:95], v[40:43]
    buffer_load_dwordx4 v120, s[20:23], s58 offen lds
    ds_read_b64_tr_b16 v[84:85], v146 offset:16384
    s_waitcnt lgkmcnt(4)
    v_mfma_f32_16x16x32_bf16 v[44:47], v[32:35], v[96:99], v[44:47]
    s_add_u32 m0, s13, 28672
    ds_read_b64_tr_b16 v[86:87], v146 offset:16640
    v_mfma_f32_16x16x32_bf16 v[56:59], v[92:95], v[96:99], v[56:59]
    buffer_load_dwordx4 v121, s[28:31], s59 offen offset:0 lds
    ds_read_b64_tr_b16 v[88:89], v147 offset:16384
    s_waitcnt lgkmcnt(4)
    v_mfma_f32_16x16x32_bf16 v[48:51], v[32:35], v[100:103], v[48:51]
    buffer_load_dwordx4 v122, s[28:31], s59 offen offset:1024 lds
    ds_read_b64_tr_b16 v[90:91], v147 offset:16640
    v_mfma_f32_16x16x32_bf16 v[60:63], v[92:95], v[100:103], v[60:63]
    s_waitcnt lgkmcnt(4)
    v_mfma_f32_16x16x32_bf16 v[36:39], v[80:83], v[32:35], v[36:39]
    ds_read_b128 v[92:95], v141 offset:16384
    v_mfma_f32_16x16x32_bf16 v[40:43], v[80:83], v[80:83], v[40:43]
    ds_read_b64_tr_b16 v[96:97], v146 offset:18432
    s_waitcnt lgkmcnt(4)
    v_mfma_f32_16x16x32_bf16 v[44:47], v[32:35], v[84:87], v[44:47]
    ds_read_b64_tr_b16 v[98:99], v146 offset:18688
    v_mfma_f32_16x16x32_bf16 v[56:59], v[80:83], v[84:87], v[56:59]
    ds_read_b64_tr_b16 v[100:101], v147 offset:18432
    s_waitcnt lgkmcnt(4)
    v_mfma_f32_16x16x32_bf16 v[48:51], v[32:35], v[88:91], v[48:51]
    ds_read_b64_tr_b16 v[102:103], v147 offset:18688
    v_mfma_f32_16x16x32_bf16 v[60:63], v[80:83], v[88:91], v[60:63]
    s_waitcnt vmcnt(6)
    s_barrier
    s_waitcnt lgkmcnt(4)
    v_mfma_f32_16x16x32_bf16 v[36:39], v[92:95], v[32:35], v[36:39]
    s_add_u32 m0, s12, 32768
    ds_read_b128 v[80:83], v140 offset:20480
    v_mfma_f32_16x16x32_bf16 v[40:43], v[92:95], v[92:95], v[40:43]
    buffer_load_dwordx4 v120, s[20:23], s64 offen lds
    ds_read_b64_tr_b16 v[84:85], v146 offset:20480
    s_waitcnt lgkmcnt(4)
    v_mfma_f32_16x16x32_bf16 v[44:47], v[32:35], v[96:99], v[44:47]
    s_add_u32 m0, s13, 32768
    ds_read_b64_tr_b16 v[86:87], v146 offset:20736
    v_mfma_f32_16x16x32_bf16 v[56:59], v[92:95], v[96:99], v[56:59]
    buffer_load_dwordx4 v121, s[28:31], s65 offen offset:0 lds
    ds_read_b64_tr_b16 v[88:89], v147 offset:20480
    s_waitcnt lgkmcnt(4)
    v_mfma_f32_16x16x32_bf16 v[48:51], v[32:35], v[100:103], v[48:51]
    buffer_load_dwordx4 v122, s[28:31], s65 offen offset:1024 lds
    ds_read_b64_tr_b16 v[90:91], v147 offset:20736
    v_mfma_f32_16x16x32_bf16 v[60:63], v[92:95], v[100:103], v[60:63]
    s_waitcnt lgkmcnt(4)
    v_mfma_f32_16x16x32_bf16 v[36:39], v[80:83], v[32:35], v[36:39]
    ds_read_b128 v[92:95], v141 offset:20480
    v_mfma_f32_16x16x32_bf16 v[40:43], v[80:83], v[80:83], v[40:43]
    ds_read_b64_tr_b16 v[96:97], v146 offset:22528
    s_waitcnt lgkmcnt(4)
    v_mfma_f32_16x16x32_bf16 v[44:47], v[32:35], v[84:87], v[44:47]
    ds_read_b64_tr_b16 v[98:99], v146 offset:22784
    v_mfma_f32_16x16x32_bf16 v[56:59], v[80:83], v[84:87], v[56:59]
    ds_read_b64_tr_b16 v[100:101], v147 offset:22528
    s_waitcnt lgkmcnt(4)
    v_mfma_f32_16x16x32_bf16 v[48:51], v[32:35], v[88:91], v[48:51]
    ds_read_b64_tr_b16 v[102:103], v147 offset:22784
    v_mfma_f32_16x16x32_bf16 v[60:63], v[80:83], v[88:91], v[60:63]
    s_waitcnt vmcnt(6)
    s_barrier
    s_waitcnt lgkmcnt(4)
    v_mfma_f32_16x16x32_bf16 v[36:39], v[92:95], v[32:35], v[36:39]
    buffer_load_dword v126, v129, s[24:27], 0 offen sc1
    ds_read_b128 v[80:83], v140 offset:24576
    v_mfma_f32_16x16x32_bf16 v[40:43], v[92:95], v[92:95], v[40:43]
    s_add_u32 m0, s15, 0
    s_add_u32 s41, s14, 0
    ds_read_b64_tr_b16 v[84:85], v146 offset:24576
    s_waitcnt lgkmcnt(4)
    v_mfma_f32_16x16x32_bf16 v[44:47], v[32:35], v[96:99], v[44:47]
    buffer_load_dwordx4 v124, s[68:71], s41 offen lds
    ds_read_b64_tr_b16 v[86:87], v146 offset:24832
    v_mfma_f32_16x16x32_bf16 v[56:59], v[92:95], v[96:99], v[56:59]
    s_add_u32 m0, s15, 1024
    s_add_u32 s41, s14, 20736
    ds_read_b64_tr_b16 v[88:89], v147 offset:24576
    s_waitcnt lgkmcnt(4)
    v_mfma_f32_16x16x32_bf16 v[48:51], v[32:35], v[100:103], v[48:51]
    buffer_load_dwordx4 v124, s[68:71], s41 offen lds
    ds_read_b64_tr_b16 v[90:91], v147 offset:24832
    v_mfma_f32_16x16x32_bf16 v[60:63], v[92:95], v[100:103], v[60:63]
    s_add_u32 m0, s15, 2048
    s_add_u32 s41, s14, 41472
    s_waitcnt lgkmcnt(4)
    v_mfma_f32_16x16x32_bf16 v[36:39], v[80:83], v[32:35], v[36:39]
    buffer_load_dwordx4 v124, s[68:71], s41 offen lds
    ds_read_b128 v[92:95], v141 offset:24576
    v_mfma_f32_16x16x32_bf16 v[40:43], v[80:83], v[80:83], v[40:43]
    s_add_u32 m0, s15, 3072
    s_add_u32 s41, s14, 62208
    ds_read_b64_tr_b16 v[96:97], v146 offset:26624
    s_waitcnt lgkmcnt(4)
    v_mfma_f32_16x16x32_bf16 v[44:47], v[32:35], v[84:87], v[44:47]
    buffer_load_dwordx4 v124, s[68:71], s41 offen lds
    ds_read_b64_tr_b16 v[98:99], v146 offset:26880
    v_mfma_f32_16x16x32_bf16 v[56:59], v[80:83], v[84:87], v[56:59]
    buffer_store_dword v25, v24, s[16:19], s11 offen sc1
    ds_read_b64_tr_b16 v[100:101], v147 offset:26624
    s_waitcnt lgkmcnt(4)
    v_mfma_f32_16x16x32_bf16 v[48:51], v[32:35], v[88:91], v[48:51]
    ds_read_b64_tr_b16 v[102:103], v147 offset:26880
    v_mfma_f32_16x16x32_bf16 v[60:63], v[80:83], v[88:91], v[60:63]
    s_waitcnt vmcnt(9)
    s_barrier
    s_waitcnt lgkmcnt(4)
    v_mfma_f32_16x16x32_bf16 v[36:39], v[92:95], v[32:35], v[36:39]
    ds_read_b128 v[80:83], v140 offset:28672
    v_mfma_f32_16x16x32_bf16 v[40:43], v[92:95], v[92:95], v[40:43]
    ds_read_b64_tr_b16 v[84:85], v146 offset:28672
    s_waitcnt lgkmcnt(4)
    v_mfma_f32_16x16x32_bf16 v[44:47], v[32:35], v[96:99], v[44:47]
    ds_read_b64_tr_b16 v[86:87], v146 offset:28928
    v_mfma_f32_16x16x32_bf16 v[56:59], v[92:95], v[96:99], v[56:59]
    ds_read_b64_tr_b16 v[88:89], v147 offset:28672
    s_waitcnt lgkmcnt(4)
    v_mfma_f32_16x16x32_bf16 v[48:51], v[32:35], v[100:103], v[48:51]
    ds_read_b64_tr_b16 v[90:91], v147 offset:28928
    v_mfma_f32_16x16x32_bf16 v[60:63], v[92:95], v[100:103], v[60:63]
    s_waitcnt lgkmcnt(4)
    v_mfma_f32_16x16x32_bf16 v[36:39], v[80:83], v[32:35], v[36:39]
    ds_read_b128 v[92:95], v141 offset:28672
    v_mfma_f32_16x16x32_bf16 v[40:43], v[80:83], v[80:83], v[40:43]
    ds_read_b64_tr_b16 v[96:97], v146 offset:30720
    s_waitcnt lgkmcnt(4)
    v_mfma_f32_16x16x32_bf16 v[44:47], v[32:35], v[84:87], v[44:47]
    ds_read_b64_tr_b16 v[98:99], v146 offset:30976
    v_mfma_f32_16x16x32_bf16 v[56:59], v[80:83], v[84:87], v[56:59]
    ds_read_b64_tr_b16 v[100:101], v147 offset:30720
    s_waitcnt lgkmcnt(4)
    v_mfma_f32_16x16x32_bf16 v[48:51], v[32:35], v[88:91], v[48:51]
    ds_read_b64_tr_b16 v[102:103], v147 offset:30976
    v_mfma_f32_16x16x32_bf16 v[60:63], v[80:83], v[88:91], v[60:63]
    s_waitcnt vmcnt(6)
    s_barrier
    s_waitcnt lgkmcnt(4)
    v_mfma_f32_16x16x32_bf16 v[36:39], v[92:95], v[32:35], v[36:39]
    ds_read_b128 v[80:83], v140 offset:32768
    v_mfma_f32_16x16x32_bf16 v[40:43], v[92:95], v[92:95], v[40:43]
    ds_read_b64_tr_b16 v[84:85], v146 offset:32768
    s_waitcnt lgkmcnt(4)
    v_mfma_f32_16x16x32_bf16 v[44:47], v[32:35], v[96:99], v[44:47]
    ds_read_b64_tr_b16 v[86:87], v146 offset:33024
    v_mfma_f32_16x16x32_bf16 v[56:59], v[92:95], v[96:99], v[56:59]
    ds_read_b64_tr_b16 v[88:89], v147 offset:32768
    s_waitcnt lgkmcnt(4)
    v_mfma_f32_16x16x32_bf16 v[48:51], v[32:35], v[100:103], v[48:51]
    ds_read_b64_tr_b16 v[90:91], v147 offset:33024
    v_mfma_f32_16x16x32_bf16 v[60:63], v[92:95], v[100:103], v[60:63]
    s_waitcnt lgkmcnt(4)
    v_mfma_f32_16x16x32_bf16 v[36:39], v[80:83], v[32:35], v[36:39]
    ds_read_b128 v[92:95], v141 offset:32768
    v_mfma_f32_16x16x32_bf16 v[40:43], v[80:83], v[80:83], v[40:43]
    ds_read_b64_tr_b16 v[96:97], v146 offset:34816
    s_waitcnt lgkmcnt(4)
    v_mfma_f32_16x16x32_bf16 v[44:47], v[32:35], v[84:87], v[44:47]
    ds_read_b64_tr_b16 v[98:99], v146 offset:35072
    v_mfma_f32_16x16x32_bf16 v[56:59], v[80:83], v[84:87], v[56:59]
    ds_read_b64_tr_b16 v[100:101], v147 offset:34816
    s_waitcnt lgkmcnt(4)
    v_mfma_f32_16x16x32_bf16 v[48:51], v[32:35], v[88:91], v[48:51]
    ds_read_b64_tr_b16 v[102:103], v147 offset:35072
    v_mfma_f32_16x16x32_bf16 v[60:63], v[80:83], v[88:91], v[60:63]
    s_waitcnt lgkmcnt(4)
    v_mfma_f32_16x16x32_bf16 v[36:39], v[92:95], v[32:35], v[36:39]
    v_mfma_f32_16x16x32_bf16 v[40:43], v[92:95], v[92:95], v[40:43]
    s_waitcnt lgkmcnt(2)
    v_mfma_f32_16x16x32_bf16 v[44:47], v[32:35], v[96:99], v[44:47]
    v_mfma_f32_16x16x32_bf16 v[56:59], v[92:95], v[96:99], v[56:59]
    s_waitcnt lgkmcnt(0)
    v_mfma_f32_16x16x32_bf16 v[48:51], v[32:35], v[100:103], v[48:51]
    v_mfma_f32_16x16x32_bf16 v[60:63], v[92:95], v[100:103], v[60:63]
    s_mov_b32 s43, 0x3727c5ac
    v_lshlrev_b32 v18, 2, v17
    v_sub_u32 v18, v16, v18
    v_cmp_eq_u32 s[44:45], 0, v18
    v_cmp_eq_u32 s[46:47], 1, v18
    v_cmp_eq_u32 s[48:49], 2, v18
    v_cmp_eq_u32 s[50:51], 3, v18
    v_and_b32 v160, 3, v16
    v_bfe_u32 v161, v16, 2, 1
    v_cndmask_b32 v40, 0, v40, s[44:45]
    v_cndmask_b32 v41, 0, v41, s[46:47]
    v_cndmask_b32 v42, 0, v42, s[48:49]
    v_cndmask_b32 v43, 0, v43, s[50:51]
    v_add_f32_dpp v40, v40, v40 row_ror:8 row_mask:0xf bank_mask:0xf
    v_add_f32_dpp v41, v41, v41 row_ror:8 row_mask:0xf bank_mask:0xf
    v_add_f32_dpp v42, v42, v42 row_ror:8 row_mask:0xf bank_mask:0xf
    v_add_f32_dpp v43, v43, v43 row_ror:8 row_mask:0xf bank_mask:0xf
    v_add_f32_dpp v40, v40, v40 row_ror:4 row_mask:0xf bank_mask:0xf
    v_add_f32_dpp v41, v41, v41 row_ror:4 row_mask:0xf bank_mask:0xf
    v_add_f32_dpp v42, v42, v42 row_ror:4 row_mask:0xf bank_mask:0xf
    v_add_f32_dpp v43, v43, v43 row_ror:4 row_mask:0xf bank_mask:0xf
    v_add_f32_dpp v40, v40, v40 row_ror:2 row_mask:0xf bank_mask:0xf
    v_add_f32_dpp v41, v41, v41 row_ror:2 row_mask:0xf bank_mask:0xf
    v_add_f32_dpp v42, v42, v42 row_ror:2 row_mask:0xf bank_mask:0xf
    v_add_f32_dpp v43, v43, v43 row_ror:2 row_mask:0xf bank_mask:0xf
    v_add_f32_dpp v40, v40, v40 row_ror:1 row_mask:0xf bank_mask:0xf
    v_add_f32_dpp v41, v41, v41 row_ror:1 row_mask:0xf bank_mask:0xf
    v_add_f32_dpp v42, v42, v42 row_ror:1 row_mask:0xf bank_mask:0xf
    v_add_f32_dpp v43, v43, v43 row_ror:1 row_mask:0xf bank_mask:0xf
    v_mul_f32 v36, 0x3ae38e39, v36
    v_mul_f32 v37, 0x3ae38e39, v37
    v_mul_f32 v38, 0x3ae38e39, v38
    v_mul_f32 v39, 0x3ae38e39, v39
    v_fma_f32 v18, -v36, v36, s43
    v_fma_f32 v19, -v37, v37, s43
    v_fma_f32 v20, -v38, v38, s43
    v_fma_f32 v21, -v39, v39, s43
    v_fmac_f32 v18, 0x3ae38e39, v40
    v_fmac_f32 v19, 0x3ae38e39, v41
    v_fmac_f32 v20, 0x3ae38e39, v42
    v_fmac_f32 v21, 0x3ae38e39, v43
    v_max_f32 v18, s43, v18
    v_max_f32 v19, s43, v19
    v_max_f32 v20, s43, v20
    v_max_f32 v21, s43, v21
    v_rsq_f32 v40, v18
    v_rsq_f32 v41, v19
    v_rsq_f32 v42, v20
    v_rsq_f32 v43, v21
    v_lshl_add_u32 v160, v161, 3, v160
    v_bfe_u32 v161, v16, 3, 1
    v_lshl_add_u32 v160, v161, 2, v160
    v_lshrrev_b32 v161, 1, v17
    v_mul_u32_u24 v162, 320, v161
    v_and_b32 v161, 1, v17
    v_lshl_add_u32 v162, v161, 3, v162
    v_lshl_add_u32 v160, v160, 4, v162
    v_and_b32 v161, 1, v16
    v_lshl_add_u32 v162, v161, 5, v162
    v_bfe_u32 v161, v16, 1, 1
    v_lshl_add_u32 v162, v161, 4, v162
    v_mov_b32 v163, 2130706432
    v_cmp_gt_u32 vcc, 4, v16
    s_lshr_b32 s37, s38, 3
    s_mul_i32 s37, s37, 5120
    s_mul_i32 s41, s38, 640
    s_add_u32 s37, s37, s41
    s_add_u32 s37, s37, 2359296
    v_cndmask_b32 v162, v163, v162, vcc
    v_cmp_lt_u32 vcc, 1, v16
    v_fma_f32 v56, -v44, v36, v56
    v_fma_f32 v57, -v45, v37, v57
    v_fma_f32 v58, -v46, v38, v58
    v_fma_f32 v59, -v47, v39, v59
    v_fma_f32 v60, -v48, v36, v60
    v_fma_f32 v61, -v49, v37, v61
    v_fma_f32 v62, -v50, v38, v62
    v_fma_f32 v63, -v51, v39, v63
    v_mul_f32 v56, v56, v40
    v_mul_f32 v57, v57, v41
    v_mul_f32 v58, v58, v42
    v_mul_f32 v59, v59, v43
    v_mul_f32 v60, v60, v40
    v_mul_f32 v61, v61, v41
    v_mul_f32 v62, v62, v42
    v_mul_f32 v63, v63, v43
    v_cvt_pk_bf16_f32 v56, v56, v57
    v_cvt_pk_bf16_f32 v57, v58, v59
    v_cvt_pk_bf16_f32 v60, v60, v61
    v_cvt_pk_bf16_f32 v61, v62, v63
    v_cndmask_b32 v60, v60, v32, vcc
    v_cndmask_b32 v61, v61, v32, vcc
    buffer_store_dwordx2 v[56:57], v160, s[16:19], s37 offen sc1
    buffer_store_dwordx2 v[60:61], v162, s[16:19], s37 offen offset:256 sc1
    s_waitcnt vmcnt(7)
    v_cmp_eq_u32 vcc, 0, v126
    s_cbranch_vccz L_set_gov
    s_mov_b32 s40, 0
L_spin_gov:
    s_sleep 2
    s_mov_b64 exec, vcc
    buffer_load_dword v126, v129, s[24:27], 0 offen sc1
    s_mov_b64 exec, -1
    s_waitcnt vmcnt(0)
    v_cmp_eq_u32 vcc, 0, v126
    s_cbranch_vccz L_set_gov
    s_add_u32 s40, s40, 1
    s_cmp_lt_u32 s40, 200000
    s_cbranch_scc1 L_spin_gov
L_set_gov:
L_pa_kvend:
L_pad4:
    s_cbranch_execz L_warm_done
    s_load_dwordx2 s[8:9], s[0:1], 48
    v_lshlrev_b32 v12, 4, v0
    v_bfe_u32 v212, v0, 2, 2
    s_mul_i32 s5, s32, 18432
    v_lshl_add_u32 v6, v212, 8, s5
    v_and_b32 v213, 1, v0
    v_lshl_add_u32 v212, v212, 1, v213
    v_mul_u32_u24 v212, 1168, v212
    v_add_u32 v212, 20480, v212
    v_bfe_u32 v213, v0, 4, 1
    v_bfe_u32 v214, v0, 1, 1
    v_lshl_add_u32 v213, v213, 1, v214
    v_mad_u32_u24 v212, v213, 36, v212
    v_lshrrev_b32 v215, 5, v0
    v_cmp_eq_u32 vcc, 0, v215
    v_lshl_add_u32 v4, v215, 4, v212
    v_add_u32 v5, 32, v212
    v_mov_b32 v216, 11264
    v_cndmask_b32 v5, v216, v5, vcc
    v_mul_u32_u24 v3, 0xaaaa, v214
    v_add_u32 v3, 0x4444, v3
    v_mov_b32 v2, 0xdddd
    v_mov_b32 v13, 0
    v_mov_b32 v14, 0
    v_mov_b32 v15, 0
    v_accvgpr_write_b32 a249, 0
    v_accvgpr_write_b32 a250, 0
    v_accvgpr_write_b32 a253, 0
    v_accvgpr_write_b32 a254, 0
    v_mfma_f32_32x32x8_bf16 a[208:223], v[14:15], v[14:15], 0
    v_lshrrev_b32 v212, 4, v0
    v_lshl_add_u32 v6, v212, 6, v6
    v_and_b32 v212, 3, v0
    v_lshl_add_u32 v6, v212, 4, v6
    s_mul_i32 s5, s32, 2560
    v_add_u32 v7, s5, v12
    v_lshlrev_b32 v10, 3, v0
    s_add_u32 s5, s5, 2048
L_pad5:
    s_cbranch_execz L_warm_done
    v_add_u32 v8, s5, v10
    v_mfma_f32_32x32x8_bf16 a[224:239], v[14:15], v[14:15], 0
    s_lshr_b32 s5, s32, 1
    s_lshl_b32 s5, s5, 10
    s_and_b32 s6, s32, 1
    s_lshl_b32 s6, s6, 3
    s_add_u32 s5, s5, s6
    v_add_u32 v9, s5, v12
    s_lshl_b32 s5, s32, 2
    s_add_u32 s5, s5, 10240
    v_add_u32 v11, s5, v12
    v_mov_b32 v178, 0
    v_mov_b32 v179, 0
    v_mov_b32 v182, 0
    v_mov_b32 v183, 0
    v_mov_b32 v186, 0
    v_mov_b32 v187, 0
    v_mov_b32 v190, 0
    v_mov_b32 v191, 0
    v_mov_b32 v194, 0
    v_mov_b32 v195, 0
    v_mov_b32 v198, 0
    v_mov_b32 v199, 0
    v_mov_b32 v202, 0
    v_mov_b32 v203, 0
    v_mov_b32 v206, 0
    v_mov_b32 v207, 0
    v_mov_b32 v210, 0
    v_mov_b32 v211, 0
    v_mov_b32 v228, -1
    v_mov_b32 v229, -1
    v_mov_b32 v230, -1
    v_mov_b32 v231, -1
    v_and_b32 v214, 31, v0
    v_lshrrev_b32 v215, 5, v0
    v_cmp_gt_u32 vcc, 18, v214
    v_and_b32 v217, 30, v214
    v_cmp_eq_u32 s[6:7], 20, v217
    v_mov_b32 v217, 133169152
    v_subrev_u32 v216, 2, v214
    v_cndmask_b32 v217, v217, v214, vcc
    v_cndmask_b32 v217, v217, v216, s[6:7]
    v_mul_u32_u24 v216, 320, v215
    v_lshl_add_u32 v136, v217, 4, v216
    v_add_u32 v137, 2560, v136
    v_add_u32 v138, 5120, v12
    v_add_u32 v139, 9216, v12
    s_lshl_b32 s5, s33, 10
    s_add_u32 s5, s5, 8982528
    v_add_u32 v220, s5, v12
    s_lshl_b32 s4, s33, 5
    s_lshr_b32 s5, s2, 3
    s_add_u32 s4, s4, s5
    s_mul_i32 s5, s4, 9216
    v_lshrrev_b32 v212, 4, v0
    v_mul_u32_u24 v212, 2304, v212
    v_add_u32 v212, s5, v212
    v_and_b32 v213, 15, v0
    s_lshl_b32 s5, s32, 8
    v_lshl_add_u32 v251, v213, 4, s5
    s_lshl_b32 s5, s32, 5
    s_add_u32 s5, s5, 1024
    v_lshl_add_u32 v253, v213, 1, s5
    v_add_u32 v1, v212, v251
    v_add_u32 v247, v212, v253
    s_lshr_b32 s5, s4, 2
    s_lshl_b32 s5, s5, 7
    s_add_u32 s5, s5, 8990720
    v_min_u32 v212, 11, v0
    v_lshl_add_u32 v255, v212, 3, s5
    s_cmp_lt_u32 s32, 3
    s_cselect_b32 s5, 0, 2130706432
    v_add_u32 v227, s5, v12
    s_cmp_lt_u32 s32, 2
    s_cselect_b32 s5, 0, 2130706432
    s_cselect_b32 s6, 0, 119936
    v_add_u32 v221, s5, v12
    v_and_b32 v212, 7, v0
    v_mul_u32_u24 v224, 144, v212
    v_mul_u32_u24 v212, 1168, v212
    v_lshrrev_b32 v213, 3, v0
    v_lshl_add_u32 v212, v213, 4, v212
    s_lshl_b32 s5, s32, 7
    v_add_u32 v223, s5, v212
    v_add_u32 v226, s6, v223
    v_mov_b32 v225, 0xc240
    s_lshr_b32 s5, s2, 3
    s_lshl_b32 s5, s5, 2
    s_add_u32 s5, s5, s32
    s_sub_u32 s5, s5, 72
    s_mul_i32 s5, s5, 24
    v_add_u32 v215, s5, v0
    v_cmp_gt_u32 s[6:7], 24, v0
    v_cmp_gt_u32 vcc, 1296, v215
    v_mul_u32_u24 v216, 7282, v215
    v_lshrrev_b32 v216, 16, v216
    v_mul_u32_u24 v216, 8064, v216
    v_lshl_add_u32 v215, v215, 7, v216
    s_and_b64 vcc, vcc, s[6:7]
    v_mov_b32 v216, 2130706432
    v_cndmask_b32 v215, v216, v215, vcc
    v_lshrrev_b32 v212, 2, v0
    v_and_b32 v213, 3, v0
    v_bfe_u32 v214, v0, 5, 1
    v_lshlrev_b32 v214, 1, v214
    v_xor_b32 v213, v213, v214
    v_mul_u32_u24 v212, 9216, v212
    s_cmp_lt_u32 s2, 144
    s_cselect_b64 vcc, -1, 0
    v_lshl_add_u32 v212, v213, 4, v212
    v_cndmask_b32 v248, v215, v212, vcc
    v_add_u32 v252, 589824, v248
    s_lshl_b32 s5, s32, 8
    s_add_u32 s5, s5, s2
    s_cmp_lt_u32 s5, 672
    s_cselect_b32 s5, 0, 2130706432
    v_add_u32 v249, s5, v12
    s_waitcnt vmcnt(0) lgkmcnt(0)
    s_barrier
    buffer_store_dword v32, v127, s[16:19], 0 offen sc1
    ds_read_b64_tr_b16 v[104:105], v143 offset:0
    ds_read_b64_tr_b16 v[106:107], v143 offset:256
    ds_read_b64_tr_b16 v[108:109], v144 offset:0
    ds_read_b64_tr_b16 v[110:111], v144 offset:256
    ds_read_b64_tr_b16 v[112:113], v143 offset:64
    ds_read_b64_tr_b16 v[114:115], v143 offset:320
    ds_read_b64_tr_b16 v[116:117], v144 offset:64
    ds_read_b64_tr_b16 v[118:119], v144 offset:320
    s_waitcnt lgkmcnt(6)
    buffer_store_dwordx4 v[104:107], v145, s[16:19], s60 offen sc1
    s_waitcnt lgkmcnt(4)
    buffer_store_dwordx4 v[108:111], v145, s[16:19], s61 offen sc1
    s_waitcnt lgkmcnt(2)
    buffer_store_dwordx4 v[112:115], v145, s[16:19], s62 offen sc1
    s_waitcnt lgkmcnt(0)
    buffer_store_dwordx4 v[116:119], v145, s[16:19], s63 offen sc1
    buffer_load_dwordx4 v[212:215], v1, s[20:23], 0 offen
    buffer_load_dwordx4 v[216:219], v1, s[20:23], 0 offen offset:1152
    buffer_load_ushort v30, v247, s[20:23], 0 offen
    buffer_load_ushort v31, v247, s[20:23], 0 offen offset:1152
    global_load_dwordx4 v[232:235], v251, s[8:9]
    global_load_ushort v236, v253, s[8:9]
    s_load_dwordx2 s[38:39], s[0:1], 72
    s_load_dwordx2 s[24:25], s[0:1], 80
    s_load_dwordx2 s[12:13], s[0:1], 56
    s_load_dwordx2 s[68:69], s[0:1], 64
    v_mov_b32 v173, 2130706432
    v_mov_b32 v174, 2130706432
    v_mov_b32 v175, 2130706432
    s_mov_b64 exec, 0
    s_cmp_eq_u32 s32, 0
    s_cbranch_scc1 L_padb0
    s_cmp_eq_u32 s32, 1
    s_cbranch_scc1 L_padb1
    s_cmp_eq_u32 s32, 2
    s_cbranch_scc1 L_padb2
    s_branch L_padb3
L_warm2_kv:
    s_mov_b64 exec, -1
    s_waitcnt vmcnt(0) lgkmcnt(0)
    buffer_load_dword v130, v131, s[16:19], 0 offen sc1
    buffer_load_dword v132, v133, s[16:19], 0 offen sc1
    ds_write_b32 v224, v225 offset:11264
    s_lshl_b32 s34, s32, 2
    s_bfe_u32 s46, s2, 0x20003
    s_add_u32 s47, s46, 0
    s_and_b32 s47, s47, 3
    s_add_u32 s47, s47, s34
    s_mul_i32 s47, s47, 10240
    s_add_u32 s47, s47, 2359296
    s_add_u32 s52, s16, s47
    s_addc_u32 s53, s17, 0
    s_movk_i32 s54, 10240
    s_mov_b32 s55, 0x20000
    s_add_u32 s47, s46, 1
    s_and_b32 s47, s47, 3
    s_add_u32 s47, s47, s34
    s_mul_i32 s47, s47, 10240
    s_add_u32 s47, s47, 2359296
    s_add_u32 s56, s16, s47
    s_addc_u32 s57, s17, 0
    s_movk_i32 s58, 10240
    s_mov_b32 s59, 0x20000
    s_add_u32 s47, s46, 2
    s_and_b32 s47, s47, 3
    s_add_u32 s47, s47, s34
    s_mul_i32 s47, s47, 10240
    s_add_u32 s47, s47, 2359296
    s_add_u32 s60, s16, s47
    s_addc_u32 s61, s17, 0
    s_movk_i32 s62, 10240
    s_mov_b32 s63, 0x20000
    s_add_u32 s47, s46, 3
    s_and_b32 s47, s47, 3
    s_add_u32 s47, s47, s34
    s_mul_i32 s47, s47, 10240
    s_add_u32 s47, s47, 2359296
    s_add_u32 s64, s16, s47
    s_addc_u32 s65, s17, 0
    s_movk_i32 s66, 10240
    s_mov_b32 s67, 0x20000
    s_mul_i32 s33, s4, 9216
    s_lshl_b32 s5, s32, 10
    s_add_u32 s5, s33, s5
    s_add_u32 s6, s5, 4096
    s_mov_b32 s26, 2359296
    s_mov_b32 s43, 0xffff0000
    s_mov_b32 s42, 0xf800000
    s_mov_b32 s14, 5308416
    s_mov_b32 s70, 5309440
    s_mov_b32 s15, 0x20000
    s_sub_u32 s68, s68, 1024
    s_subb_u32 s69, s69, 0
    s_and_b32 s10, s2, 7
    s_mul_i32 s10, s10, 18
    s_lshr_b32 s47, s2, 3
    s_add_u32 s3, s10, s47
    s_min_u32 s3, s3, 143
    s_mul_i32 s48, s32, 147456
    s_lshl_b32 s47, s3, 6
    s_add_u32 s48, s48, s47
    s_lshl_b32 s10, s10, 6
    s_cmp_lt_u32 s2, 144
    s_cselect_b32 s48, s48, s10
    s_cselect_b32 s9, 0, 1327104
    s_cselect_b32 s8, 1179648, 0
    s_mul_i32 s49, s3, 36864
    s_mul_i32 s51, s32, 9216
    s_add_u32 s49, s49, s51
    s_add_u32 s51, s51, 103552
    s_add_u32 s12, s12, s48
    s_addc_u32 s13, s13, 0
    s_add_u32 s68, s68, s48
    s_addc_u32 s69, s69, 0
    s_add_u32 s38, s38, s49
    s_addc_u32 s39, s39, 0
    s_lshl_b32 s50, s32, 11
    s_add_u32 s50, s50, 29824
    s_add_u32 s36, s5, 3190784
    s_add_u32 s37, s5, 3194880
    s_add_u32 s47, s33, 3198976
    s_lshl_b32 s44, s2, 2
    s_add_u32 s44, s44, s32
    s_lshl_b32 s44, s44, 10
    s_add_u32 s44, s44, 5816320
    s_lshl_b32 s45, s32, 8
    s_add_u32 s45, s45, s2
    s_lshl_b32 s45, s45, 10
    s_add_u32 s45, s45, 6602752
    s_cmp_eq_u32 s32, 0
    s_cselect_b32 s45, s47, s45
    v_lshlrev_b32 v238, 16, v232
    v_and_b32 v239, s43, v232
    v_lshlrev_b32 v240, 16, v233
    v_and_b32 v241, s43, v233
    v_lshlrev_b32 v242, 16, v234
    v_and_b32 v243, s43, v234
    v_lshlrev_b32 v244, 16, v235
    v_and_b32 v245, s43, v235
    v_lshlrev_b32 v246, 16, v236
    v_add_f32 v254, v238, v239
    v_add_f32 v254, v254, v240
    v_add_f32 v254, v254, v241
    v_add_f32 v254, v254, v242
    v_add_f32 v254, v254, v243
    v_add_f32 v254, v254, v244
    v_add_f32 v254, v254, v245
    v_add_f32 v254, v254, v246
    v_lshlrev_b32 v176, 16, v212
    v_lshlrev_b32 v177, 16, v216
    v_and_b32 v180, s43, v212
    v_add_f32_dpp v254, v254, v254 row_ror:8 row_mask:0xf bank_mask:0xf
    v_and_b32 v181, s43, v216
    v_lshlrev_b32 v184, 16, v213
    v_lshlrev_b32 v185, 16, v217
    v_add_f32_dpp v254, v254, v254 row_ror:4 row_mask:0xf bank_mask:0xf
    v_and_b32 v188, s43, v213
    v_and_b32 v189, s43, v217
    v_lshlrev_b32 v192, 16, v214
    v_add_f32_dpp v254, v254, v254 row_ror:2 row_mask:0xf bank_mask:0xf
    v_lshlrev_b32 v193, 16, v218
    v_and_b32 v196, s43, v214
    v_and_b32 v197, s43, v218
    v_add_f32_dpp v254, v254, v254 row_ror:1 row_mask:0xf bank_mask:0xf
    v_lshlrev_b32 v200, 16, v215
    v_lshlrev_b32 v201, 16, v219
    v_and_b32 v204, s43, v215
    v_and_b32 v205, s43, v219
    v_lshlrev_b32 v208, 16, v30
    v_lshlrev_b32 v209, 16, v31
    s_waitcnt vmcnt(0) lgkmcnt(0)
    v_cmp_eq_u32 vcc, 0, v132
    s_cbranch_vccz L_set_kvk
    s_mov_b32 s40, 0
L_spin_kvk:
    s_sleep 2
    s_mov_b64 exec, vcc
    buffer_load_dword v132, v133, s[16:19], 0 offen sc1
    s_mov_b64 exec, -1
    s_waitcnt vmcnt(0)
    v_cmp_eq_u32 vcc, 0, v132
    s_cbranch_vccz L_set_kvk
    s_add_u32 s40, s40, 1
    s_cmp_lt_u32 s40, 200000
    s_cbranch_scc1 L_spin_kvk
L_set_kvk:
    v_cmp_eq_u32 vcc, 0, v130
    s_cbranch_vccz L_set_cfk
    s_mov_b32 s40, 0
L_spin_cfk:
    s_sleep 2
    s_mov_b64 exec, vcc
    buffer_load_dword v130, v131, s[16:19], 0 offen sc1
    s_mov_b64 exec, -1
    s_waitcnt vmcnt(0)
    v_cmp_eq_u32 vcc, 0, v130
    s_cbranch_vccz L_set_cfk
    s_add_u32 s40, s40, 1
    s_cmp_lt_u32 s40, 200000
    s_cbranch_scc1 L_spin_cfk
L_set_cfk:
    buffer_load_dwordx4 v[112:115], v227, s[16:19], s5 offen sc1
    buffer_load_dwordx4 a[64:67], v139, s[52:55], 0 offen sc1
    buffer_load_dwordx4 a[0:3], v138, s[52:55], 0 offen offset:0 sc1
    buffer_load_dwordx4 a[4:7], v138, s[52:55], 0 offen offset:1024 sc1
    buffer_load_dwordx4 a[80:83], v136, s[52:55], 0 offen offset:0 sc1
    buffer_load_dwordx4 a[84:87], v136, s[52:55], 0 offen offset:640 sc1
    buffer_load_dwordx4 a[8:11], v138, s[52:55], 0 offen offset:2048 sc1
    buffer_load_dwordx4 a[88:91], v136, s[52:55], 0 offen offset:1280 sc1
    buffer_load_dwordx4 a[92:95], v136, s[52:55], 0 offen offset:1920 sc1
L_join:
L_pad6:
    s_cbranch_execz L_warm_done
    s_waitcnt vmcnt(8)
    v_cmp_eq_u32 vcc, -1, v112
    s_mov_b32 s28, s38
    s_mov_b32 s29, s39
    s_mov_b32 s30, 5308416
    s_cbranch_vccnz L_qspin
L_qok:
    ds_write_b128 v223, v[112:115] offset:20480
    buffer_store_dwordx4 v[104:107], v173, s[16:19], 0 offen sc1
    buffer_store_dwordx4 v[108:111], v174, s[16:19], 0 offen sc1
    buffer_load_dwordx4 a[12:15], v138, s[52:55], 0 offen offset:3072 sc1
    buffer_load_dwordx4 a[96:99], v137, s[52:55], 0 offen offset:0 sc1
    buffer_load_dwordx4 a[100:103], v137, s[52:55], 0 offen offset:640 sc1
    buffer_load_dwordx4 a[68:71], v139, s[56:59], 0 offen sc1
    s_waitcnt lgkmcnt(0)
    s_barrier
    ds_read2_b32 a[240:241], v4 offset0:0 offset1:1
    ds_read2_b32 a[242:243], v4 offset0:2 offset1:3
    ds_read_b32 a248, v5 offset:0
    ds_read_b32 a251, v5 offset:0
    ds_read2_b32 a[244:245], v4 offset0:36 offset1:37
    ds_read2_b32 a[246:247], v4 offset0:38 offset1:39
    ds_read_b32 a252, v5 offset:144
    ds_read_b32 a255, v5 offset:144
    buffer_store_dword v228, v134, s[16:19], 0 offen sc1
    s_cmp_lt_u32 s2, 144
    s_cselect_b64 vcc, -1, 0
    s_waitcnt vmcnt(13) lgkmcnt(4)
    v_mfma_f32_32x32x8_bf16 v[16:31], a[64:65], a[248:249], 0
    v_mfma_f32_32x32x16_bf16 v[16:31], a[0:3], a[240:243], v[16:31]
    buffer_load_dwordx4 a[16:19], v138, s[56:59], 0 offen offset:0 sc1
    buffer_load_dwordx4 a[104:107], v137, s[52:55], 0 offen offset:1280 sc1
    buffer_load_dwordx4 a[108:111], v137, s[52:55], 0 offen offset:1920 sc1
    buffer_load_dwordx4 a[20:23], v138, s[56:59], 0 offen offset:1024 sc1
    buffer_load_dwordx4 a[112:115], v136, s[56:59], 0 offen offset:0 sc1
    buffer_load_dwordx4 a[116:119], v136, s[56:59], 0 offen offset:640 sc1
    buffer_load_dwordx4 a[24:27], v138, s[56:59], 0 offen offset:2048 sc1
    buffer_load_dwordx4 a[120:123], v136, s[56:59], 0 offen offset:1280 sc1
    s_nop 1
    s_waitcnt lgkmcnt(0)
    v_mfma_f32_32x32x8_bf16 v[32:47], a[64:65], a[252:253], 0
    v_exp_f32 v16, v16
    v_exp_f32 v17, v17
    v_exp_f32 v18, v18
    v_exp_f32 v19, v19
    v_mfma_f32_32x32x16_bf16 v[32:47], a[0:3], a[244:247], v[32:47]
    s_waitcnt vmcnt(20)
    v_exp_f32 v20, v20
    v_exp_f32 v21, v21
    v_exp_f32 v22, v22
    v_exp_f32 v23, v23
    v_exp_f32 v24, v24
    v_exp_f32 v25, v25
    v_exp_f32 v26, v26
    v_exp_f32 v27, v27
    s_add_u32 m0, s51, 0
    s_cbranch_vccz L_skip1
    buffer_load_dwordx4 v12, s[28:31], 0 offen offset:0 lds
    buffer_load_dwordx4 v12, s[28:31], 0 offen offset:1024 lds
    s_branch L_skip1j
L_skip1:
    buffer_load_dword v250, v248, s[12:15], 0 offen
    buffer_load_dword v250, v248, s[68:71], 0 offen offset:1024
L_skip1j:
    v_exp_f32 v28, v28
    v_exp_f32 v29, v29
    v_exp_f32 v30, v30
    v_exp_f32 v31, v31
    v_mfma_f32_32x32x8_bf16 v[48:63], a[64:65], a[250:251], 0
    v_exp_f32 v32, v32
    v_exp_f32 v33, v33
    v_exp_f32 v34, v34
    v_exp_f32 v35, v35
    v_mfma_f32_32x32x16_bf16 v[48:63], a[4:7], a[240:243], v[48:63]
    s_waitcnt vmcnt(18)
    v_exp_f32 v36, v36
    v_exp_f32 v37, v37
    v_exp_f32 v38, v38
    v_exp_f32 v39, v39
    v_smfmac_f32_32x32x32_bf16 a[208:223], a[80:83], v[16:23], v2
    s_add_u32 s12, s12, s9
    s_addc_u32 s13, s13, 0
    v_exp_f32 v40, v40
    v_exp_f32 v41, v41
    v_exp_f32 v42, v42
    v_exp_f32 v43, v43
    v_smfmac_f32_32x32x32_bf16 a[208:223], a[84:87], v[24:31], v2
    s_add_u32 s68, s68, s9
    s_addc_u32 s69, s69, 0
    v_exp_f32 v44, v44
    v_exp_f32 v45, v45
    v_exp_f32 v46, v46
    v_exp_f32 v47, v47
    v_mfma_f32_32x32x8_bf16 v[16:31], a[64:65], a[254:255], 0
    v_exp_f32 v48, v48
    v_exp_f32 v49, v49
    v_exp_f32 v50, v50
    v_exp_f32 v51, v51
    v_mfma_f32_32x32x16_bf16 v[16:31], a[4:7], a[244:247], v[16:31]
    s_waitcnt vmcnt(17)
    v_exp_f32 v52, v52
    v_exp_f32 v53, v53
    v_exp_f32 v54, v54
    v_exp_f32 v55, v55
    v_smfmac_f32_32x32x32_bf16 a[224:239], a[80:83], v[32:39], v2
    v_exp_f32 v56, v56
    v_exp_f32 v57, v57
    v_exp_f32 v58, v58
    v_exp_f32 v59, v59
    v_smfmac_f32_32x32x32_bf16 a[224:239], a[84:87], v[40:47], v2
    v_exp_f32 v60, v60
    v_exp_f32 v61, v61
    v_exp_f32 v62, v62
    v_exp_f32 v63, v63
    v_mfma_f32_32x32x8_bf16 v[32:47], a[66:67], a[248:249], 0
    v_exp_f32 v16, v16
    v_exp_f32 v17, v17
    v_exp_f32 v18, v18
    v_exp_f32 v19, v19
    v_mfma_f32_32x32x16_bf16 v[32:47], a[8:11], a[240:243], v[32:47]
    s_waitcnt vmcnt(15)
    v_exp_f32 v20, v20
    v_exp_f32 v21, v21
    v_exp_f32 v22, v22
    v_exp_f32 v23, v23
    v_smfmac_f32_32x32x32_bf16 a[208:223], a[88:91], v[48:55], v2
    v_exp_f32 v24, v24
    v_exp_f32 v25, v25
    v_exp_f32 v26, v26
    v_exp_f32 v27, v27
    v_smfmac_f32_32x32x32_bf16 a[208:223], a[92:95], v[56:63], v2
    v_exp_f32 v28, v28
    v_exp_f32 v29, v29
    v_exp_f32 v30, v30
    v_exp_f32 v31, v31
    v_mfma_f32_32x32x8_bf16 v[48:63], a[66:67], a[252:253], 0
    v_exp_f32 v32, v32
    v_exp_f32 v33, v33
    v_exp_f32 v34, v34
    v_exp_f32 v35, v35
    v_mfma_f32_32x32x16_bf16 v[48:63], a[8:11], a[244:247], v[48:63]
    s_waitcnt vmcnt(12)
    v_exp_f32 v36, v36
    v_exp_f32 v37, v37
    v_exp_f32 v38, v38
    v_exp_f32 v39, v39
    v_smfmac_f32_32x32x32_bf16 a[224:239], a[88:91], v[16:23], v2
    buffer_store_dword v228, v175, s[16:19], 0 offen sc1
    v_exp_f32 v40, v40
    v_exp_f32 v41, v41
    v_exp_f32 v42, v42
    v_exp_f32 v43, v43
    v_smfmac_f32_32x32x32_bf16 a[224:239], a[92:95], v[24:31], v2
    v_exp_f32 v44, v44
    v_exp_f32 v45, v45
    v_exp_f32 v46, v46
    v_exp_f32 v47, v47
    v_mfma_f32_32x32x8_bf16 v[16:31], a[66:67], a[250:251], 0
    v_exp_f32 v48, v48
    v_exp_f32 v49, v49
    v_exp_f32 v50, v50
    v_exp_f32 v51, v51
    v_mfma_f32_32x32x16_bf16 v[16:31], a[12:15], a[240:243], v[16:31]
    s_waitcnt vmcnt(11)
    v_exp_f32 v52, v52
    v_exp_f32 v53, v53
    v_exp_f32 v54, v54
    v_exp_f32 v55, v55
    v_smfmac_f32_32x32x32_bf16 a[208:223], a[96:99], v[32:39], v2
    v_exp_f32 v56, v56
    v_exp_f32 v57, v57
    v_exp_f32 v58, v58
    v_exp_f32 v59, v59
    v_smfmac_f32_32x32x32_bf16 a[208:223], a[100:103], v[40:47], v2
    v_exp_f32 v60, v60
    v_exp_f32 v61, v61
    v_exp_f32 v62, v62
    v_exp_f32 v63, v63
    v_mfma_f32_32x32x8_bf16 v[32:47], a[66:67], a[254:255], 0
    v_exp_f32 v16, v16
    v_exp_f32 v17, v17
    v_exp_f32 v18, v18
    v_exp_f32 v19, v19
    v_mfma_f32_32x32x16_bf16 v[32:47], a[12:15], a[244:247], v[32:47]
    s_waitcnt vmcnt(8)
    v_exp_f32 v20, v20
    v_exp_f32 v21, v21
    v_exp_f32 v22, v22
    v_exp_f32 v23, v23
    v_smfmac_f32_32x32x32_bf16 a[224:239], a[96:99], v[48:55], v2
    buffer_load_dwordx4 a[124:127], v136, s[56:59], 0 offen offset:1920 sc1
    v_exp_f32 v24, v24
    v_exp_f32 v25, v25
    v_exp_f32 v26, v26
    v_exp_f32 v27, v27
    v_smfmac_f32_32x32x32_bf16 a[224:239], a[100:103], v[56:63], v2
    buffer_load_dwordx4 a[28:31], v138, s[56:59], 0 offen offset:3072 sc1
    v_exp_f32 v28, v28
    v_exp_f32 v29, v29
    v_exp_f32 v30, v30
    v_exp_f32 v31, v31
    v_mfma_f32_32x32x8_bf16 v[48:63], a[68:69], a[248:249], 0
    v_exp_f32 v32, v32
    v_exp_f32 v33, v33
    v_exp_f32 v34, v34
    v_exp_f32 v35, v35
    v_mfma_f32_32x32x16_bf16 v[48:63], a[16:19], a[240:243], v[48:63]
    s_waitcnt vmcnt(8)
    v_exp_f32 v36, v36
    v_exp_f32 v37, v37
    v_exp_f32 v38, v38
    v_exp_f32 v39, v39
    v_smfmac_f32_32x32x32_bf16 a[208:223], a[104:107], v[16:23], v2
    buffer_load_dwordx4 a[128:131], v137, s[56:59], 0 offen offset:0 sc1
    v_exp_f32 v40, v40
    v_exp_f32 v41, v41
    v_exp_f32 v42, v42
    v_exp_f32 v43, v43
    v_smfmac_f32_32x32x32_bf16 a[208:223], a[108:111], v[24:31], v2
    buffer_load_dwordx4 a[132:135], v137, s[56:59], 0 offen offset:640 sc1
    v_exp_f32 v44, v44
    v_exp_f32 v45, v45
    v_exp_f32 v46, v46
    v_exp_f32 v47, v47
    v_mfma_f32_32x32x8_bf16 v[16:31], a[68:69], a[252:253], 0
    v_exp_f32 v48, v48
    v_exp_f32 v49, v49
    v_exp_f32 v50, v50
    v_exp_f32 v51, v51
    v_mfma_f32_32x32x16_bf16 v[16:31], a[16:19], a[244:247], v[16:31]
    s_waitcnt vmcnt(9)
    v_exp_f32 v52, v52
    v_exp_f32 v53, v53
    v_exp_f32 v54, v54
    v_exp_f32 v55, v55
    v_smfmac_f32_32x32x32_bf16 a[224:239], a[104:107], v[32:39], v2
    buffer_load_dwordx4 a[72:75], v139, s[60:63], 0 offen sc1
    v_exp_f32 v56, v56
    v_exp_f32 v57, v57
    v_exp_f32 v58, v58
    v_exp_f32 v59, v59
    v_smfmac_f32_32x32x32_bf16 a[224:239], a[108:111], v[40:47], v2
    buffer_load_dwordx4 a[32:35], v138, s[60:63], 0 offen offset:0 sc1
    v_exp_f32 v60, v60
    v_exp_f32 v61, v61
    v_exp_f32 v62, v62
    v_exp_f32 v63, v63
    v_mfma_f32_32x32x8_bf16 v[32:47], a[68:69], a[250:251], 0
    v_exp_f32 v16, v16
    v_exp_f32 v17, v17
    v_exp_f32 v18, v18
    v_exp_f32 v19, v19
    v_mfma_f32_32x32x16_bf16 v[32:47], a[20:23], a[240:243], v[32:47]
    s_waitcnt vmcnt(9)
    v_exp_f32 v20, v20
    v_exp_f32 v21, v21
    v_exp_f32 v22, v22
    v_exp_f32 v23, v23
    v_smfmac_f32_32x32x32_bf16 a[208:223], a[112:115], v[48:55], v2
    buffer_load_dwordx4 a[136:139], v137, s[56:59], 0 offen offset:1280 sc1
    v_exp_f32 v24, v24
    v_exp_f32 v25, v25
    v_exp_f32 v26, v26
    v_exp_f32 v27, v27
    v_smfmac_f32_32x32x32_bf16 a[208:223], a[116:119], v[56:63], v2
    buffer_load_dwordx4 a[140:143], v137, s[56:59], 0 offen offset:1920 sc1
    v_exp_f32 v28, v28
    v_exp_f32 v29, v29
    v_exp_f32 v30, v30
    v_exp_f32 v31, v31
    v_mfma_f32_32x32x8_bf16 v[48:63], a[68:69], a[254:255], 0
    v_exp_f32 v32, v32
    v_exp_f32 v33, v33
    v_exp_f32 v34, v34
    v_exp_f32 v35, v35
    v_mfma_f32_32x32x16_bf16 v[48:63], a[20:23], a[244:247], v[48:63]
    s_waitcnt vmcnt(10)
    v_exp_f32 v36, v36
    v_exp_f32 v37, v37
    v_exp_f32 v38, v38
    v_exp_f32 v39, v39
    v_smfmac_f32_32x32x32_bf16 a[224:239], a[112:115], v[16:23], v2
    buffer_load_dwordx4 a[36:39], v138, s[60:63], 0 offen offset:1024 sc1
    v_exp_f32 v40, v40
    v_exp_f32 v41, v41
    v_exp_f32 v42, v42
    v_exp_f32 v43, v43
    v_smfmac_f32_32x32x32_bf16 a[224:239], a[116:119], v[24:31], v2
    buffer_load_dwordx4 a[144:147], v136, s[60:63], 0 offen offset:0 sc1
    v_exp_f32 v44, v44
    v_exp_f32 v45, v45
    v_exp_f32 v46, v46
    v_exp_f32 v47, v47
    v_mfma_f32_32x32x8_bf16 v[16:31], a[70:71], a[248:249], 0
    v_exp_f32 v48, v48
    v_exp_f32 v49, v49
    v_exp_f32 v50, v50
    v_exp_f32 v51, v51
    v_mfma_f32_32x32x16_bf16 v[16:31], a[24:27], a[240:243], v[16:31]
    s_waitcnt vmcnt(9)
    v_exp_f32 v52, v52
    v_exp_f32 v53, v53
    v_exp_f32 v54, v54
    v_exp_f32 v55, v55
    v_smfmac_f32_32x32x32_bf16 a[208:223], a[120:123], v[32:39], v2
    buffer_load_dwordx4 a[148:151], v136, s[60:63], 0 offen offset:640 sc1
    v_exp_f32 v56, v56
    v_exp_f32 v57, v57
    v_exp_f32 v58, v58
    v_exp_f32 v59, v59
    v_smfmac_f32_32x32x32_bf16 a[208:223], a[124:127], v[40:47], v2
    buffer_load_dwordx4 a[40:43], v138, s[60:63], 0 offen offset:2048 sc1
    v_exp_f32 v60, v60
    v_exp_f32 v61, v61
    v_exp_f32 v62, v62
    v_exp_f32 v63, v63
    v_mfma_f32_32x32x8_bf16 v[32:47], a[70:71], a[252:253], 0
    buffer_load_dword v222, v220, s[16:19], 0 offen sc1
    v_exp_f32 v16, v16
    v_exp_f32 v17, v17
    v_exp_f32 v18, v18
    v_exp_f32 v19, v19
    v_mfma_f32_32x32x16_bf16 v[32:47], a[24:27], a[244:247], v[32:47]
    s_waitcnt vmcnt(11)
    v_exp_f32 v20, v20
    v_exp_f32 v21, v21
    v_exp_f32 v22, v22
    v_exp_f32 v23, v23
    v_smfmac_f32_32x32x32_bf16 a[224:239], a[120:123], v[48:55], v2
    buffer_load_dwordx4 a[152:155], v136, s[60:63], 0 offen offset:1280 sc1
    v_exp_f32 v24, v24
    v_exp_f32 v25, v25
    v_exp_f32 v26, v26
    v_exp_f32 v27, v27
    v_smfmac_f32_32x32x32_bf16 a[224:239], a[124:127], v[56:63], v2
    buffer_load_dwordx4 a[156:159], v136, s[60:63], 0 offen offset:1920 sc1
    v_exp_f32 v28, v28
    v_exp_f32 v29, v29
    v_exp_f32 v30, v30
    v_exp_f32 v31, v31
    v_mfma_f32_32x32x8_bf16 v[48:63], a[70:71], a[250:251], 0
    buffer_load_dword v213, v255, s[16:19], 0 offen sc1
    v_exp_f32 v32, v32
    v_exp_f32 v33, v33
    v_exp_f32 v34, v34
    v_exp_f32 v35, v35
    v_mfma_f32_32x32x16_bf16 v[48:63], a[28:31], a[240:243], v[48:63]
    s_waitcnt vmcnt(12)
    v_exp_f32 v36, v36
    v_exp_f32 v37, v37
    v_exp_f32 v38, v38
    v_exp_f32 v39, v39
    v_smfmac_f32_32x32x32_bf16 a[208:223], a[128:131], v[16:23], v2
    buffer_load_dwordx4 a[44:47], v138, s[60:63], 0 offen offset:3072 sc1
    v_exp_f32 v40, v40
    v_exp_f32 v41, v41
    v_exp_f32 v42, v42
    v_exp_f32 v43, v43
    v_smfmac_f32_32x32x32_bf16 a[208:223], a[132:135], v[24:31], v2
    buffer_load_dwordx4 a[160:163], v137, s[60:63], 0 offen offset:0 sc1
    v_exp_f32 v44, v44
    v_exp_f32 v45, v45
    v_exp_f32 v46, v46
    v_exp_f32 v47, v47
    v_mfma_f32_32x32x8_bf16 v[16:31], a[70:71], a[254:255], 0
    v_exp_f32 v48, v48
    v_exp_f32 v49, v49
    v_exp_f32 v50, v50
    v_exp_f32 v51, v51
    v_mfma_f32_32x32x16_bf16 v[16:31], a[28:31], a[244:247], v[16:31]
    s_waitcnt vmcnt(12)
    v_exp_f32 v52, v52
    v_exp_f32 v53, v53
    v_exp_f32 v54, v54
    v_exp_f32 v55, v55
    v_smfmac_f32_32x32x32_bf16 a[224:239], a[128:131], v[32:39], v2
    buffer_load_dwordx4 a[164:167], v137, s[60:63], 0 offen offset:640 sc1
    v_exp_f32 v56, v56
    v_exp_f32 v57, v57
    v_exp_f32 v58, v58
    v_exp_f32 v59, v59
    v_smfmac_f32_32x32x32_bf16 a[224:239], a[132:135], v[40:47], v2
    buffer_load_dwordx4 a[76:79], v139, s[64:67], 0 offen sc1
    v_exp_f32 v60, v60
    v_exp_f32 v61, v61
    v_exp_f32 v62, v62
    v_exp_f32 v63, v63
    v_mfma_f32_32x32x8_bf16 v[32:47], a[72:73], a[248:249], 0
    v_exp_f32 v16, v16
    v_exp_f32 v17, v17
    v_exp_f32 v18, v18
    v_exp_f32 v19, v19
    v_mfma_f32_32x32x16_bf16 v[32:47], a[32:35], a[240:243], v[32:47]
    s_waitcnt vmcnt(12)
    v_exp_f32 v20, v20
    v_exp_f32 v21, v21
    v_exp_f32 v22, v22
    v_exp_f32 v23, v23
    v_smfmac_f32_32x32x32_bf16 a[208:223], a[136:139], v[48:55], v2
    buffer_load_dwordx4 a[48:51], v138, s[64:67], 0 offen offset:0 sc1
    v_exp_f32 v24, v24
    v_exp_f32 v25, v25
    v_exp_f32 v26, v26
    v_exp_f32 v27, v27
    v_smfmac_f32_32x32x32_bf16 a[208:223], a[140:143], v[56:63], v2
    buffer_load_dwordx4 a[168:171], v137, s[60:63], 0 offen offset:1280 sc1
    v_exp_f32 v28, v28
    v_exp_f32 v29, v29
    v_exp_f32 v30, v30
    v_exp_f32 v31, v31
    v_mfma_f32_32x32x8_bf16 v[48:63], a[72:73], a[252:253], 0
    v_exp_f32 v32, v32
    v_exp_f32 v33, v33
    v_exp_f32 v34, v34
    v_exp_f32 v35, v35
    v_mfma_f32_32x32x16_bf16 v[48:63], a[32:35], a[244:247], v[48:63]
    s_waitcnt vmcnt(13)
    v_exp_f32 v36, v36
    v_exp_f32 v37, v37
    v_exp_f32 v38, v38
    v_exp_f32 v39, v39
    v_smfmac_f32_32x32x32_bf16 a[224:239], a[136:139], v[16:23], v2
    buffer_load_dwordx4 a[172:175], v137, s[60:63], 0 offen offset:1920 sc1
    v_exp_f32 v40, v40
    v_exp_f32 v41, v41
    v_exp_f32 v42, v42
    v_exp_f32 v43, v43
    v_smfmac_f32_32x32x32_bf16 a[224:239], a[140:143], v[24:31], v2
    buffer_load_dwordx4 a[52:55], v138, s[64:67], 0 offen offset:1024 sc1
    v_exp_f32 v44, v44
    v_exp_f32 v45, v45
    v_exp_f32 v46, v46
    v_exp_f32 v47, v47
    v_mfma_f32_32x32x8_bf16 v[16:31], a[72:73], a[250:251], 0
    v_exp_f32 v48, v48
    v_exp_f32 v49, v49
    v_exp_f32 v50, v50
    v_exp_f32 v51, v51
    v_mfma_f32_32x32x16_bf16 v[16:31], a[36:39], a[240:243], v[16:31]
    s_waitcnt vmcnt(13)
    s_waitcnt vmcnt(8)
    v_exp_f32 v52, v52
    v_exp_f32 v53, v53
    v_exp_f32 v54, v54
    v_min_u32 v212, v213, v222
    v_cmp_eq_u32 s[10:11], 0, v212
    v_exp_f32 v55, v55
    v_smfmac_f32_32x32x32_bf16 a[208:223], a[144:147], v[32:39], v2
    buffer_load_dwordx4 a[176:179], v136, s[64:67], 0 offen offset:0 sc1
    v_exp_f32 v56, v56
L_padb0:
    s_cbranch_execz L_padb4
    v_exp_f32 v57, v57
    v_exp_f32 v58, v58
    v_exp_f32 v59, v59
    v_smfmac_f32_32x32x32_bf16 a[208:223], a[148:151], v[40:47], v2
    buffer_load_dwordx4 a[180:183], v136, s[64:67], 0 offen offset:640 sc1
    v_exp_f32 v60, v60
    v_exp_f32 v61, v61
    v_exp_f32 v62, v62
    v_exp_f32 v63, v63
    v_mfma_f32_32x32x8_bf16 v[32:47], a[72:73], a[254:255], 0
    v_exp_f32 v16, v16
    v_exp_f32 v17, v17
    v_exp_f32 v18, v18
    v_exp_f32 v19, v19
    v_mfma_f32_32x32x16_bf16 v[32:47], a[36:39], a[244:247], v[32:47]
    s_cmp_lg_u64 s[10:11], 0
    s_cbranch_scc1 L_wospin
L_wook:
    v_exp_f32 v20, v20
    v_exp_f32 v21, v21
    v_exp_f32 v22, v22
    v_exp_f32 v23, v23
    v_smfmac_f32_32x32x32_bf16 a[224:239], a[144:147], v[48:55], v2
    buffer_load_dwordx4 a[56:59], v138, s[64:67], 0 offen offset:2048 sc1
    v_exp_f32 v24, v24
    v_exp_f32 v25, v25
    v_exp_f32 v26, v26
    v_exp_f32 v27, v27
    v_smfmac_f32_32x32x32_bf16 a[224:239], a[148:151], v[56:63], v2
    buffer_load_dwordx4 a[184:187], v136, s[64:67], 0 offen offset:1280 sc1
    v_exp_f32 v28, v28
    v_exp_f32 v29, v29
    v_exp_f32 v30, v30
    v_exp_f32 v31, v31
    v_mfma_f32_32x32x8_bf16 v[48:63], a[74:75], a[248:249], 0
    buffer_load_dwordx4 v[140:143], v12, s[16:19], s5 offen offset:3072 sc1
    v_exp_f32 v32, v32
    v_exp_f32 v33, v33
    v_exp_f32 v34, v34
    v_exp_f32 v35, v35
    v_mfma_f32_32x32x16_bf16 v[48:63], a[40:43], a[240:243], v[48:63]
    v_exp_f32 v36, v36
    v_exp_f32 v37, v37
    v_exp_f32 v38, v38
    v_exp_f32 v39, v39
    v_smfmac_f32_32x32x32_bf16 a[208:223], a[152:155], v[16:23], v2
    buffer_load_dwordx4 a[188:191], v136, s[64:67], 0 offen offset:1920 sc1
    v_exp_f32 v40, v40
    v_exp_f32 v41, v41
    v_exp_f32 v42, v42
    v_exp_f32 v43, v43
    v_smfmac_f32_32x32x32_bf16 a[208:223], a[156:159], v[24:31], v2
    buffer_load_dwordx4 a[60:63], v138, s[64:67], 0 offen offset:3072 sc1
    v_exp_f32 v44, v44
    v_exp_f32 v45, v45
    v_exp_f32 v46, v46
    v_exp_f32 v47, v47
    v_mfma_f32_32x32x8_bf16 v[16:31], a[74:75], a[252:253], 0
    buffer_load_dwordx4 v[144:147], v221, s[16:19], s6 offen offset:3072 sc1
    v_exp_f32 v48, v48
    v_exp_f32 v49, v49
    v_exp_f32 v50, v50
    v_exp_f32 v51, v51
    v_mfma_f32_32x32x16_bf16 v[16:31], a[40:43], a[244:247], v[16:31]
    s_waitcnt vmcnt(15)
    v_exp_f32 v52, v52
    v_exp_f32 v53, v53
    v_exp_f32 v54, v54
    v_exp_f32 v55, v55
    v_smfmac_f32_32x32x32_bf16 a[224:239], a[152:155], v[32:39], v2
    buffer_load_dwordx4 a[192:195], v137, s[64:67], 0 offen offset:0 sc1
    v_exp_f32 v56, v56
    v_exp_f32 v57, v57
    v_exp_f32 v58, v58
    v_exp_f32 v59, v59
    v_smfmac_f32_32x32x32_bf16 a[224:239], a[156:159], v[40:47], v2
    buffer_load_dwordx4 a[196:199], v137, s[64:67], 0 offen offset:640 sc1
    v_exp_f32 v60, v60
    v_exp_f32 v61, v61
    v_exp_f32 v62, v62
    v_exp_f32 v63, v63
    v_mfma_f32_32x32x8_bf16 v[32:47], a[74:75], a[250:251], 0
    v_exp_f32 v16, v16
    v_exp_f32 v17, v17
    v_exp_f32 v18, v18
    v_exp_f32 v19, v19
    v_mfma_f32_32x32x16_bf16 v[32:47], a[44:47], a[240:243], v[32:47]
    s_waitcnt vmcnt(15)
    v_exp_f32 v20, v20
    v_exp_f32 v21, v21
    v_exp_f32 v22, v22
    v_exp_f32 v23, v23
    v_smfmac_f32_32x32x32_bf16 a[208:223], a[160:163], v[48:55], v2
    buffer_load_dwordx4 a[200:203], v137, s[64:67], 0 offen offset:1280 sc1
    v_exp_f32 v24, v24
    v_exp_f32 v25, v25
    v_exp_f32 v26, v26
    v_exp_f32 v27, v27
    v_smfmac_f32_32x32x32_bf16 a[208:223], a[164:167], v[56:63], v2
    buffer_load_dwordx4 a[204:207], v137, s[64:67], 0 offen offset:1920 sc1
    v_exp_f32 v28, v28
    v_exp_f32 v29, v29
    v_exp_f32 v30, v30
    v_exp_f32 v31, v31
    v_mfma_f32_32x32x8_bf16 v[48:63], a[74:75], a[254:255], 0
    v_exp_f32 v32, v32
    v_exp_f32 v33, v33
    v_exp_f32 v34, v34
    v_exp_f32 v35, v35
    v_mfma_f32_32x32x16_bf16 v[48:63], a[44:47], a[244:247], v[48:63]
    s_waitcnt vmcnt(15)
    v_exp_f32 v36, v36
    v_exp_f32 v37, v37
    v_exp_f32 v38, v38
    v_exp_f32 v39, v39
    v_smfmac_f32_32x32x32_bf16 a[224:239], a[160:163], v[16:23], v2
    s_add_u32 s38, s16, 2531328
    s_addc_u32 s39, s17, 0
    v_exp_f32 v40, v40
    v_exp_f32 v41, v41
    v_exp_f32 v42, v42
    v_exp_f32 v43, v43
    v_smfmac_f32_32x32x32_bf16 a[224:239], a[164:167], v[24:31], v2
    global_load_dwordx4 v[64:67], v6, s[38:39] offset:-4096 sc1
    global_load_dwordx4 v[68:71], v6, s[38:39] offset:-3072 sc1
    v_exp_f32 v44, v44
    v_exp_f32 v45, v45
    v_exp_f32 v46, v46
    v_exp_f32 v47, v47
    v_mfma_f32_32x32x8_bf16 v[16:31], a[76:77], a[248:249], 0
    v_exp_f32 v48, v48
    v_exp_f32 v49, v49
    v_exp_f32 v50, v50
    v_exp_f32 v51, v51
    v_mfma_f32_32x32x16_bf16 v[16:31], a[48:51], a[240:243], v[16:31]
    s_waitcnt vmcnt(14)
    buffer_store_dwordx4 v[228:231], v249, s[16:19], s45 offen sc1
    v_exp_f32 v52, v52
    v_exp_f32 v53, v53
    v_exp_f32 v54, v54
    v_exp_f32 v55, v55
    v_smfmac_f32_32x32x32_bf16 a[208:223], a[168:171], v[32:39], v2
    global_load_dwordx4 v[72:75], v6, s[38:39] offset:-2048 sc1
    v_exp_f32 v56, v56
    v_exp_f32 v57, v57
    v_exp_f32 v58, v58
    v_exp_f32 v59, v59
    v_smfmac_f32_32x32x32_bf16 a[208:223], a[172:175], v[40:47], v2
    global_load_dwordx4 v[76:79], v6, s[38:39] offset:-1024 sc1
    v_exp_f32 v60, v60
    v_exp_f32 v61, v61
    v_exp_f32 v62, v62
    v_exp_f32 v63, v63
    v_mfma_f32_32x32x8_bf16 v[32:47], a[76:77], a[250:251], 0
    v_exp_f32 v16, v16
    v_exp_f32 v17, v17
    v_exp_f32 v18, v18
    v_exp_f32 v19, v19
    v_mfma_f32_32x32x16_bf16 v[32:47], a[52:55], a[240:243], v[32:47]
    s_waitcnt vmcnt(14)
    s_waitcnt vmcnt(9)
    ds_write_b128 v223, v[140:143] offset:20864
    v_exp_f32 v20, v20
    v_exp_f32 v21, v21
    v_exp_f32 v22, v22
    v_exp_f32 v23, v23
    v_smfmac_f32_32x32x32_bf16 a[224:239], a[168:171], v[48:55], v2
    global_load_dwordx4 v[80:83], v6, s[38:39] offset:0 sc1
    v_exp_f32 v24, v24
    v_exp_f32 v25, v25
    v_exp_f32 v26, v26
    v_exp_f32 v27, v27
    v_smfmac_f32_32x32x32_bf16 a[224:239], a[172:175], v[56:63], v2
    global_load_dwordx4 v[84:87], v6, s[38:39] offset:1024 sc1
    v_exp_f32 v28, v28
    v_exp_f32 v29, v29
    v_exp_f32 v30, v30
    v_exp_f32 v31, v31
    v_mfma_f32_32x32x8_bf16 v[48:63], a[78:79], a[248:249], 0
    v_exp_f32 v32, v32
    v_exp_f32 v33, v33
    v_exp_f32 v34, v34
    v_exp_f32 v35, v35
    v_mfma_f32_32x32x16_bf16 v[48:63], a[56:59], a[240:243], v[48:63]
    ds_write_b128 v226, v[144:147] offset:21376
    v_exp_f32 v36, v36
    v_exp_f32 v37, v37
    v_exp_f32 v38, v38
    v_exp_f32 v39, v39
    v_smfmac_f32_32x32x32_bf16 a[208:223], a[176:179], v[16:23], v2
    global_load_dwordx4 v[88:91], v6, s[38:39] offset:2048 sc1
    v_exp_f32 v40, v40
    v_exp_f32 v41, v41
    v_exp_f32 v42, v42
    v_exp_f32 v43, v43
    v_smfmac_f32_32x32x32_bf16 a[208:223], a[180:183], v[24:31], v2
    global_load_dwordx4 v[92:95], v6, s[38:39] offset:3072 sc1
    v_exp_f32 v44, v44
    v_exp_f32 v45, v45
    v_exp_f32 v46, v46
    v_exp_f32 v47, v47
    v_mfma_f32_32x32x8_bf16 v[16:31], a[78:79], a[250:251], 0
    v_exp_f32 v48, v48
    v_exp_f32 v49, v49
    v_exp_f32 v50, v50
    v_exp_f32 v51, v51
    v_mfma_f32_32x32x16_bf16 v[16:31], a[60:63], a[240:243], v[16:31]
    s_waitcnt lgkmcnt(0)
    s_barrier
    v_exp_f32 v52, v52
    v_exp_f32 v53, v53
    v_exp_f32 v54, v54
    v_exp_f32 v55, v55
    v_smfmac_f32_32x32x32_bf16 a[208:223], a[184:187], v[32:39], v2
    s_add_u32 s38, s16, 2539520
    s_addc_u32 s39, s17, 0
    v_exp_f32 v56, v56
    v_exp_f32 v57, v57
    v_exp_f32 v58, v58
    v_exp_f32 v59, v59
    v_smfmac_f32_32x32x32_bf16 a[208:223], a[188:191], v[40:47], v2
    global_load_dwordx4 v[96:99], v6, s[38:39] offset:-4096 sc1
    global_load_dwordx4 v[100:103], v6, s[38:39] offset:-3072 sc1
    v_exp_f32 v60, v60
    v_exp_f32 v61, v61
    v_exp_f32 v62, v62
    v_exp_f32 v63, v63
    v_mfma_f32_32x32x8_bf16 v[32:47], a[76:77], a[252:253], 0
    v_exp_f32 v16, v16
    v_exp_f32 v17, v17
    v_exp_f32 v18, v18
    v_exp_f32 v19, v19
    v_mfma_f32_32x32x16_bf16 v[32:47], a[48:51], a[244:247], v[32:47]
    s_waitcnt vmcnt(13)
    ds_read2_b32 a[240:241], v4 offset0:72 offset1:73
    v_exp_f32 v20, v20
    v_exp_f32 v21, v21
    v_exp_f32 v22, v22
    v_exp_f32 v23, v23
    v_smfmac_f32_32x32x32_bf16 a[208:223], a[192:195], v[48:55], v2
    global_load_dwordx4 v[104:107], v6, s[38:39] offset:-2048 sc1
    ds_read2_b32 a[242:243], v4 offset0:74 offset1:75
    v_exp_f32 v24, v24
    v_exp_f32 v25, v25
    v_exp_f32 v26, v26
    v_exp_f32 v27, v27
    v_smfmac_f32_32x32x32_bf16 a[208:223], a[196:199], v[56:63], v2
    global_load_dwordx4 v[108:111], v6, s[38:39] offset:-1024 sc1
    ds_read_b32 a248, v5 offset:288
    v_exp_f32 v28, v28
    v_exp_f32 v29, v29
    v_exp_f32 v30, v30
    v_exp_f32 v31, v31
    v_mfma_f32_32x32x8_bf16 v[48:63], a[76:77], a[254:255], 0
    v_exp_f32 v32, v32
    v_exp_f32 v33, v33
    v_exp_f32 v34, v34
    v_exp_f32 v35, v35
    v_mfma_f32_32x32x16_bf16 v[48:63], a[52:55], a[244:247], v[48:63]
    s_waitcnt vmcnt(13)
    ds_read_b32 a251, v5 offset:288
    v_exp_f32 v36, v36
    v_exp_f32 v37, v37
    v_exp_f32 v38, v38
    v_exp_f32 v39, v39
    v_smfmac_f32_32x32x32_bf16 a[208:223], a[200:203], v[16:23], v2
    global_load_dwordx4 v[112:115], v6, s[38:39] offset:0 sc1
    v_exp_f32 v40, v40
    v_exp_f32 v41, v41
    v_exp_f32 v42, v42
    v_exp_f32 v43, v43
    v_smfmac_f32_32x32x32_bf16 a[208:223], a[204:207], v[24:31], v2
    global_load_dwordx4 v[116:119], v6, s[38:39] offset:1024 sc1
    v_exp_f32 v44, v44
    v_exp_f32 v45, v45
    v_exp_f32 v46, v46
    v_exp_f32 v47, v47
    v_mfma_f32_32x32x8_bf16 v[16:31], a[78:79], a[252:253], 0
    v_exp_f32 v48, v48
    v_exp_f32 v49, v49
    v_exp_f32 v50, v50
    v_exp_f32 v51, v51
    v_mfma_f32_32x32x16_bf16 v[16:31], a[56:59], a[244:247], v[16:31]
    buffer_store_dwordx4 v[228:231], v12, s[16:19], s36 offen sc1
    v_exp_f32 v52, v52
    v_exp_f32 v53, v53
    v_exp_f32 v54, v54
    v_exp_f32 v55, v55
    v_smfmac_f32_32x32x32_bf16 a[224:239], a[176:179], v[32:39], v2
    global_load_dwordx4 v[120:123], v6, s[38:39] offset:2048 sc1
    ds_write_b128 v7, a[208:211]
    v_exp_f32 v56, v56
    v_exp_f32 v57, v57
    v_exp_f32 v58, v58
    v_exp_f32 v59, v59
    v_smfmac_f32_32x32x32_bf16 a[224:239], a[180:183], v[40:47], v2
    global_load_dwordx4 v[124:127], v6, s[38:39] offset:3072 sc1
    ds_write_b128 v7, a[212:215] offset:1024
    v_exp_f32 v60, v60
    v_exp_f32 v61, v61
    v_exp_f32 v62, v62
    v_exp_f32 v63, v63
    v_mfma_f32_32x32x8_bf16 v[32:47], a[78:79], a[254:255], 0
    v_exp_f32 v16, v16
    v_exp_f32 v17, v17
    v_exp_f32 v18, v18
    v_exp_f32 v19, v19
    v_mfma_f32_32x32x16_bf16 v[32:47], a[60:63], a[244:247], v[32:47]
    ds_write_b64 v8, a[216:217]
    v_exp_f32 v20, v20
    v_exp_f32 v21, v21
    v_exp_f32 v22, v22
    v_exp_f32 v23, v23
    v_smfmac_f32_32x32x32_bf16 a[224:239], a[184:187], v[48:55], v2
    s_add_u32 s38, s16, 2547712
    s_addc_u32 s39, s17, 0
    buffer_store_dwordx4 v[228:231], v12, s[16:19], s37 offen sc1
    v_exp_f32 v24, v24
    v_exp_f32 v25, v25
    v_exp_f32 v26, v26
    v_exp_f32 v27, v27
    v_smfmac_f32_32x32x32_bf16 a[224:239], a[188:191], v[56:63], v2
    s_waitcnt lgkmcnt(3)
    global_load_dwordx4 v[128:131], v6, s[38:39] offset:-4096 sc1
    global_load_dwordx4 v[132:135], v6, s[38:39] offset:-3072 sc1
    s_waitcnt lgkmcnt(0)
    s_barrier
    v_exp_f32 v28, v28
    v_exp_f32 v29, v29
    v_exp_f32 v30, v30
    v_exp_f32 v31, v31
    v_mfma_f32_32x32x8_bf16 v[48:63], a[64:65], a[248:249], 0
    v_exp_f32 v32, v32
    v_exp_f32 v33, v33
    v_exp_f32 v34, v34
    v_exp_f32 v35, v35
    v_mfma_f32_32x32x16_bf16 v[48:63], a[0:3], a[240:243], v[48:63]
    ds_read2st64_b64 v[220:223], v10 offset0:4 offset1:9
    v_exp_f32 v36, v36
    v_exp_f32 v37, v37
    v_exp_f32 v38, v38
    v_smfmac_f32_32x32x32_bf16 a[224:239], a[192:195], v[16:23], v2
    ds_read2st64_b64 v[224:227], v10 offset0:14 offset1:19
    v_exp_f32 v39, v39
    v_exp_f32 v40, v40
    v_exp_f32 v41, v41
    v_mfma_f32_32x32x8_bf16 a[208:223], v[14:15], v[14:15], 0
    v_exp_f32 v42, v42
    v_exp_f32 v43, v43
    v_exp_f32 v44, v44
    v_smfmac_f32_32x32x32_bf16 a[224:239], a[196:199], v[24:31], v2
    ds_read2st64_b64 v[212:215], v9 offset0:0 offset1:5
    v_exp_f32 v45, v45
    v_exp_f32 v46, v46
    v_exp_f32 v47, v47
    v_mfma_f32_32x32x8_bf16 v[16:31], a[64:65], a[250:251], 0
    v_exp_f32 v48, v48
    v_exp_f32 v49, v49
    v_exp_f32 v50, v50
    v_exp_f32 v51, v51
    v_mfma_f32_32x32x16_bf16 v[16:31], a[4:7], a[240:243], v[16:31]
    ds_read2st64_b64 v[216:219], v9 offset0:10 offset1:15
    v_exp_f32 v52, v52
    v_exp_f32 v53, v53
    v_exp_f32 v54, v54
    v_exp_f32 v55, v55
    v_smfmac_f32_32x32x32_bf16 a[224:239], a[200:203], v[32:39], v2
    s_waitcnt lgkmcnt(1)
    v_exp_f32 v56, v56
    v_exp_f32 v57, v57
    v_exp_f32 v58, v58
    v_exp_f32 v59, v59
    v_pk_add_f32 v[220:221], v[220:221], v[222:223]
    v_pk_add_f32 v[224:225], v[224:225], v[226:227]
    v_pk_add_f32 v[212:213], v[212:213], v[214:215]
    v_pk_add_f32 v[220:221], v[220:221], v[224:225]
    v_smfmac_f32_32x32x32_bf16 a[224:239], a[204:207], v[40:47], v2
    s_waitcnt lgkmcnt(0)
    v_exp_f32 v60, v60
    v_exp_f32 v61, v61
    v_rcp_f32 v222, v221
    v_subrev_u32 v223, s42, v221
    v_exp_f32 v62, v62
    v_exp_f32 v63, v63
    v_pk_add_f32 v[216:217], v[216:217], v[218:219]
    v_mul_f32 v236, v220, v222
    v_pk_add_f32 v[212:213], v[212:213], v[216:217]
    v_max_u32 v13, v13, v223
    v_pk_mul_f32 v[212:213], v[212:213], v[222:223] op_sel_hi:[1,0]
    v_cvt_pk_bf16_f32 v212, v212, v213
    v_mfma_f32_32x32x8_bf16 v[32:47], a[66:67], a[248:249], 0
    v_exp_f32 v16, v16
    v_exp_f32 v17, v17
    v_exp_f32 v18, v18
    v_exp_f32 v19, v19
    v_mfma_f32_32x32x16_bf16 v[32:47], a[8:11], a[240:243], v[32:47]
    ds_write_b32 v11, v212
    v_exp_f32 v20, v20
    v_exp_f32 v21, v21
    v_exp_f32 v22, v22
    v_exp_f32 v23, v23
    v_smfmac_f32_32x32x32_bf16 a[208:223], a[80:83], v[48:55], v2
    buffer_store_dwordx4 v[228:231], v12, s[16:19], s44 offen sc1
    v_exp_f32 v24, v24
    v_exp_f32 v25, v25
    v_exp_f32 v26, v26
    v_exp_f32 v27, v27
    v_smfmac_f32_32x32x32_bf16 a[208:223], a[84:87], v[56:63], v2
    s_waitcnt lgkmcnt(0)
    s_barrier
    v_exp_f32 v28, v28
    v_exp_f32 v29, v29
    v_exp_f32 v30, v30
    v_exp_f32 v31, v31
    v_mfma_f32_32x32x8_bf16 v[48:63], a[66:67], a[250:251], 0
    v_exp_f32 v32, v32
    v_exp_f32 v33, v33
    v_exp_f32 v34, v34
    v_exp_f32 v35, v35
    v_mfma_f32_32x32x16_bf16 v[48:63], a[12:15], a[240:243], v[48:63]
    ds_read_b128 v[228:231], v12 offset:10240
    v_exp_f32 v36, v36
    v_exp_f32 v37, v37
    v_exp_f32 v38, v38
    v_exp_f32 v39, v39
    v_smfmac_f32_32x32x32_bf16 a[208:223], a[88:91], v[16:23], v2
    s_add_u32 s40, s16, 2605056
    s_addc_u32 s41, s17, 0
    v_exp_f32 v40, v40
    v_exp_f32 v41, v41
    v_exp_f32 v42, v42
    v_exp_f32 v43, v43
    v_smfmac_f32_32x32x32_bf16 a[208:223], a[92:95], v[24:31], v2
    v_exp_f32 v44, v44
    v_exp_f32 v45, v45
    v_exp_f32 v46, v46
    v_exp_f32 v47, v47
    v_mfma_f32_32x32x8_bf16 v[16:31], a[68:69], a[248:249], 0
    v_exp_f32 v48, v48
    v_exp_f32 v49, v49
    v_exp_f32 v50, v50
    v_exp_f32 v51, v51
    v_mfma_f32_32x32x16_bf16 v[16:31], a[16:19], a[240:243], v[16:31]
    s_waitcnt vmcnt(15) lgkmcnt(0)
    v_exp_f32 v52, v52
    v_exp_f32 v53, v53
    v_exp_f32 v54, v54
    v_smfmac_f32_16x16x64_bf16 v[176:179], v[228:231], v[64:71], v3
    global_load_dwordx4 v[64:67], v6, s[40:41] offset:-4096 sc1
    global_load_dwordx4 v[68:71], v6, s[40:41] offset:-3072 sc1
    v_exp_f32 v55, v55
    v_smfmac_f32_32x32x32_bf16 a[208:223], a[96:99], v[32:39], v2
    ds_read2_b32 a[244:245], v4 offset0:108 offset1:109
    v_exp_f32 v56, v56
    v_exp_f32 v57, v57
    v_exp_f32 v58, v58
    v_exp_f32 v59, v59
    v_smfmac_f32_32x32x32_bf16 a[208:223], a[100:103], v[40:47], v2
    ds_read2_b32 a[246:247], v4 offset0:110 offset1:111
    v_exp_f32 v60, v60
    v_exp_f32 v61, v61
    v_exp_f32 v62, v62
    v_exp_f32 v63, v63
    v_mfma_f32_32x32x8_bf16 v[32:47], a[68:69], a[250:251], 0
    v_exp_f32 v16, v16
    v_exp_f32 v17, v17
    v_exp_f32 v18, v18
    v_exp_f32 v19, v19
    v_mfma_f32_32x32x16_bf16 v[32:47], a[20:23], a[240:243], v[32:47]
    ds_read_b32 a252, v5 offset:432
    v_exp_f32 v20, v20
    v_exp_f32 v21, v21
    v_exp_f32 v22, v22
    v_smfmac_f32_16x16x64_bf16 v[180:183], v[228:231], v[72:79], v3
    global_load_dwordx4 v[72:75], v6, s[40:41] offset:-2048 sc1
    global_load_dwordx4 v[76:79], v6, s[40:41] offset:-1024 sc1
    v_exp_f32 v23, v23
    v_smfmac_f32_32x32x32_bf16 a[208:223], a[104:107], v[48:55], v2
    ds_read_b32 a255, v5 offset:432
    v_exp_f32 v24, v24
    v_exp_f32 v25, v25
    v_exp_f32 v26, v26
    v_exp_f32 v27, v27
    v_smfmac_f32_32x32x32_bf16 a[208:223], a[108:111], v[56:63], v2
    v_exp_f32 v28, v28
    v_exp_f32 v29, v29
    v_exp_f32 v30, v30
    v_exp_f32 v31, v31
    v_mfma_f32_32x32x8_bf16 v[48:63], a[70:71], a[248:249], 0
    v_exp_f32 v32, v32
    v_exp_f32 v33, v33
    v_exp_f32 v34, v34
    v_exp_f32 v35, v35
    v_mfma_f32_32x32x16_bf16 v[48:63], a[24:27], a[240:243], v[48:63]
    v_exp_f32 v36, v36
    v_exp_f32 v37, v37
    v_exp_f32 v38, v38
    v_smfmac_f32_16x16x64_bf16 v[184:187], v[228:231], v[80:87], v3
    global_load_dwordx4 v[80:83], v6, s[40:41] offset:0 sc1
    global_load_dwordx4 v[84:87], v6, s[40:41] offset:1024 sc1
    v_exp_f32 v39, v39
    v_smfmac_f32_32x32x32_bf16 a[208:223], a[112:115], v[16:23], v2
    v_exp_f32 v40, v40
    v_exp_f32 v41, v41
    v_exp_f32 v42, v42
    v_exp_f32 v43, v43
    v_smfmac_f32_32x32x32_bf16 a[208:223], a[116:119], v[24:31], v2
    v_exp_f32 v44, v44
    v_exp_f32 v45, v45
    v_exp_f32 v46, v46
    v_exp_f32 v47, v47
    v_mfma_f32_32x32x8_bf16 v[16:31], a[70:71], a[250:251], 0
    v_exp_f32 v48, v48
    v_exp_f32 v49, v49
    v_exp_f32 v50, v50
    v_exp_f32 v51, v51
    v_mfma_f32_32x32x16_bf16 v[16:31], a[28:31], a[240:243], v[16:31]
    s_waitcnt vmcnt(15)
    v_exp_f32 v52, v52
    v_exp_f32 v53, v53
    v_exp_f32 v54, v54
    v_smfmac_f32_16x16x64_bf16 v[188:191], v[228:231], v[88:95], v3
    global_load_dwordx4 v[88:91], v6, s[40:41] offset:2048 sc1
    global_load_dwordx4 v[92:95], v6, s[40:41] offset:3072 sc1
    v_exp_f32 v55, v55
    v_smfmac_f32_32x32x32_bf16 a[208:223], a[120:123], v[32:39], v2
    s_add_u32 s40, s16, 2613248
    s_addc_u32 s41, s17, 0
    v_exp_f32 v56, v56
    v_exp_f32 v57, v57
    v_exp_f32 v58, v58
    v_exp_f32 v59, v59
    v_smfmac_f32_32x32x32_bf16 a[208:223], a[124:127], v[40:47], v2
    v_exp_f32 v60, v60
    v_exp_f32 v61, v61
    v_exp_f32 v62, v62
    v_exp_f32 v63, v63
    v_mfma_f32_32x32x8_bf16 v[32:47], a[72:73], a[248:249], 0
    v_exp_f32 v16, v16
    v_exp_f32 v17, v17
    v_exp_f32 v18, v18
    v_exp_f32 v19, v19
    v_mfma_f32_32x32x16_bf16 v[32:47], a[32:35], a[240:243], v[32:47]
    v_exp_f32 v20, v20
    v_exp_f32 v21, v21
    v_exp_f32 v22, v22
    v_smfmac_f32_16x16x64_bf16 v[192:195], v[228:231], v[96:103], v3
    global_load_dwordx4 v[96:99], v6, s[40:41] offset:-4096 sc1
    global_load_dwordx4 v[100:103], v6, s[40:41] offset:-3072 sc1
    v_exp_f32 v23, v23
    v_smfmac_f32_32x32x32_bf16 a[208:223], a[128:131], v[48:55], v2
    ds_write_b128 v7, a[224:227]
    v_exp_f32 v24, v24
    v_exp_f32 v25, v25
    v_exp_f32 v26, v26
    v_exp_f32 v27, v27
    v_smfmac_f32_32x32x32_bf16 a[208:223], a[132:135], v[56:63], v2
    ds_write_b128 v7, a[228:231] offset:1024
    v_exp_f32 v28, v28
    v_exp_f32 v29, v29
    v_exp_f32 v30, v30
    v_exp_f32 v31, v31
    v_mfma_f32_32x32x8_bf16 v[48:63], a[72:73], a[250:251], 0
    v_exp_f32 v32, v32
    v_exp_f32 v33, v33
    v_exp_f32 v34, v34
    v_exp_f32 v35, v35
    v_mfma_f32_32x32x16_bf16 v[48:63], a[36:39], a[240:243], v[48:63]
    ds_write_b64 v8, a[232:233]
    v_exp_f32 v36, v36
    v_exp_f32 v37, v37
    v_exp_f32 v38, v38
    v_smfmac_f32_16x16x64_bf16 v[196:199], v[228:231], v[104:111], v3
    global_load_dwordx4 v[104:107], v6, s[40:41] offset:-2048 sc1
    global_load_dwordx4 v[108:111], v6, s[40:41] offset:-1024 sc1
    v_exp_f32 v39, v39
    v_smfmac_f32_32x32x32_bf16 a[208:223], a[136:139], v[16:23], v2
    v_exp_f32 v40, v40
    v_exp_f32 v41, v41
    v_exp_f32 v42, v42
    v_exp_f32 v43, v43
    v_smfmac_f32_32x32x32_bf16 a[208:223], a[140:143], v[24:31], v2
    s_waitcnt lgkmcnt(0)
    s_barrier
    v_exp_f32 v44, v44
    v_exp_f32 v45, v45
    v_exp_f32 v46, v46
    v_exp_f32 v47, v47
    v_mfma_f32_32x32x8_bf16 v[16:31], a[74:75], a[248:249], 0
    v_exp_f32 v48, v48
    v_exp_f32 v49, v49
    v_exp_f32 v50, v50
    v_exp_f32 v51, v51
    v_mfma_f32_32x32x16_bf16 v[16:31], a[40:43], a[240:243], v[16:31]
    s_waitcnt vmcnt(13)
    ds_read2st64_b64 v[220:223], v10 offset0:4 offset1:9
    v_exp_f32 v52, v52
    v_exp_f32 v53, v53
    v_exp_f32 v54, v54
    v_smfmac_f32_16x16x64_bf16 v[200:203], v[228:231], v[112:119], v3
    global_load_dwordx4 v[112:115], v6, s[40:41] offset:0 sc1
    global_load_dwordx4 v[116:119], v6, s[40:41] offset:1024 sc1
    v_exp_f32 v55, v55
    v_smfmac_f32_32x32x32_bf16 a[208:223], a[144:147], v[32:39], v2
    ds_read2st64_b64 v[224:227], v10 offset0:14 offset1:19
    v_exp_f32 v56, v56
    v_exp_f32 v57, v57
    v_exp_f32 v58, v58
    v_mfma_f32_32x32x8_bf16 a[224:239], v[14:15], v[14:15], 0
    v_exp_f32 v59, v59
    v_exp_f32 v60, v60
    v_smfmac_f32_32x32x32_bf16 a[208:223], a[148:151], v[40:47], v2
    ds_read2st64_b64 v[212:215], v9 offset0:0 offset1:5
    v_exp_f32 v61, v61
    v_exp_f32 v62, v62
    v_exp_f32 v63, v63
    v_mfma_f32_32x32x8_bf16 v[32:47], a[74:75], a[250:251], 0
    v_exp_f32 v16, v16
    v_exp_f32 v17, v17
    v_exp_f32 v18, v18
    v_exp_f32 v19, v19
    v_mfma_f32_32x32x16_bf16 v[32:47], a[44:47], a[240:243], v[32:47]
    ds_read2st64_b64 v[216:219], v9 offset0:10 offset1:15
    v_exp_f32 v20, v20
    v_exp_f32 v21, v21
    v_exp_f32 v22, v22
    v_smfmac_f32_16x16x64_bf16 v[204:207], v[228:231], v[120:127], v3
    global_load_dwordx4 v[120:123], v6, s[40:41] offset:2048 sc1
    global_load_dwordx4 v[124:127], v6, s[40:41] offset:3072 sc1
    v_exp_f32 v23, v23
    v_smfmac_f32_32x32x32_bf16 a[208:223], a[152:155], v[48:55], v2
    s_waitcnt lgkmcnt(1)
    s_add_u32 s40, s16, 2621440
    s_addc_u32 s41, s17, 0
    v_exp_f32 v24, v24
    v_exp_f32 v25, v25
    v_exp_f32 v26, v26
    v_exp_f32 v27, v27
    v_pk_add_f32 v[220:221], v[220:221], v[222:223]
    v_pk_add_f32 v[224:225], v[224:225], v[226:227]
    v_pk_add_f32 v[212:213], v[212:213], v[214:215]
    v_pk_add_f32 v[220:221], v[220:221], v[224:225]
    v_smfmac_f32_32x32x32_bf16 a[208:223], a[156:159], v[56:63], v2
    s_waitcnt lgkmcnt(0)
    v_exp_f32 v28, v28
    v_exp_f32 v29, v29
    v_rcp_f32 v222, v221
    v_subrev_u32 v223, s42, v221
    v_exp_f32 v30, v30
    v_exp_f32 v31, v31
    v_pk_add_f32 v[216:217], v[216:217], v[218:219]
    v_mul_f32 v237, v220, v222
    v_pk_add_f32 v[212:213], v[212:213], v[216:217]
    v_max_u32 v13, v13, v223
    v_pk_mul_f32 v[212:213], v[212:213], v[222:223] op_sel_hi:[1,0]
    v_cvt_pk_bf16_f32 v212, v212, v213
    v_mfma_f32_32x32x8_bf16 v[48:63], a[76:77], a[248:249], 0
    v_exp_f32 v32, v32
    v_exp_f32 v33, v33
    v_exp_f32 v34, v34
    v_exp_f32 v35, v35
    v_mfma_f32_32x32x16_bf16 v[48:63], a[48:51], a[240:243], v[48:63]
    ds_write_b32 v11, v212
    v_exp_f32 v36, v36
    v_exp_f32 v37, v37
    v_cvt_pk_bf16_f32 v232, v236, v237
    v_exp_f32 v38, v38
    v_smfmac_f32_16x16x64_bf16 v[208:211], v[228:231], v[128:135], v3
    global_load_dwordx4 v[128:131], v6, s[40:41] offset:-4096 sc1
    global_load_dwordx4 v[132:135], v6, s[40:41] offset:-3072 sc1
    v_exp_f32 v39, v39
    v_smfmac_f32_32x32x32_bf16 a[208:223], a[160:163], v[16:23], v2
    v_exp_f32 v40, v40
    v_exp_f32 v41, v41
    v_exp_f32 v42, v42
    v_exp_f32 v43, v43
    v_smfmac_f32_32x32x32_bf16 a[208:223], a[164:167], v[24:31], v2
    s_waitcnt lgkmcnt(0)
    s_barrier
    v_exp_f32 v44, v44
    v_exp_f32 v45, v45
    v_exp_f32 v46, v46
    v_exp_f32 v47, v47
    v_mfma_f32_32x32x8_bf16 v[16:31], a[76:77], a[250:251], 0
    v_exp_f32 v48, v48
    v_exp_f32 v49, v49
    v_exp_f32 v50, v50
    v_exp_f32 v51, v51
    v_mfma_f32_32x32x16_bf16 v[16:31], a[52:55], a[240:243], v[16:31]
    ds_read_b128 v[228:231], v12 offset:10240
    v_exp_f32 v52, v52
    v_exp_f32 v53, v53
    v_exp_f32 v54, v54
    v_exp_f32 v55, v55
    v_smfmac_f32_32x32x32_bf16 a[208:223], a[168:171], v[32:39], v2
    s_add_u32 s40, s16, 2678784
    s_addc_u32 s41, s17, 0
    s_add_u32 s38, s16, 3121152
    s_addc_u32 s39, s17, 0
    v_exp_f32 v56, v56
    v_exp_f32 v57, v57
    v_exp_f32 v58, v58
    v_exp_f32 v59, v59
    v_smfmac_f32_32x32x32_bf16 a[208:223], a[172:175], v[40:47], v2
    global_load_dwordx4 v[136:139], v6, s[38:39] offset:-4096 sc1
    global_load_dwordx4 v[140:143], v6, s[38:39] offset:-3072 sc1
    v_exp_f32 v60, v60
    v_exp_f32 v61, v61
    v_exp_f32 v62, v62
    v_exp_f32 v63, v63
    v_mfma_f32_32x32x8_bf16 v[32:47], a[78:79], a[248:249], 0
    v_exp_f32 v16, v16
    v_exp_f32 v17, v17
    v_exp_f32 v18, v18
    v_exp_f32 v19, v19
    v_mfma_f32_32x32x16_bf16 v[32:47], a[56:59], a[240:243], v[32:47]
    s_waitcnt vmcnt(14) lgkmcnt(0)
    v_exp_f32 v20, v20
    v_exp_f32 v21, v21
    v_exp_f32 v22, v22
    v_smfmac_f32_16x16x64_bf16 v[176:179], v[228:231], v[64:71], v3
    global_load_dwordx4 v[64:67], v6, s[40:41] offset:-4096 sc1
    global_load_dwordx4 v[68:71], v6, s[40:41] offset:-3072 sc1
    v_exp_f32 v23, v23
    v_smfmac_f32_32x32x32_bf16 a[208:223], a[176:179], v[48:55], v2
    v_exp_f32 v24, v24
    v_exp_f32 v25, v25
    v_exp_f32 v26, v26
    v_exp_f32 v27, v27
    v_smfmac_f32_32x32x32_bf16 a[208:223], a[180:183], v[56:63], v2
    v_exp_f32 v28, v28
    v_exp_f32 v29, v29
    v_exp_f32 v30, v30
    v_exp_f32 v31, v31
    v_mfma_f32_32x32x8_bf16 v[48:63], a[78:79], a[250:251], 0
    v_exp_f32 v32, v32
    v_exp_f32 v33, v33
    v_exp_f32 v34, v34
    v_exp_f32 v35, v35
    v_mfma_f32_32x32x16_bf16 v[48:63], a[60:63], a[240:243], v[48:63]
    v_exp_f32 v36, v36
    v_exp_f32 v37, v37
    v_exp_f32 v38, v38
    v_smfmac_f32_16x16x64_bf16 v[180:183], v[228:231], v[72:79], v3
    global_load_dwordx4 v[72:75], v6, s[40:41] offset:-2048 sc1
    global_load_dwordx4 v[76:79], v6, s[40:41] offset:-1024 sc1
    v_exp_f32 v39, v39
    v_smfmac_f32_32x32x32_bf16 a[208:223], a[184:187], v[16:23], v2
    v_exp_f32 v40, v40
    v_exp_f32 v41, v41
    v_exp_f32 v42, v42
    v_exp_f32 v43, v43
    v_smfmac_f32_32x32x32_bf16 a[208:223], a[188:191], v[24:31], v2
    v_exp_f32 v44, v44
    v_exp_f32 v45, v45
    v_exp_f32 v46, v46
    v_exp_f32 v47, v47
    v_mfma_f32_32x32x8_bf16 v[16:31], a[64:65], a[252:253], 0
    v_exp_f32 v48, v48
    v_exp_f32 v49, v49
    v_exp_f32 v50, v50
    v_exp_f32 v51, v51
    v_mfma_f32_32x32x16_bf16 v[16:31], a[0:3], a[244:247], v[16:31]
    v_exp_f32 v52, v52
    v_exp_f32 v53, v53
    v_exp_f32 v54, v54
    v_smfmac_f32_16x16x64_bf16 v[184:187], v[228:231], v[80:87], v3
    global_load_dwordx4 v[80:83], v6, s[40:41] offset:0 sc1
    global_load_dwordx4 v[84:87], v6, s[40:41] offset:1024 sc1
    v_exp_f32 v55, v55
    v_smfmac_f32_32x32x32_bf16 a[208:223], a[192:195], v[32:39], v2
    v_exp_f32 v56, v56
    v_exp_f32 v57, v57
    v_exp_f32 v58, v58
    v_exp_f32 v59, v59
    v_smfmac_f32_32x32x32_bf16 a[208:223], a[196:199], v[40:47], v2
    v_exp_f32 v60, v60
L_padb1:
    s_cbranch_execz L_padb5
    v_exp_f32 v61, v61
    v_exp_f32 v62, v62
    v_exp_f32 v63, v63
    v_mfma_f32_32x32x8_bf16 v[32:47], a[64:65], a[254:255], 0
    v_exp_f32 v16, v16
    v_exp_f32 v17, v17
    v_exp_f32 v18, v18
    v_exp_f32 v19, v19
    v_mfma_f32_32x32x16_bf16 v[32:47], a[4:7], a[244:247], v[32:47]
    s_waitcnt vmcnt(14)
    v_exp_f32 v20, v20
    v_exp_f32 v21, v21
    v_exp_f32 v22, v22
    v_smfmac_f32_16x16x64_bf16 v[188:191], v[228:231], v[88:95], v3
    global_load_dwordx4 v[88:91], v6, s[40:41] offset:2048 sc1
    global_load_dwordx4 v[92:95], v6, s[40:41] offset:3072 sc1
    v_exp_f32 v23, v23
    v_smfmac_f32_32x32x32_bf16 a[208:223], a[200:203], v[48:55], v2
    s_add_u32 s40, s16, 2686976
    s_addc_u32 s41, s17, 0
    v_exp_f32 v24, v24
    v_exp_f32 v25, v25
    v_exp_f32 v26, v26
    v_exp_f32 v27, v27
    v_smfmac_f32_32x32x32_bf16 a[208:223], a[204:207], v[56:63], v2
    v_exp_f32 v28, v28
    v_exp_f32 v29, v29
    v_exp_f32 v30, v30
    v_exp_f32 v31, v31
    v_mfma_f32_32x32x8_bf16 v[48:63], a[66:67], a[252:253], 0
    v_exp_f32 v32, v32
    v_exp_f32 v33, v33
    v_exp_f32 v34, v34
    v_exp_f32 v35, v35
    v_mfma_f32_32x32x16_bf16 v[48:63], a[8:11], a[244:247], v[48:63]
    v_exp_f32 v36, v36
    v_exp_f32 v37, v37
    v_exp_f32 v38, v38
    v_smfmac_f32_16x16x64_bf16 v[192:195], v[228:231], v[96:103], v3
    global_load_dwordx4 v[96:99], v6, s[40:41] offset:-4096 sc1
    global_load_dwordx4 v[100:103], v6, s[40:41] offset:-3072 sc1
    v_exp_f32 v39, v39
    v_smfmac_f32_32x32x32_bf16 a[224:239], a[80:83], v[16:23], v2
    ds_write_b128 v7, a[208:211]
    v_exp_f32 v40, v40
    v_exp_f32 v41, v41
    v_exp_f32 v42, v42
    v_exp_f32 v43, v43
    v_smfmac_f32_32x32x32_bf16 a[224:239], a[84:87], v[24:31], v2
    ds_write_b128 v7, a[212:215] offset:1024
    v_exp_f32 v44, v44
    v_exp_f32 v45, v45
    v_exp_f32 v46, v46
    v_exp_f32 v47, v47
    v_mfma_f32_32x32x8_bf16 v[16:31], a[66:67], a[254:255], 0
    v_exp_f32 v48, v48
    v_exp_f32 v49, v49
    v_exp_f32 v50, v50
    v_exp_f32 v51, v51
    v_mfma_f32_32x32x16_bf16 v[16:31], a[12:15], a[244:247], v[16:31]
    ds_write_b64 v8, a[216:217]
    v_exp_f32 v52, v52
    v_exp_f32 v53, v53
    v_exp_f32 v54, v54
    v_smfmac_f32_16x16x64_bf16 v[196:199], v[228:231], v[104:111], v3
    global_load_dwordx4 v[104:107], v6, s[40:41] offset:-2048 sc1
    global_load_dwordx4 v[108:111], v6, s[40:41] offset:-1024 sc1
    v_exp_f32 v55, v55
    v_smfmac_f32_32x32x32_bf16 a[224:239], a[88:91], v[32:39], v2
    v_exp_f32 v56, v56
    v_exp_f32 v57, v57
    v_exp_f32 v58, v58
    v_exp_f32 v59, v59
    v_smfmac_f32_32x32x32_bf16 a[224:239], a[92:95], v[40:47], v2
    s_waitcnt lgkmcnt(0)
    s_barrier
    v_exp_f32 v60, v60
    v_exp_f32 v61, v61
    v_exp_f32 v62, v62
    v_exp_f32 v63, v63
    v_mfma_f32_32x32x8_bf16 v[32:47], a[68:69], a[252:253], 0
    v_exp_f32 v16, v16
    v_exp_f32 v17, v17
    v_exp_f32 v18, v18
    v_exp_f32 v19, v19
    v_mfma_f32_32x32x16_bf16 v[32:47], a[16:19], a[244:247], v[32:47]
    s_waitcnt vmcnt(14)
    ds_read2st64_b64 v[220:223], v10 offset0:4 offset1:9
    v_exp_f32 v20, v20
    v_exp_f32 v21, v21
    v_exp_f32 v22, v22
    v_smfmac_f32_16x16x64_bf16 v[200:203], v[228:231], v[112:119], v3
    global_load_dwordx4 v[112:115], v6, s[40:41] offset:0 sc1
    global_load_dwordx4 v[116:119], v6, s[40:41] offset:1024 sc1
    v_exp_f32 v23, v23
    v_smfmac_f32_32x32x32_bf16 a[224:239], a[96:99], v[48:55], v2
    ds_read2st64_b64 v[224:227], v10 offset0:14 offset1:19
    v_exp_f32 v24, v24
    v_exp_f32 v25, v25
    v_exp_f32 v26, v26
    v_mfma_f32_32x32x8_bf16 a[208:223], v[14:15], v[14:15], 0
    v_exp_f32 v27, v27
    v_exp_f32 v28, v28
    v_smfmac_f32_32x32x32_bf16 a[224:239], a[100:103], v[56:63], v2
    ds_read2st64_b64 v[212:215], v9 offset0:0 offset1:5
    v_exp_f32 v29, v29
    v_exp_f32 v30, v30
    v_exp_f32 v31, v31
    v_mfma_f32_32x32x8_bf16 v[48:63], a[68:69], a[254:255], 0
    v_exp_f32 v32, v32
    v_exp_f32 v33, v33
    v_exp_f32 v34, v34
    v_exp_f32 v35, v35
    v_mfma_f32_32x32x16_bf16 v[48:63], a[20:23], a[244:247], v[48:63]
    ds_read2st64_b64 v[216:219], v9 offset0:10 offset1:15
    v_exp_f32 v36, v36
    v_exp_f32 v37, v37
    v_exp_f32 v38, v38
    v_smfmac_f32_16x16x64_bf16 v[204:207], v[228:231], v[120:127], v3
    global_load_dwordx4 v[120:123], v6, s[40:41] offset:2048 sc1
    global_load_dwordx4 v[124:127], v6, s[40:41] offset:3072 sc1
    v_exp_f32 v39, v39
    v_smfmac_f32_32x32x32_bf16 a[224:239], a[104:107], v[16:23], v2
    s_waitcnt lgkmcnt(1)
    s_add_u32 s40, s16, 2695168
    s_addc_u32 s41, s17, 0
    v_exp_f32 v40, v40
    v_exp_f32 v41, v41
    v_exp_f32 v42, v42
    v_exp_f32 v43, v43
    v_pk_add_f32 v[220:221], v[220:221], v[222:223]
    v_pk_add_f32 v[224:225], v[224:225], v[226:227]
    v_pk_add_f32 v[212:213], v[212:213], v[214:215]
    v_pk_add_f32 v[220:221], v[220:221], v[224:225]
    v_smfmac_f32_32x32x32_bf16 a[224:239], a[108:111], v[24:31], v2
    s_waitcnt lgkmcnt(0)
    v_exp_f32 v44, v44
    v_exp_f32 v45, v45
    v_rcp_f32 v222, v221
    v_subrev_u32 v223, s42, v221
    v_exp_f32 v46, v46
    v_exp_f32 v47, v47
    v_pk_add_f32 v[216:217], v[216:217], v[218:219]
    v_mul_f32 v236, v220, v222
    v_pk_add_f32 v[212:213], v[212:213], v[216:217]
    v_max_u32 v13, v13, v223
    v_pk_mul_f32 v[212:213], v[212:213], v[222:223] op_sel_hi:[1,0]
    v_cvt_pk_bf16_f32 v212, v212, v213
    v_mfma_f32_32x32x8_bf16 v[16:31], a[70:71], a[252:253], 0
    v_exp_f32 v48, v48
    v_exp_f32 v49, v49
    v_exp_f32 v50, v50
    v_exp_f32 v51, v51
    v_mfma_f32_32x32x16_bf16 v[16:31], a[24:27], a[244:247], v[16:31]
    ds_write_b32 v11, v212
    v_exp_f32 v52, v52
    v_exp_f32 v53, v53
    v_exp_f32 v54, v54
    v_smfmac_f32_16x16x64_bf16 v[208:211], v[228:231], v[128:135], v3
    global_load_dwordx4 v[128:131], v6, s[40:41] offset:-4096 sc1
    global_load_dwordx4 v[132:135], v6, s[40:41] offset:-3072 sc1
    v_exp_f32 v55, v55
    v_smfmac_f32_32x32x32_bf16 a[224:239], a[112:115], v[32:39], v2
    v_exp_f32 v56, v56
    v_exp_f32 v57, v57
    v_exp_f32 v58, v58
    v_exp_f32 v59, v59
    v_smfmac_f32_32x32x32_bf16 a[224:239], a[116:119], v[40:47], v2
    s_waitcnt lgkmcnt(0)
    s_barrier
    v_exp_f32 v60, v60
    v_exp_f32 v61, v61
    v_exp_f32 v62, v62
    v_exp_f32 v63, v63
    v_mfma_f32_32x32x8_bf16 v[32:47], a[70:71], a[254:255], 0
    v_exp_f32 v16, v16
    v_exp_f32 v17, v17
    v_exp_f32 v18, v18
    v_exp_f32 v19, v19
    v_mfma_f32_32x32x16_bf16 v[32:47], a[28:31], a[244:247], v[32:47]
    ds_read_b128 v[228:231], v12 offset:10240
    v_exp_f32 v20, v20
    v_exp_f32 v21, v21
    v_exp_f32 v22, v22
    v_exp_f32 v23, v23
    v_smfmac_f32_32x32x32_bf16 a[224:239], a[120:123], v[48:55], v2
    s_add_u32 s40, s16, 2752512
    s_addc_u32 s41, s17, 0
    global_load_dwordx4 v[144:147], v6, s[38:39] offset:-2048 sc1
    v_exp_f32 v24, v24
    v_exp_f32 v25, v25
    v_exp_f32 v26, v26
    v_exp_f32 v27, v27
    v_smfmac_f32_32x32x32_bf16 a[224:239], a[124:127], v[56:63], v2
    global_load_dwordx4 v[148:151], v6, s[38:39] offset:-1024 sc1
    v_exp_f32 v28, v28
    v_exp_f32 v29, v29
    v_exp_f32 v30, v30
    v_exp_f32 v31, v31
    v_mfma_f32_32x32x8_bf16 v[48:63], a[72:73], a[252:253], 0
    v_exp_f32 v32, v32
    v_exp_f32 v33, v33
    v_exp_f32 v34, v34
    v_exp_f32 v35, v35
    v_mfma_f32_32x32x16_bf16 v[48:63], a[32:35], a[244:247], v[48:63]
    s_waitcnt vmcnt(14) lgkmcnt(0)
    v_exp_f32 v36, v36
    v_exp_f32 v37, v37
    v_exp_f32 v38, v38
    v_smfmac_f32_16x16x64_bf16 v[176:179], v[228:231], v[64:71], v3
    global_load_dwordx4 v[64:67], v6, s[40:41] offset:-4096 sc1
    global_load_dwordx4 v[68:71], v6, s[40:41] offset:-3072 sc1
    v_exp_f32 v39, v39
    v_smfmac_f32_32x32x32_bf16 a[224:239], a[128:131], v[16:23], v2
    ds_read2_b32 a[240:241], v4 offset0:144 offset1:145
    v_exp_f32 v40, v40
    v_exp_f32 v41, v41
    v_exp_f32 v42, v42
    v_exp_f32 v43, v43
    v_smfmac_f32_32x32x32_bf16 a[224:239], a[132:135], v[24:31], v2
    ds_read2_b32 a[242:243], v4 offset0:146 offset1:147
    v_exp_f32 v44, v44
    v_exp_f32 v45, v45
    v_exp_f32 v46, v46
    v_exp_f32 v47, v47
    v_mfma_f32_32x32x8_bf16 v[16:31], a[72:73], a[254:255], 0
    v_exp_f32 v48, v48
    v_exp_f32 v49, v49
    v_exp_f32 v50, v50
    v_exp_f32 v51, v51
    v_mfma_f32_32x32x16_bf16 v[16:31], a[36:39], a[244:247], v[16:31]
    ds_read_b32 a248, v5 offset:576
    v_exp_f32 v52, v52
    v_exp_f32 v53, v53
    v_exp_f32 v54, v54
    v_smfmac_f32_16x16x64_bf16 v[180:183], v[228:231], v[72:79], v3
    global_load_dwordx4 v[72:75], v6, s[40:41] offset:-2048 sc1
    global_load_dwordx4 v[76:79], v6, s[40:41] offset:-1024 sc1
    v_exp_f32 v55, v55
    v_smfmac_f32_32x32x32_bf16 a[224:239], a[136:139], v[32:39], v2
    ds_read_b32 a251, v5 offset:576
    v_exp_f32 v56, v56
    v_exp_f32 v57, v57
    v_exp_f32 v58, v58
    v_exp_f32 v59, v59
    v_smfmac_f32_32x32x32_bf16 a[224:239], a[140:143], v[40:47], v2
    v_exp_f32 v60, v60
    v_exp_f32 v61, v61
    v_exp_f32 v62, v62
    v_exp_f32 v63, v63
    v_mfma_f32_32x32x8_bf16 v[32:47], a[74:75], a[252:253], 0
    v_exp_f32 v16, v16
    v_exp_f32 v17, v17
    v_exp_f32 v18, v18
    v_exp_f32 v19, v19
    v_mfma_f32_32x32x16_bf16 v[32:47], a[40:43], a[244:247], v[32:47]
    v_exp_f32 v20, v20
    v_exp_f32 v21, v21
    v_exp_f32 v22, v22
    v_smfmac_f32_16x16x64_bf16 v[184:187], v[228:231], v[80:87], v3
    global_load_dwordx4 v[80:83], v6, s[40:41] offset:0 sc1
    global_load_dwordx4 v[84:87], v6, s[40:41] offset:1024 sc1
    v_exp_f32 v23, v23
    v_smfmac_f32_32x32x32_bf16 a[224:239], a[144:147], v[48:55], v2
    v_exp_f32 v24, v24
    v_exp_f32 v25, v25
    v_exp_f32 v26, v26
    v_exp_f32 v27, v27
    v_smfmac_f32_32x32x32_bf16 a[224:239], a[148:151], v[56:63], v2
    v_exp_f32 v28, v28
    v_exp_f32 v29, v29
    v_exp_f32 v30, v30
    v_exp_f32 v31, v31
    v_mfma_f32_32x32x8_bf16 v[48:63], a[74:75], a[254:255], 0
    v_exp_f32 v32, v32
    v_exp_f32 v33, v33
    v_exp_f32 v34, v34
    v_exp_f32 v35, v35
    v_mfma_f32_32x32x16_bf16 v[48:63], a[44:47], a[244:247], v[48:63]
    s_waitcnt vmcnt(14)
    v_exp_f32 v36, v36
    v_exp_f32 v37, v37
    v_exp_f32 v38, v38
    v_smfmac_f32_16x16x64_bf16 v[188:191], v[228:231], v[88:95], v3
    global_load_dwordx4 v[88:91], v6, s[40:41] offset:2048 sc1
    global_load_dwordx4 v[92:95], v6, s[40:41] offset:3072 sc1
    v_exp_f32 v39, v39
    v_smfmac_f32_32x32x32_bf16 a[224:239], a[152:155], v[16:23], v2
    s_add_u32 s40, s16, 2760704
    s_addc_u32 s41, s17, 0
    v_exp_f32 v40, v40
    v_exp_f32 v41, v41
    v_exp_f32 v42, v42
    v_exp_f32 v43, v43
    v_smfmac_f32_32x32x32_bf16 a[224:239], a[156:159], v[24:31], v2
    v_exp_f32 v44, v44
    v_exp_f32 v45, v45
    v_exp_f32 v46, v46
    v_exp_f32 v47, v47
    v_mfma_f32_32x32x8_bf16 v[16:31], a[76:77], a[252:253], 0
    v_exp_f32 v48, v48
    v_exp_f32 v49, v49
    v_exp_f32 v50, v50
    v_exp_f32 v51, v51
    v_mfma_f32_32x32x16_bf16 v[16:31], a[48:51], a[244:247], v[16:31]
    v_exp_f32 v52, v52
    v_exp_f32 v53, v53
    v_exp_f32 v54, v54
    v_smfmac_f32_16x16x64_bf16 v[192:195], v[228:231], v[96:103], v3
    global_load_dwordx4 v[96:99], v6, s[40:41] offset:-4096 sc1
    global_load_dwordx4 v[100:103], v6, s[40:41] offset:-3072 sc1
    v_exp_f32 v55, v55
    v_smfmac_f32_32x32x32_bf16 a[224:239], a[160:163], v[32:39], v2
    v_exp_f32 v56, v56
    v_exp_f32 v57, v57
    v_exp_f32 v58, v58
    v_exp_f32 v59, v59
    v_smfmac_f32_32x32x32_bf16 a[224:239], a[164:167], v[40:47], v2
    v_exp_f32 v60, v60
    v_exp_f32 v61, v61
    v_exp_f32 v62, v62
    v_exp_f32 v63, v63
    v_mfma_f32_32x32x8_bf16 v[32:47], a[76:77], a[254:255], 0
    v_exp_f32 v16, v16
    v_exp_f32 v17, v17
    v_exp_f32 v18, v18
    v_exp_f32 v19, v19
    v_mfma_f32_32x32x16_bf16 v[32:47], a[52:55], a[244:247], v[32:47]
    v_exp_f32 v20, v20
    v_exp_f32 v21, v21
    v_exp_f32 v22, v22
    v_smfmac_f32_16x16x64_bf16 v[196:199], v[228:231], v[104:111], v3
    global_load_dwordx4 v[104:107], v6, s[40:41] offset:-2048 sc1
    global_load_dwordx4 v[108:111], v6, s[40:41] offset:-1024 sc1
    v_exp_f32 v23, v23
    v_smfmac_f32_32x32x32_bf16 a[224:239], a[168:171], v[48:55], v2
    v_exp_f32 v24, v24
    v_exp_f32 v25, v25
    v_exp_f32 v26, v26
    v_exp_f32 v27, v27
    v_smfmac_f32_32x32x32_bf16 a[224:239], a[172:175], v[56:63], v2
    v_exp_f32 v28, v28
    v_exp_f32 v29, v29
    v_exp_f32 v30, v30
    v_exp_f32 v31, v31
    v_mfma_f32_32x32x8_bf16 v[48:63], a[78:79], a[252:253], 0
    v_exp_f32 v32, v32
    v_exp_f32 v33, v33
    v_exp_f32 v34, v34
    v_exp_f32 v35, v35
    v_mfma_f32_32x32x16_bf16 v[48:63], a[56:59], a[244:247], v[48:63]
    s_waitcnt vmcnt(14)
    v_exp_f32 v36, v36
    v_exp_f32 v37, v37
    v_exp_f32 v38, v38
    v_smfmac_f32_16x16x64_bf16 v[200:203], v[228:231], v[112:119], v3
    global_load_dwordx4 v[112:115], v6, s[40:41] offset:0 sc1
    global_load_dwordx4 v[116:119], v6, s[40:41] offset:1024 sc1
    v_exp_f32 v39, v39
    v_smfmac_f32_32x32x32_bf16 a[224:239], a[176:179], v[16:23], v2
    v_exp_f32 v40, v40
    v_exp_f32 v41, v41
    v_exp_f32 v42, v42
    v_exp_f32 v43, v43
    v_smfmac_f32_32x32x32_bf16 a[224:239], a[180:183], v[24:31], v2
    v_exp_f32 v44, v44
    v_exp_f32 v45, v45
    v_exp_f32 v46, v46
    v_exp_f32 v47, v47
    v_mfma_f32_32x32x8_bf16 v[16:31], a[78:79], a[254:255], 0
    v_exp_f32 v48, v48
    v_exp_f32 v49, v49
    v_exp_f32 v50, v50
    v_exp_f32 v51, v51
    v_mfma_f32_32x32x16_bf16 v[16:31], a[60:63], a[244:247], v[16:31]
    v_exp_f32 v52, v52
    v_exp_f32 v53, v53
    v_exp_f32 v54, v54
    v_smfmac_f32_16x16x64_bf16 v[204:207], v[228:231], v[120:127], v3
    global_load_dwordx4 v[120:123], v6, s[40:41] offset:2048 sc1
    global_load_dwordx4 v[124:127], v6, s[40:41] offset:3072 sc1
    v_exp_f32 v55, v55
    v_smfmac_f32_32x32x32_bf16 a[224:239], a[184:187], v[32:39], v2
    s_add_u32 s40, s16, 2768896
    s_addc_u32 s41, s17, 0
    v_exp_f32 v56, v56
    v_exp_f32 v57, v57
    v_exp_f32 v58, v58
    v_exp_f32 v59, v59
    v_smfmac_f32_32x32x32_bf16 a[224:239], a[188:191], v[40:47], v2
    s_waitcnt lgkmcnt(0)
    v_exp_f32 v60, v60
    v_exp_f32 v61, v61
    v_exp_f32 v62, v62
    v_exp_f32 v63, v63
    v_mfma_f32_32x32x8_bf16 v[32:47], a[64:65], a[248:249], 0
    v_exp_f32 v16, v16
    v_exp_f32 v17, v17
    v_exp_f32 v18, v18
    v_exp_f32 v19, v19
    v_mfma_f32_32x32x16_bf16 v[32:47], a[0:3], a[240:243], v[32:47]
    v_exp_f32 v20, v20
    v_exp_f32 v21, v21
    v_exp_f32 v22, v22
    v_smfmac_f32_16x16x64_bf16 v[208:211], v[228:231], v[128:135], v3
    global_load_dwordx4 v[128:131], v6, s[40:41] offset:-4096 sc1
    global_load_dwordx4 v[132:135], v6, s[40:41] offset:-3072 sc1
    v_exp_f32 v23, v23
    v_smfmac_f32_32x32x32_bf16 a[224:239], a[192:195], v[48:55], v2
    v_exp_f32 v24, v24
    v_exp_f32 v25, v25
    v_exp_f32 v26, v26
    v_exp_f32 v27, v27
    v_smfmac_f32_32x32x32_bf16 a[224:239], a[196:199], v[56:63], v2
    v_exp_f32 v28, v28
    v_exp_f32 v29, v29
    v_exp_f32 v30, v30
    v_exp_f32 v31, v31
    v_mfma_f32_32x32x8_bf16 v[48:63], a[64:65], a[250:251], 0
    v_exp_f32 v32, v32
    v_exp_f32 v33, v33
    v_exp_f32 v34, v34
    v_exp_f32 v35, v35
    v_mfma_f32_32x32x16_bf16 v[48:63], a[4:7], a[240:243], v[48:63]
    v_exp_f32 v36, v36
    v_exp_f32 v37, v37
    v_exp_f32 v38, v38
    v_exp_f32 v39, v39
    v_smfmac_f32_32x32x32_bf16 a[224:239], a[200:203], v[16:23], v2
    v_exp_f32 v40, v40
    v_exp_f32 v41, v41
    v_exp_f32 v42, v42
    v_exp_f32 v43, v43
    v_smfmac_f32_32x32x32_bf16 a[224:239], a[204:207], v[24:31], v2
    s_add_u32 m0, s50, 0
    s_cbranch_vccz L_skip6
    buffer_load_dwordx4 v248, s[12:15], 0 offen lds
    buffer_load_dwordx4 v248, s[68:71], 0 offen offset:1024 lds
    s_branch L_skip6j
L_skip6:
    buffer_load_dword v250, v248, s[12:15], 0 offen
    buffer_load_dword v250, v248, s[68:71], 0 offen offset:1024
L_skip6j:
    v_exp_f32 v44, v44
    v_exp_f32 v45, v45
    v_exp_f32 v46, v46
    v_exp_f32 v47, v47
    v_mfma_f32_32x32x8_bf16 v[16:31], a[66:67], a[248:249], 0
    v_exp_f32 v48, v48
    v_exp_f32 v49, v49
    v_exp_f32 v50, v50
    v_exp_f32 v51, v51
    v_mfma_f32_32x32x16_bf16 v[16:31], a[8:11], a[240:243], v[16:31]
    v_exp_f32 v52, v52
    v_exp_f32 v53, v53
    v_exp_f32 v54, v54
    v_exp_f32 v55, v55
    v_smfmac_f32_32x32x32_bf16 a[208:223], a[80:83], v[32:39], v2
    ds_write_b128 v7, a[224:227]
    v_exp_f32 v56, v56
    v_exp_f32 v57, v57
    v_exp_f32 v58, v58
    v_exp_f32 v59, v59
    v_smfmac_f32_32x32x32_bf16 a[208:223], a[84:87], v[40:47], v2
    ds_write_b128 v7, a[228:231] offset:1024
    s_add_u32 m0, s50, 8192
    s_cbranch_vccz L_skip7
    buffer_load_dwordx4 v252, s[12:15], 0 offen lds
    buffer_load_dwordx4 v252, s[68:71], 0 offen offset:1024 lds
L_skip7:
    v_exp_f32 v60, v60
    v_exp_f32 v61, v61
    v_exp_f32 v62, v62
    v_exp_f32 v63, v63
    v_mfma_f32_32x32x8_bf16 v[32:47], a[66:67], a[250:251], 0
    v_exp_f32 v16, v16
    v_exp_f32 v17, v17
    v_exp_f32 v18, v18
    v_exp_f32 v19, v19
    v_mfma_f32_32x32x16_bf16 v[32:47], a[12:15], a[240:243], v[32:47]
    ds_write_b64 v8, a[232:233]
    v_exp_f32 v20, v20
    v_exp_f32 v21, v21
    v_exp_f32 v22, v22
    v_exp_f32 v23, v23
    v_smfmac_f32_32x32x32_bf16 a[208:223], a[88:91], v[48:55], v2
    s_add_u32 m0, s51, 0
    s_cbranch_vccz L_skip2
    buffer_load_dwordx4 v12, s[28:31], 0 offen offset:2048 lds
    buffer_load_dwordx4 v12, s[28:31], 0 offen offset:3072 lds
L_skip2:
    v_exp_f32 v24, v24
    v_exp_f32 v25, v25
    v_exp_f32 v26, v26
    v_exp_f32 v27, v27
    v_smfmac_f32_32x32x32_bf16 a[208:223], a[92:95], v[56:63], v2
    s_waitcnt lgkmcnt(0)
    s_barrier
    v_exp_f32 v28, v28
    v_exp_f32 v29, v29
    v_exp_f32 v30, v30
    v_exp_f32 v31, v31
    v_mfma_f32_32x32x8_bf16 v[48:63], a[68:69], a[248:249], 0
    v_exp_f32 v32, v32
    v_exp_f32 v33, v33
    v_exp_f32 v34, v34
    v_exp_f32 v35, v35
    v_mfma_f32_32x32x16_bf16 v[48:63], a[16:19], a[240:243], v[48:63]
    ds_read2st64_b64 v[220:223], v10 offset0:4 offset1:9
    v_exp_f32 v36, v36
    v_exp_f32 v37, v37
    v_exp_f32 v38, v38
    v_smfmac_f32_32x32x32_bf16 a[208:223], a[96:99], v[16:23], v2
    ds_read2st64_b64 v[224:227], v10 offset0:14 offset1:19
    v_exp_f32 v39, v39
    v_exp_f32 v40, v40
    v_exp_f32 v41, v41
    v_mfma_f32_32x32x8_bf16 a[224:239], v[14:15], v[14:15], 0
    v_exp_f32 v42, v42
    v_exp_f32 v43, v43
    v_exp_f32 v44, v44
    v_smfmac_f32_32x32x32_bf16 a[208:223], a[100:103], v[24:31], v2
    ds_read2st64_b64 v[212:215], v9 offset0:0 offset1:5
    v_exp_f32 v45, v45
    v_exp_f32 v46, v46
    v_exp_f32 v47, v47
    v_mfma_f32_32x32x8_bf16 v[16:31], a[68:69], a[250:251], 0
    v_exp_f32 v48, v48
    v_exp_f32 v49, v49
    v_exp_f32 v50, v50
    v_exp_f32 v51, v51
    v_mfma_f32_32x32x16_bf16 v[16:31], a[20:23], a[240:243], v[16:31]
    ds_read2st64_b64 v[216:219], v9 offset0:10 offset1:15
    v_exp_f32 v52, v52
    v_exp_f32 v53, v53
    v_exp_f32 v54, v54
    v_exp_f32 v55, v55
    v_smfmac_f32_32x32x32_bf16 a[208:223], a[104:107], v[32:39], v2
    s_waitcnt lgkmcnt(1)
    v_exp_f32 v56, v56
    v_exp_f32 v57, v57
    v_exp_f32 v58, v58
    v_exp_f32 v59, v59
    v_pk_add_f32 v[220:221], v[220:221], v[222:223]
    v_pk_add_f32 v[224:225], v[224:225], v[226:227]
    v_pk_add_f32 v[212:213], v[212:213], v[214:215]
    v_pk_add_f32 v[220:221], v[220:221], v[224:225]
    v_smfmac_f32_32x32x32_bf16 a[208:223], a[108:111], v[40:47], v2
    s_waitcnt lgkmcnt(0)
    v_exp_f32 v60, v60
    v_exp_f32 v61, v61
    v_rcp_f32 v222, v221
    v_subrev_u32 v223, s42, v221
    v_exp_f32 v62, v62
    v_exp_f32 v63, v63
    v_pk_add_f32 v[216:217], v[216:217], v[218:219]
    v_mul_f32 v237, v220, v222
    v_pk_add_f32 v[212:213], v[212:213], v[216:217]
    v_max_u32 v13, v13, v223
    v_pk_mul_f32 v[212:213], v[212:213], v[222:223] op_sel_hi:[1,0]
    v_cvt_pk_bf16_f32 v212, v212, v213
    v_mfma_f32_32x32x8_bf16 v[32:47], a[70:71], a[248:249], 0
    v_exp_f32 v16, v16
    v_exp_f32 v17, v17
    v_exp_f32 v18, v18
    v_exp_f32 v19, v19
    v_mfma_f32_32x32x16_bf16 v[32:47], a[24:27], a[240:243], v[32:47]
    ds_write_b32 v11, v212
    v_exp_f32 v20, v20
    v_exp_f32 v21, v21
    v_cvt_pk_bf16_f32 v233, v236, v237
    v_exp_f32 v22, v22
    v_exp_f32 v23, v23
    v_smfmac_f32_32x32x32_bf16 a[208:223], a[112:115], v[48:55], v2
    s_add_u32 s28, s28, 4096
    s_addc_u32 s29, s29, 0
    v_exp_f32 v24, v24
    v_exp_f32 v25, v25
    v_exp_f32 v26, v26
    v_exp_f32 v27, v27
    v_smfmac_f32_32x32x32_bf16 a[208:223], a[116:119], v[56:63], v2
    s_waitcnt lgkmcnt(0)
    s_barrier
    v_exp_f32 v28, v28
    v_exp_f32 v29, v29
    v_exp_f32 v30, v30
    v_exp_f32 v31, v31
    v_mfma_f32_32x32x8_bf16 v[48:63], a[70:71], a[250:251], 0
    v_exp_f32 v32, v32
    v_exp_f32 v33, v33
    v_exp_f32 v34, v34
    v_exp_f32 v35, v35
    v_mfma_f32_32x32x16_bf16 v[48:63], a[28:31], a[240:243], v[48:63]
    ds_read_b128 v[228:231], v12 offset:10240
    v_exp_f32 v36, v36
    v_exp_f32 v37, v37
    v_exp_f32 v38, v38
    v_exp_f32 v39, v39
    v_smfmac_f32_32x32x32_bf16 a[208:223], a[120:123], v[16:23], v2
    s_add_u32 s40, s16, 2826240
    s_addc_u32 s41, s17, 0
    global_load_dwordx4 v[152:155], v6, s[38:39] offset:0 sc1
    v_exp_f32 v40, v40
    v_exp_f32 v41, v41
    v_exp_f32 v42, v42
    v_exp_f32 v43, v43
    v_smfmac_f32_32x32x32_bf16 a[208:223], a[124:127], v[24:31], v2
    global_load_dwordx4 v[156:159], v6, s[38:39] offset:1024 sc1
    v_exp_f32 v44, v44
    v_exp_f32 v45, v45
    v_exp_f32 v46, v46
    v_exp_f32 v47, v47
    v_mfma_f32_32x32x8_bf16 v[16:31], a[72:73], a[248:249], 0
    v_exp_f32 v48, v48
    v_exp_f32 v49, v49
    v_exp_f32 v50, v50
    v_exp_f32 v51, v51
    v_mfma_f32_32x32x16_bf16 v[16:31], a[32:35], a[240:243], v[16:31]
    s_waitcnt vmcnt(14) lgkmcnt(0)
    v_exp_f32 v52, v52
    v_exp_f32 v53, v53
    v_exp_f32 v54, v54
    v_smfmac_f32_16x16x64_bf16 v[176:179], v[228:231], v[64:71], v3
    global_load_dwordx4 v[64:67], v6, s[40:41] offset:-4096 sc1
    global_load_dwordx4 v[68:71], v6, s[40:41] offset:-3072 sc1
    v_exp_f32 v55, v55
    v_smfmac_f32_32x32x32_bf16 a[208:223], a[128:131], v[32:39], v2
    ds_read2_b32 a[244:245], v4 offset0:180 offset1:181
    v_exp_f32 v56, v56
    v_exp_f32 v57, v57
    v_exp_f32 v58, v58
    v_exp_f32 v59, v59
    v_smfmac_f32_32x32x32_bf16 a[208:223], a[132:135], v[40:47], v2
    ds_read2_b32 a[246:247], v4 offset0:182 offset1:183
    v_exp_f32 v60, v60
    v_exp_f32 v61, v61
    v_exp_f32 v62, v62
    v_exp_f32 v63, v63
    v_mfma_f32_32x32x8_bf16 v[32:47], a[72:73], a[250:251], 0
    v_exp_f32 v16, v16
    v_exp_f32 v17, v17
    v_exp_f32 v18, v18
    v_exp_f32 v19, v19
    v_mfma_f32_32x32x16_bf16 v[32:47], a[36:39], a[240:243], v[32:47]
    ds_read_b32 a252, v5 offset:720
    v_exp_f32 v20, v20
    v_exp_f32 v21, v21
    v_exp_f32 v22, v22
    v_smfmac_f32_16x16x64_bf16 v[180:183], v[228:231], v[72:79], v3
    global_load_dwordx4 v[72:75], v6, s[40:41] offset:-2048 sc1
    global_load_dwordx4 v[76:79], v6, s[40:41] offset:-1024 sc1
    v_exp_f32 v23, v23
    v_smfmac_f32_32x32x32_bf16 a[208:223], a[136:139], v[48:55], v2
    ds_read_b32 a255, v5 offset:720
    v_exp_f32 v24, v24
    v_exp_f32 v25, v25
    v_exp_f32 v26, v26
    v_exp_f32 v27, v27
    v_smfmac_f32_32x32x32_bf16 a[208:223], a[140:143], v[56:63], v2
    s_add_u32 s12, s12, s9
    s_addc_u32 s13, s13, 0
    v_exp_f32 v28, v28
    v_exp_f32 v29, v29
    v_exp_f32 v30, v30
    v_exp_f32 v31, v31
    v_mfma_f32_32x32x8_bf16 v[48:63], a[74:75], a[248:249], 0
    v_exp_f32 v32, v32
    v_exp_f32 v33, v33
    v_exp_f32 v34, v34
    v_exp_f32 v35, v35
    v_mfma_f32_32x32x16_bf16 v[48:63], a[40:43], a[240:243], v[48:63]
    v_exp_f32 v36, v36
    v_exp_f32 v37, v37
    v_exp_f32 v38, v38
    v_smfmac_f32_16x16x64_bf16 v[184:187], v[228:231], v[80:87], v3
    global_load_dwordx4 v[80:83], v6, s[40:41] offset:0 sc1
    global_load_dwordx4 v[84:87], v6, s[40:41] offset:1024 sc1
    v_exp_f32 v39, v39
    v_smfmac_f32_32x32x32_bf16 a[208:223], a[144:147], v[16:23], v2
    s_add_u32 s68, s68, s9
    s_addc_u32 s69, s69, 0
    v_exp_f32 v40, v40
    v_exp_f32 v41, v41
    v_exp_f32 v42, v42
    v_exp_f32 v43, v43
    v_smfmac_f32_32x32x32_bf16 a[208:223], a[148:151], v[24:31], v2
    s_add_u32 s12, s12, s8
    s_addc_u32 s13, s13, 0
    v_exp_f32 v44, v44
    v_exp_f32 v45, v45
    v_exp_f32 v46, v46
    v_exp_f32 v47, v47
    v_mfma_f32_32x32x8_bf16 v[16:31], a[74:75], a[250:251], 0
    v_exp_f32 v48, v48
    v_exp_f32 v49, v49
    v_exp_f32 v50, v50
    v_exp_f32 v51, v51
    v_mfma_f32_32x32x16_bf16 v[16:31], a[44:47], a[240:243], v[16:31]
    s_waitcnt vmcnt(14)
    v_exp_f32 v52, v52
    v_exp_f32 v53, v53
    v_exp_f32 v54, v54
    v_smfmac_f32_16x16x64_bf16 v[188:191], v[228:231], v[88:95], v3
    global_load_dwordx4 v[88:91], v6, s[40:41] offset:2048 sc1
    global_load_dwordx4 v[92:95], v6, s[40:41] offset:3072 sc1
    v_exp_f32 v55, v55
    v_smfmac_f32_32x32x32_bf16 a[208:223], a[152:155], v[32:39], v2
    s_add_u32 s40, s16, 2834432
    s_addc_u32 s41, s17, 0
    v_exp_f32 v56, v56
    v_exp_f32 v57, v57
    v_exp_f32 v58, v58
    v_exp_f32 v59, v59
    v_smfmac_f32_32x32x32_bf16 a[208:223], a[156:159], v[40:47], v2
    s_add_u32 s68, s68, s8
    s_addc_u32 s69, s69, 0
    v_exp_f32 v60, v60
    v_exp_f32 v61, v61
    v_exp_f32 v62, v62
    v_exp_f32 v63, v63
    v_mfma_f32_32x32x8_bf16 v[32:47], a[76:77], a[248:249], 0
    v_exp_f32 v16, v16
    v_exp_f32 v17, v17
    v_exp_f32 v18, v18
    v_exp_f32 v19, v19
    v_mfma_f32_32x32x16_bf16 v[32:47], a[48:51], a[240:243], v[32:47]
    v_exp_f32 v20, v20
    v_exp_f32 v21, v21
    v_exp_f32 v22, v22
    v_smfmac_f32_16x16x64_bf16 v[192:195], v[228:231], v[96:103], v3
    global_load_dwordx4 v[96:99], v6, s[40:41] offset:-4096 sc1
    global_load_dwordx4 v[100:103], v6, s[40:41] offset:-3072 sc1
    v_exp_f32 v23, v23
    v_smfmac_f32_32x32x32_bf16 a[208:223], a[160:163], v[48:55], v2
    v_exp_f32 v24, v24
    v_exp_f32 v25, v25
    v_exp_f32 v26, v26
    v_exp_f32 v27, v27
    v_smfmac_f32_32x32x32_bf16 a[208:223], a[164:167], v[56:63], v2
    v_exp_f32 v28, v28
    v_exp_f32 v29, v29
    v_exp_f32 v30, v30
    v_exp_f32 v31, v31
    v_mfma_f32_32x32x8_bf16 v[48:63], a[76:77], a[250:251], 0
    v_exp_f32 v32, v32
    v_exp_f32 v33, v33
    v_exp_f32 v34, v34
    v_exp_f32 v35, v35
    v_mfma_f32_32x32x16_bf16 v[48:63], a[52:55], a[240:243], v[48:63]
    v_exp_f32 v36, v36
    v_exp_f32 v37, v37
    v_exp_f32 v38, v38
    v_smfmac_f32_16x16x64_bf16 v[196:199], v[228:231], v[104:111], v3
    global_load_dwordx4 v[104:107], v6, s[40:41] offset:-2048 sc1
    global_load_dwordx4 v[108:111], v6, s[40:41] offset:-1024 sc1
    v_exp_f32 v39, v39
    v_smfmac_f32_32x32x32_bf16 a[208:223], a[168:171], v[16:23], v2
    v_exp_f32 v40, v40
    v_exp_f32 v41, v41
    v_exp_f32 v42, v42
    v_exp_f32 v43, v43
    v_smfmac_f32_32x32x32_bf16 a[208:223], a[172:175], v[24:31], v2
    v_exp_f32 v44, v44
    v_exp_f32 v45, v45
    v_exp_f32 v46, v46
    v_exp_f32 v47, v47
    v_mfma_f32_32x32x8_bf16 v[16:31], a[78:79], a[248:249], 0
    v_exp_f32 v48, v48
    v_exp_f32 v49, v49
    v_exp_f32 v50, v50
    v_exp_f32 v51, v51
    v_mfma_f32_32x32x16_bf16 v[16:31], a[56:59], a[240:243], v[16:31]
    s_waitcnt vmcnt(14)
    v_exp_f32 v52, v52
    v_exp_f32 v53, v53
    v_exp_f32 v54, v54
    v_smfmac_f32_16x16x64_bf16 v[200:203], v[228:231], v[112:119], v3
    global_load_dwordx4 v[112:115], v6, s[40:41] offset:0 sc1
    global_load_dwordx4 v[116:119], v6, s[40:41] offset:1024 sc1
    v_exp_f32 v55, v55
    v_smfmac_f32_32x32x32_bf16 a[208:223], a[176:179], v[32:39], v2
L_padb2:
    s_cbranch_execz L_padb6
    v_exp_f32 v56, v56
    v_exp_f32 v57, v57
    v_exp_f32 v58, v58
    v_exp_f32 v59, v59
    v_smfmac_f32_32x32x32_bf16 a[208:223], a[180:183], v[40:47], v2
    v_exp_f32 v60, v60
    v_exp_f32 v61, v61
    v_exp_f32 v62, v62
    v_exp_f32 v63, v63
    v_mfma_f32_32x32x8_bf16 v[32:47], a[78:79], a[250:251], 0
    v_exp_f32 v16, v16
    v_exp_f32 v17, v17
    v_exp_f32 v18, v18
    v_exp_f32 v19, v19
    v_mfma_f32_32x32x16_bf16 v[32:47], a[60:63], a[240:243], v[32:47]
    v_exp_f32 v20, v20
    v_exp_f32 v21, v21
    v_exp_f32 v22, v22
    v_smfmac_f32_16x16x64_bf16 v[204:207], v[228:231], v[120:127], v3
    global_load_dwordx4 v[120:123], v6, s[40:41] offset:2048 sc1
    global_load_dwordx4 v[124:127], v6, s[40:41] offset:3072 sc1
    v_exp_f32 v23, v23
    v_smfmac_f32_32x32x32_bf16 a[208:223], a[184:187], v[48:55], v2
    s_add_u32 s40, s16, 2842624
    s_addc_u32 s41, s17, 0
    v_exp_f32 v24, v24
    v_exp_f32 v25, v25
    v_exp_f32 v26, v26
    v_exp_f32 v27, v27
    v_smfmac_f32_32x32x32_bf16 a[208:223], a[188:191], v[56:63], v2
    s_waitcnt lgkmcnt(0)
    v_exp_f32 v28, v28
    v_exp_f32 v29, v29
    v_exp_f32 v30, v30
    v_exp_f32 v31, v31
    v_mfma_f32_32x32x8_bf16 v[48:63], a[64:65], a[252:253], 0
    v_exp_f32 v32, v32
    v_exp_f32 v33, v33
    v_exp_f32 v34, v34
    v_exp_f32 v35, v35
    v_mfma_f32_32x32x16_bf16 v[48:63], a[0:3], a[244:247], v[48:63]
    v_exp_f32 v36, v36
    v_exp_f32 v37, v37
    v_exp_f32 v38, v38
    v_smfmac_f32_16x16x64_bf16 v[208:211], v[228:231], v[128:135], v3
    global_load_dwordx4 v[128:131], v6, s[40:41] offset:-4096 sc1
    global_load_dwordx4 v[132:135], v6, s[40:41] offset:-3072 sc1
    v_exp_f32 v39, v39
    v_smfmac_f32_32x32x32_bf16 a[208:223], a[192:195], v[16:23], v2
    v_exp_f32 v40, v40
    v_exp_f32 v41, v41
    v_exp_f32 v42, v42
    v_exp_f32 v43, v43
    v_smfmac_f32_32x32x32_bf16 a[208:223], a[196:199], v[24:31], v2
    v_exp_f32 v44, v44
    v_exp_f32 v45, v45
    v_exp_f32 v46, v46
    v_exp_f32 v47, v47
    v_mfma_f32_32x32x8_bf16 v[16:31], a[64:65], a[254:255], 0
    v_exp_f32 v48, v48
    v_exp_f32 v49, v49
    v_exp_f32 v50, v50
    v_exp_f32 v51, v51
    v_mfma_f32_32x32x16_bf16 v[16:31], a[4:7], a[244:247], v[16:31]
    v_exp_f32 v52, v52
    v_exp_f32 v53, v53
    v_exp_f32 v54, v54
    v_exp_f32 v55, v55
    v_smfmac_f32_32x32x32_bf16 a[208:223], a[200:203], v[32:39], v2
    v_exp_f32 v56, v56
    v_exp_f32 v57, v57
    v_exp_f32 v58, v58
    v_exp_f32 v59, v59
    v_smfmac_f32_32x32x32_bf16 a[208:223], a[204:207], v[40:47], v2
    s_add_u32 m0, s50, 16384
    s_cbranch_vccz L_skip8
    buffer_load_dwordx4 v248, s[12:15], 0 offen lds
    buffer_load_dwordx4 v248, s[68:71], 0 offen offset:1024 lds
    s_branch L_skip8j
L_skip8:
    buffer_load_dword v250, v248, s[12:15], 0 offen
    buffer_load_dword v250, v248, s[68:71], 0 offen offset:1024
L_skip8j:
    v_exp_f32 v60, v60
    v_exp_f32 v61, v61
    v_exp_f32 v62, v62
    v_exp_f32 v63, v63
    v_mfma_f32_32x32x8_bf16 v[32:47], a[66:67], a[252:253], 0
    v_exp_f32 v16, v16
    v_exp_f32 v17, v17
    v_exp_f32 v18, v18
    v_exp_f32 v19, v19
    v_mfma_f32_32x32x16_bf16 v[32:47], a[8:11], a[244:247], v[32:47]
    v_exp_f32 v20, v20
    v_exp_f32 v21, v21
    v_exp_f32 v22, v22
    v_exp_f32 v23, v23
    v_smfmac_f32_32x32x32_bf16 a[224:239], a[80:83], v[48:55], v2
    ds_write_b128 v7, a[208:211]
    v_exp_f32 v24, v24
    v_exp_f32 v25, v25
    v_exp_f32 v26, v26
    v_exp_f32 v27, v27
    v_smfmac_f32_32x32x32_bf16 a[224:239], a[84:87], v[56:63], v2
    ds_write_b128 v7, a[212:215] offset:1024
    s_add_u32 m0, s50, 24576
    s_cbranch_vccz L_skip9
    buffer_load_dwordx4 v252, s[12:15], 0 offen lds
    buffer_load_dwordx4 v252, s[68:71], 0 offen offset:1024 lds
L_skip9:
    v_exp_f32 v28, v28
    v_exp_f32 v29, v29
    v_exp_f32 v30, v30
    v_exp_f32 v31, v31
    v_mfma_f32_32x32x8_bf16 v[48:63], a[66:67], a[254:255], 0
    v_exp_f32 v32, v32
    v_exp_f32 v33, v33
    v_exp_f32 v34, v34
    v_exp_f32 v35, v35
    v_mfma_f32_32x32x16_bf16 v[48:63], a[12:15], a[244:247], v[48:63]
    ds_write_b64 v8, a[216:217]
    v_exp_f32 v36, v36
    v_exp_f32 v37, v37
    v_exp_f32 v38, v38
    v_exp_f32 v39, v39
    v_smfmac_f32_32x32x32_bf16 a[224:239], a[88:91], v[16:23], v2
    s_add_u32 m0, s51, 4096
    s_cbranch_vccz L_skip3
    buffer_load_dwordx4 v12, s[28:31], 0 offen offset:0 lds
    buffer_load_dwordx4 v12, s[28:31], 0 offen offset:1024 lds
L_skip3:
    v_exp_f32 v40, v40
    v_exp_f32 v41, v41
    v_exp_f32 v42, v42
    v_exp_f32 v43, v43
    v_smfmac_f32_32x32x32_bf16 a[224:239], a[92:95], v[24:31], v2
    s_waitcnt lgkmcnt(0)
    s_barrier
    v_exp_f32 v44, v44
    v_exp_f32 v45, v45
    v_exp_f32 v46, v46
    v_exp_f32 v47, v47
    v_mfma_f32_32x32x8_bf16 v[16:31], a[68:69], a[252:253], 0
    v_exp_f32 v48, v48
    v_exp_f32 v49, v49
    v_exp_f32 v50, v50
    v_exp_f32 v51, v51
    v_mfma_f32_32x32x16_bf16 v[16:31], a[16:19], a[244:247], v[16:31]
    ds_read2st64_b64 v[220:223], v10 offset0:4 offset1:9
    v_exp_f32 v52, v52
    v_exp_f32 v53, v53
    v_exp_f32 v54, v54
    v_smfmac_f32_32x32x32_bf16 a[224:239], a[96:99], v[32:39], v2
    ds_read2st64_b64 v[224:227], v10 offset0:14 offset1:19
    v_exp_f32 v55, v55
    v_exp_f32 v56, v56
    v_exp_f32 v57, v57
    v_mfma_f32_32x32x8_bf16 a[208:223], v[14:15], v[14:15], 0
    v_exp_f32 v58, v58
    v_exp_f32 v59, v59
    v_exp_f32 v60, v60
    v_smfmac_f32_32x32x32_bf16 a[224:239], a[100:103], v[40:47], v2
    ds_read2st64_b64 v[212:215], v9 offset0:0 offset1:5
    v_exp_f32 v61, v61
    v_exp_f32 v62, v62
    v_exp_f32 v63, v63
    v_mfma_f32_32x32x8_bf16 v[32:47], a[68:69], a[254:255], 0
    v_exp_f32 v16, v16
    v_exp_f32 v17, v17
    v_exp_f32 v18, v18
    v_exp_f32 v19, v19
    v_mfma_f32_32x32x16_bf16 v[32:47], a[20:23], a[244:247], v[32:47]
    ds_read2st64_b64 v[216:219], v9 offset0:10 offset1:15
    v_exp_f32 v20, v20
    v_exp_f32 v21, v21
    v_exp_f32 v22, v22
    v_exp_f32 v23, v23
    v_smfmac_f32_32x32x32_bf16 a[224:239], a[104:107], v[48:55], v2
    s_waitcnt lgkmcnt(1)
    v_exp_f32 v24, v24
    v_exp_f32 v25, v25
    v_exp_f32 v26, v26
    v_exp_f32 v27, v27
    v_pk_add_f32 v[220:221], v[220:221], v[222:223]
    v_pk_add_f32 v[224:225], v[224:225], v[226:227]
    v_pk_add_f32 v[212:213], v[212:213], v[214:215]
    v_pk_add_f32 v[220:221], v[220:221], v[224:225]
    v_smfmac_f32_32x32x32_bf16 a[224:239], a[108:111], v[56:63], v2
    s_waitcnt lgkmcnt(0)
    v_exp_f32 v28, v28
    v_exp_f32 v29, v29
    v_rcp_f32 v222, v221
    v_subrev_u32 v223, s42, v221
    v_exp_f32 v30, v30
    v_exp_f32 v31, v31
    v_pk_add_f32 v[216:217], v[216:217], v[218:219]
    v_mul_f32 v236, v220, v222
    v_pk_add_f32 v[212:213], v[212:213], v[216:217]
    v_max_u32 v13, v13, v223
    v_pk_mul_f32 v[212:213], v[212:213], v[222:223] op_sel_hi:[1,0]
    v_cvt_pk_bf16_f32 v212, v212, v213
    v_mfma_f32_32x32x8_bf16 v[48:63], a[70:71], a[252:253], 0
    v_exp_f32 v32, v32
    v_exp_f32 v33, v33
    v_exp_f32 v34, v34
    v_exp_f32 v35, v35
    v_mfma_f32_32x32x16_bf16 v[48:63], a[24:27], a[244:247], v[48:63]
    ds_write_b32 v11, v212
    v_exp_f32 v36, v36
    v_exp_f32 v37, v37
    v_exp_f32 v38, v38
    v_exp_f32 v39, v39
    v_smfmac_f32_32x32x32_bf16 a[224:239], a[112:115], v[16:23], v2
    s_add_u32 s12, s12, s9
    s_addc_u32 s13, s13, 0
    v_exp_f32 v40, v40
    v_exp_f32 v41, v41
    v_exp_f32 v42, v42
    v_exp_f32 v43, v43
    v_smfmac_f32_32x32x32_bf16 a[224:239], a[116:119], v[24:31], v2
    s_waitcnt lgkmcnt(0)
    s_barrier
    v_exp_f32 v44, v44
    v_exp_f32 v45, v45
    v_exp_f32 v46, v46
    v_exp_f32 v47, v47
    v_mfma_f32_32x32x8_bf16 v[16:31], a[70:71], a[254:255], 0
    v_exp_f32 v48, v48
    v_exp_f32 v49, v49
    v_exp_f32 v50, v50
    v_exp_f32 v51, v51
    v_mfma_f32_32x32x16_bf16 v[16:31], a[28:31], a[244:247], v[16:31]
    ds_read_b128 v[228:231], v12 offset:10240
    v_exp_f32 v52, v52
    v_exp_f32 v53, v53
    v_exp_f32 v54, v54
    v_exp_f32 v55, v55
    v_smfmac_f32_32x32x32_bf16 a[224:239], a[120:123], v[32:39], v2
    s_add_u32 s40, s16, 2899968
    s_addc_u32 s41, s17, 0
    global_load_dwordx4 v[160:163], v6, s[38:39] offset:2048 sc1
    v_exp_f32 v56, v56
    v_exp_f32 v57, v57
    v_exp_f32 v58, v58
    v_exp_f32 v59, v59
    v_smfmac_f32_32x32x32_bf16 a[224:239], a[124:127], v[40:47], v2
    global_load_dwordx4 v[164:167], v6, s[38:39] offset:3072 sc1
    v_exp_f32 v60, v60
    v_exp_f32 v61, v61
    v_exp_f32 v62, v62
    v_exp_f32 v63, v63
    v_mfma_f32_32x32x8_bf16 v[32:47], a[72:73], a[252:253], 0
    v_exp_f32 v16, v16
    v_exp_f32 v17, v17
    v_exp_f32 v18, v18
    v_exp_f32 v19, v19
    v_mfma_f32_32x32x16_bf16 v[32:47], a[32:35], a[244:247], v[32:47]
    s_waitcnt vmcnt(14) lgkmcnt(0)
    v_exp_f32 v20, v20
    v_exp_f32 v21, v21
    v_exp_f32 v22, v22
    v_smfmac_f32_16x16x64_bf16 v[176:179], v[228:231], v[64:71], v3
    global_load_dwordx4 v[64:67], v6, s[40:41] offset:-4096 sc1
    global_load_dwordx4 v[68:71], v6, s[40:41] offset:-3072 sc1
    v_exp_f32 v23, v23
    v_smfmac_f32_32x32x32_bf16 a[224:239], a[128:131], v[48:55], v2
    ds_read2_b32 a[240:241], v4 offset0:216 offset1:217
    v_exp_f32 v24, v24
    v_exp_f32 v25, v25
    v_exp_f32 v26, v26
    v_exp_f32 v27, v27
    v_smfmac_f32_32x32x32_bf16 a[224:239], a[132:135], v[56:63], v2
    ds_read2_b32 a[242:243], v4 offset0:218 offset1:219
    v_exp_f32 v28, v28
    v_exp_f32 v29, v29
    v_exp_f32 v30, v30
    v_exp_f32 v31, v31
    v_mfma_f32_32x32x8_bf16 v[48:63], a[72:73], a[254:255], 0
    v_exp_f32 v32, v32
    v_exp_f32 v33, v33
    v_exp_f32 v34, v34
    v_exp_f32 v35, v35
    v_mfma_f32_32x32x16_bf16 v[48:63], a[36:39], a[244:247], v[48:63]
    ds_read_b32 a248, v5 offset:864
    v_exp_f32 v36, v36
    v_exp_f32 v37, v37
    v_exp_f32 v38, v38
    v_smfmac_f32_16x16x64_bf16 v[180:183], v[228:231], v[72:79], v3
    global_load_dwordx4 v[72:75], v6, s[40:41] offset:-2048 sc1
    global_load_dwordx4 v[76:79], v6, s[40:41] offset:-1024 sc1
    v_exp_f32 v39, v39
    v_smfmac_f32_32x32x32_bf16 a[224:239], a[136:139], v[16:23], v2
    ds_read_b32 a251, v5 offset:864
    v_exp_f32 v40, v40
    v_exp_f32 v41, v41
    v_exp_f32 v42, v42
    v_exp_f32 v43, v43
    v_smfmac_f32_32x32x32_bf16 a[224:239], a[140:143], v[24:31], v2
    s_add_u32 s68, s68, s9
    s_addc_u32 s69, s69, 0
    v_exp_f32 v44, v44
    v_exp_f32 v45, v45
    v_exp_f32 v46, v46
    v_exp_f32 v47, v47
    v_mfma_f32_32x32x8_bf16 v[16:31], a[74:75], a[252:253], 0
    v_exp_f32 v48, v48
    v_exp_f32 v49, v49
    v_exp_f32 v50, v50
    v_exp_f32 v51, v51
    v_mfma_f32_32x32x16_bf16 v[16:31], a[40:43], a[244:247], v[16:31]
    v_exp_f32 v52, v52
    v_exp_f32 v53, v53
    v_exp_f32 v54, v54
    v_smfmac_f32_16x16x64_bf16 v[184:187], v[228:231], v[80:87], v3
    global_load_dwordx4 v[80:83], v6, s[40:41] offset:0 sc1
    global_load_dwordx4 v[84:87], v6, s[40:41] offset:1024 sc1
    v_exp_f32 v55, v55
    v_smfmac_f32_32x32x32_bf16 a[224:239], a[144:147], v[32:39], v2
    s_add_u32 s12, s12, s8
    s_addc_u32 s13, s13, 0
    v_exp_f32 v56, v56
    v_exp_f32 v57, v57
    v_exp_f32 v58, v58
    v_exp_f32 v59, v59
    v_smfmac_f32_32x32x32_bf16 a[224:239], a[148:151], v[40:47], v2
    s_add_u32 s68, s68, s8
    s_addc_u32 s69, s69, 0
    v_exp_f32 v60, v60
    v_exp_f32 v61, v61
    v_exp_f32 v62, v62
    v_exp_f32 v63, v63
    v_mfma_f32_32x32x8_bf16 v[32:47], a[74:75], a[254:255], 0
    v_exp_f32 v16, v16
    v_exp_f32 v17, v17
    v_exp_f32 v18, v18
    v_exp_f32 v19, v19
    v_mfma_f32_32x32x16_bf16 v[32:47], a[44:47], a[244:247], v[32:47]
    s_waitcnt vmcnt(14)
    v_exp_f32 v20, v20
    v_exp_f32 v21, v21
    v_exp_f32 v22, v22
    v_smfmac_f32_16x16x64_bf16 v[188:191], v[228:231], v[88:95], v3
    global_load_dwordx4 v[88:91], v6, s[40:41] offset:2048 sc1
    global_load_dwordx4 v[92:95], v6, s[40:41] offset:3072 sc1
    v_exp_f32 v23, v23
    v_smfmac_f32_32x32x32_bf16 a[224:239], a[152:155], v[48:55], v2
    s_add_u32 s40, s16, 2908160
    s_addc_u32 s41, s17, 0
    v_exp_f32 v24, v24
    v_exp_f32 v25, v25
    v_exp_f32 v26, v26
    v_exp_f32 v27, v27
    v_smfmac_f32_32x32x32_bf16 a[224:239], a[156:159], v[56:63], v2
    v_exp_f32 v28, v28
    v_exp_f32 v29, v29
    v_exp_f32 v30, v30
    v_exp_f32 v31, v31
    v_mfma_f32_32x32x8_bf16 v[48:63], a[76:77], a[252:253], 0
    v_exp_f32 v32, v32
    v_exp_f32 v33, v33
    v_exp_f32 v34, v34
    v_exp_f32 v35, v35
    v_mfma_f32_32x32x16_bf16 v[48:63], a[48:51], a[244:247], v[48:63]
    v_exp_f32 v36, v36
    v_exp_f32 v37, v37
    v_exp_f32 v38, v38
    v_smfmac_f32_16x16x64_bf16 v[192:195], v[228:231], v[96:103], v3
    global_load_dwordx4 v[96:99], v6, s[40:41] offset:-4096 sc1
    global_load_dwordx4 v[100:103], v6, s[40:41] offset:-3072 sc1
    v_exp_f32 v39, v39
    v_smfmac_f32_32x32x32_bf16 a[224:239], a[160:163], v[16:23], v2
    v_exp_f32 v40, v40
    v_exp_f32 v41, v41
    v_exp_f32 v42, v42
    v_exp_f32 v43, v43
    v_smfmac_f32_32x32x32_bf16 a[224:239], a[164:167], v[24:31], v2
    v_exp_f32 v44, v44
    v_exp_f32 v45, v45
    v_exp_f32 v46, v46
    v_exp_f32 v47, v47
    v_mfma_f32_32x32x8_bf16 v[16:31], a[76:77], a[254:255], 0
    v_exp_f32 v48, v48
    v_exp_f32 v49, v49
    v_exp_f32 v50, v50
    v_exp_f32 v51, v51
    v_mfma_f32_32x32x16_bf16 v[16:31], a[52:55], a[244:247], v[16:31]
    v_exp_f32 v52, v52
    v_exp_f32 v53, v53
    v_exp_f32 v54, v54
    v_smfmac_f32_16x16x64_bf16 v[196:199], v[228:231], v[104:111], v3
    global_load_dwordx4 v[104:107], v6, s[40:41] offset:-2048 sc1
    global_load_dwordx4 v[108:111], v6, s[40:41] offset:-1024 sc1
    v_exp_f32 v55, v55
    v_smfmac_f32_32x32x32_bf16 a[224:239], a[168:171], v[32:39], v2
    v_exp_f32 v56, v56
    v_exp_f32 v57, v57
    v_exp_f32 v58, v58
    v_exp_f32 v59, v59
    v_smfmac_f32_32x32x32_bf16 a[224:239], a[172:175], v[40:47], v2
    v_exp_f32 v60, v60
    v_exp_f32 v61, v61
    v_exp_f32 v62, v62
    v_exp_f32 v63, v63
    v_mfma_f32_32x32x8_bf16 v[32:47], a[78:79], a[252:253], 0
    v_exp_f32 v16, v16
    v_exp_f32 v17, v17
    v_exp_f32 v18, v18
    v_exp_f32 v19, v19
    v_mfma_f32_32x32x16_bf16 v[32:47], a[56:59], a[244:247], v[32:47]
    s_waitcnt vmcnt(14)
    v_exp_f32 v20, v20
    v_exp_f32 v21, v21
    v_exp_f32 v22, v22
    v_smfmac_f32_16x16x64_bf16 v[200:203], v[228:231], v[112:119], v3
    global_load_dwordx4 v[112:115], v6, s[40:41] offset:0 sc1
    global_load_dwordx4 v[116:119], v6, s[40:41] offset:1024 sc1
    v_exp_f32 v23, v23
    v_smfmac_f32_32x32x32_bf16 a[224:239], a[176:179], v[48:55], v2
    v_exp_f32 v24, v24
    v_exp_f32 v25, v25
    v_exp_f32 v26, v26
    v_exp_f32 v27, v27
    v_smfmac_f32_32x32x32_bf16 a[224:239], a[180:183], v[56:63], v2
    v_exp_f32 v28, v28
    v_exp_f32 v29, v29
    v_exp_f32 v30, v30
    v_exp_f32 v31, v31
    v_mfma_f32_32x32x8_bf16 v[48:63], a[78:79], a[254:255], 0
    v_exp_f32 v32, v32
    v_exp_f32 v33, v33
    v_exp_f32 v34, v34
    v_exp_f32 v35, v35
    v_mfma_f32_32x32x16_bf16 v[48:63], a[60:63], a[244:247], v[48:63]
    v_exp_f32 v36, v36
    v_exp_f32 v37, v37
    v_exp_f32 v38, v38
    v_smfmac_f32_16x16x64_bf16 v[204:207], v[228:231], v[120:127], v3
    global_load_dwordx4 v[120:123], v6, s[40:41] offset:2048 sc1
    global_load_dwordx4 v[124:127], v6, s[40:41] offset:3072 sc1
    v_exp_f32 v39, v39
    v_smfmac_f32_32x32x32_bf16 a[224:239], a[184:187], v[16:23], v2
    s_add_u32 s40, s16, 2916352
    s_addc_u32 s41, s17, 0
    v_exp_f32 v40, v40
    v_exp_f32 v41, v41
    v_exp_f32 v42, v42
    v_exp_f32 v43, v43
    v_smfmac_f32_32x32x32_bf16 a[224:239], a[188:191], v[24:31], v2
    s_waitcnt lgkmcnt(0)
    v_exp_f32 v44, v44
    v_exp_f32 v45, v45
    v_exp_f32 v46, v46
    v_exp_f32 v47, v47
    v_mfma_f32_32x32x8_bf16 v[16:31], a[64:65], a[248:249], 0
    v_exp_f32 v48, v48
    v_exp_f32 v49, v49
    v_exp_f32 v50, v50
    v_exp_f32 v51, v51
    v_mfma_f32_32x32x16_bf16 v[16:31], a[0:3], a[240:243], v[16:31]
    v_exp_f32 v52, v52
    v_exp_f32 v53, v53
    v_exp_f32 v54, v54
    v_smfmac_f32_16x16x64_bf16 v[208:211], v[228:231], v[128:135], v3
    global_load_dwordx4 v[128:131], v6, s[40:41] offset:-4096 sc1
    global_load_dwordx4 v[132:135], v6, s[40:41] offset:-3072 sc1
    v_exp_f32 v55, v55
    v_smfmac_f32_32x32x32_bf16 a[224:239], a[192:195], v[32:39], v2
    v_exp_f32 v56, v56
    v_exp_f32 v57, v57
    v_exp_f32 v58, v58
    v_exp_f32 v59, v59
    v_smfmac_f32_32x32x32_bf16 a[224:239], a[196:199], v[40:47], v2
    v_exp_f32 v60, v60
    v_exp_f32 v61, v61
    v_exp_f32 v62, v62
    v_exp_f32 v63, v63
    v_mfma_f32_32x32x8_bf16 v[32:47], a[64:65], a[250:251], 0
    v_exp_f32 v16, v16
    v_exp_f32 v17, v17
    v_exp_f32 v18, v18
    v_exp_f32 v19, v19
    v_mfma_f32_32x32x16_bf16 v[32:47], a[4:7], a[240:243], v[32:47]
    v_exp_f32 v20, v20
    v_exp_f32 v21, v21
    v_exp_f32 v22, v22
    v_exp_f32 v23, v23
    v_smfmac_f32_32x32x32_bf16 a[224:239], a[200:203], v[48:55], v2
    v_exp_f32 v24, v24
    v_exp_f32 v25, v25
    v_exp_f32 v26, v26
    v_exp_f32 v27, v27
    v_smfmac_f32_32x32x32_bf16 a[224:239], a[204:207], v[56:63], v2
    s_add_u32 m0, s50, 32768
    s_cbranch_vccz L_skip10
    buffer_load_dwordx4 v248, s[12:15], 0 offen lds
    buffer_load_dwordx4 v248, s[68:71], 0 offen offset:1024 lds
    s_branch L_skip10j
L_skip10:
    buffer_load_dword v250, v248, s[12:15], 0 offen
    buffer_load_dword v250, v248, s[68:71], 0 offen offset:1024
L_skip10j:
    v_exp_f32 v28, v28
    v_exp_f32 v29, v29
    v_exp_f32 v30, v30
    v_exp_f32 v31, v31
    v_mfma_f32_32x32x8_bf16 v[48:63], a[66:67], a[248:249], 0
    v_exp_f32 v32, v32
    v_exp_f32 v33, v33
    v_exp_f32 v34, v34
    v_exp_f32 v35, v35
    v_mfma_f32_32x32x16_bf16 v[48:63], a[8:11], a[240:243], v[48:63]
    v_exp_f32 v36, v36
    v_exp_f32 v37, v37
    v_exp_f32 v38, v38
    v_exp_f32 v39, v39
    v_smfmac_f32_32x32x32_bf16 a[208:223], a[80:83], v[16:23], v2
    ds_write_b128 v7, a[224:227]
    v_exp_f32 v40, v40
    v_exp_f32 v41, v41
    v_exp_f32 v42, v42
    v_exp_f32 v43, v43
    v_smfmac_f32_32x32x32_bf16 a[208:223], a[84:87], v[24:31], v2
    ds_write_b128 v7, a[228:231] offset:1024
    s_add_u32 m0, s50, 40960
    s_cbranch_vccz L_skip11
    buffer_load_dwordx4 v252, s[12:15], 0 offen lds
    buffer_load_dwordx4 v252, s[68:71], 0 offen offset:1024 lds
L_skip11:
    v_exp_f32 v44, v44
    v_exp_f32 v45, v45
    v_exp_f32 v46, v46
    v_exp_f32 v47, v47
    v_mfma_f32_32x32x8_bf16 v[16:31], a[66:67], a[250:251], 0
    v_exp_f32 v48, v48
    v_exp_f32 v49, v49
    v_exp_f32 v50, v50
    v_exp_f32 v51, v51
    v_mfma_f32_32x32x16_bf16 v[16:31], a[12:15], a[240:243], v[16:31]
    ds_write_b64 v8, a[232:233]
    v_exp_f32 v52, v52
    v_exp_f32 v53, v53
    v_exp_f32 v54, v54
    v_exp_f32 v55, v55
    v_smfmac_f32_32x32x32_bf16 a[208:223], a[88:91], v[32:39], v2
    s_add_u32 m0, s51, 4096
    s_cbranch_vccz L_skip4
    buffer_load_dwordx4 v12, s[28:31], 0 offen offset:2048 lds
    buffer_load_dwordx4 v12, s[28:31], 0 offen offset:3072 lds
L_skip4:
    v_exp_f32 v56, v56
    v_exp_f32 v57, v57
    v_exp_f32 v58, v58
    v_exp_f32 v59, v59
    v_smfmac_f32_32x32x32_bf16 a[208:223], a[92:95], v[40:47], v2
    s_waitcnt lgkmcnt(0)
    s_barrier
    v_exp_f32 v60, v60
    v_exp_f32 v61, v61
    v_exp_f32 v62, v62
    v_exp_f32 v63, v63
    v_mfma_f32_32x32x8_bf16 v[32:47], a[68:69], a[248:249], 0
    v_exp_f32 v16, v16
    v_exp_f32 v17, v17
    v_exp_f32 v18, v18
    v_exp_f32 v19, v19
    v_mfma_f32_32x32x16_bf16 v[32:47], a[16:19], a[240:243], v[32:47]
    s_add_u32 s28, s28, 4096
    s_addc_u32 s29, s29, 0
    ds_read2st64_b64 v[220:223], v10 offset0:4 offset1:9
    v_exp_f32 v20, v20
    v_exp_f32 v21, v21
    v_exp_f32 v22, v22
    v_smfmac_f32_32x32x32_bf16 a[208:223], a[96:99], v[48:55], v2
    ds_read2st64_b64 v[224:227], v10 offset0:14 offset1:19
    v_exp_f32 v23, v23
    v_exp_f32 v24, v24
    v_exp_f32 v25, v25
    v_mfma_f32_32x32x8_bf16 a[224:239], v[14:15], v[14:15], 0
    v_exp_f32 v26, v26
    v_exp_f32 v27, v27
    v_exp_f32 v28, v28
    v_smfmac_f32_32x32x32_bf16 a[208:223], a[100:103], v[56:63], v2
    ds_read2st64_b64 v[212:215], v9 offset0:0 offset1:5
    s_add_u32 m0, s51, 8192
    s_cbranch_vccz L_skip5
    buffer_load_dwordx4 v12, s[28:31], 0 offen offset:0 lds
L_skip5:
    v_exp_f32 v29, v29
    v_exp_f32 v30, v30
    v_exp_f32 v31, v31
    v_mfma_f32_32x32x8_bf16 v[48:63], a[68:69], a[250:251], 0
    v_exp_f32 v32, v32
    v_exp_f32 v33, v33
    v_exp_f32 v34, v34
    v_exp_f32 v35, v35
    v_mfma_f32_32x32x16_bf16 v[48:63], a[20:23], a[240:243], v[48:63]
    ds_read2st64_b64 v[216:219], v9 offset0:10 offset1:15
    v_exp_f32 v36, v36
    v_exp_f32 v37, v37
    v_exp_f32 v38, v38
    v_exp_f32 v39, v39
    v_smfmac_f32_32x32x32_bf16 a[208:223], a[104:107], v[16:23], v2
    s_waitcnt lgkmcnt(1)
    v_exp_f32 v40, v40
    v_exp_f32 v41, v41
    v_exp_f32 v42, v42
    v_exp_f32 v43, v43
    v_pk_add_f32 v[220:221], v[220:221], v[222:223]
    v_pk_add_f32 v[224:225], v[224:225], v[226:227]
    v_pk_add_f32 v[212:213], v[212:213], v[214:215]
    v_pk_add_f32 v[220:221], v[220:221], v[224:225]
    v_smfmac_f32_32x32x32_bf16 a[208:223], a[108:111], v[24:31], v2
    s_waitcnt lgkmcnt(0)
    v_exp_f32 v44, v44
    v_exp_f32 v45, v45
    v_rcp_f32 v222, v221
    v_subrev_u32 v223, s42, v221
    v_exp_f32 v46, v46
    v_exp_f32 v47, v47
    v_pk_add_f32 v[216:217], v[216:217], v[218:219]
    v_mul_f32 v237, v220, v222
    v_pk_add_f32 v[212:213], v[212:213], v[216:217]
    v_max_u32 v13, v13, v223
    v_pk_mul_f32 v[212:213], v[212:213], v[222:223] op_sel_hi:[1,0]
    v_cvt_pk_bf16_f32 v212, v212, v213
    v_mfma_f32_32x32x8_bf16 v[16:31], a[70:71], a[248:249], 0
    v_exp_f32 v48, v48
    v_exp_f32 v49, v49
    v_exp_f32 v50, v50
    v_exp_f32 v51, v51
    v_mfma_f32_32x32x16_bf16 v[16:31], a[24:27], a[240:243], v[16:31]
    ds_write_b32 v11, v212
    v_exp_f32 v52, v52
    v_exp_f32 v53, v53
    v_cvt_pk_bf16_f32 v234, v236, v237
    v_exp_f32 v54, v54
    v_exp_f32 v55, v55
    v_smfmac_f32_32x32x32_bf16 a[208:223], a[112:115], v[32:39], v2
    s_add_u32 s12, s12, s8
    s_addc_u32 s13, s13, 0
    v_exp_f32 v56, v56
    v_exp_f32 v57, v57
    v_exp_f32 v58, v58
    v_exp_f32 v59, v59
    v_smfmac_f32_32x32x32_bf16 a[208:223], a[116:119], v[40:47], v2
    s_waitcnt lgkmcnt(0)
    s_barrier
    v_exp_f32 v60, v60
    v_exp_f32 v61, v61
    v_exp_f32 v62, v62
    v_exp_f32 v63, v63
    v_mfma_f32_32x32x8_bf16 v[32:47], a[70:71], a[250:251], 0
    v_exp_f32 v16, v16
    v_exp_f32 v17, v17
    v_exp_f32 v18, v18
    v_exp_f32 v19, v19
    v_mfma_f32_32x32x16_bf16 v[32:47], a[28:31], a[240:243], v[32:47]
    ds_read_b128 v[228:231], v12 offset:10240
    v_exp_f32 v20, v20
    v_exp_f32 v21, v21
    v_exp_f32 v22, v22
    v_exp_f32 v23, v23
    v_smfmac_f32_32x32x32_bf16 a[208:223], a[120:123], v[48:55], v2
    s_add_u32 s40, s16, 2973696
    s_addc_u32 s41, s17, 0
    s_add_u32 s38, s16, 3129344
    s_addc_u32 s39, s17, 0
    v_exp_f32 v24, v24
    v_exp_f32 v25, v25
    v_exp_f32 v26, v26
    v_exp_f32 v27, v27
    v_smfmac_f32_32x32x32_bf16 a[208:223], a[124:127], v[56:63], v2
    global_load_dwordx4 v[168:171], v6, s[38:39] offset:-4096 sc1
    global_load_dwordx4 v[172:175], v6, s[38:39] offset:-3072 sc1
    v_exp_f32 v28, v28
    v_exp_f32 v29, v29
    v_exp_f32 v30, v30
    v_exp_f32 v31, v31
    v_mfma_f32_32x32x8_bf16 v[48:63], a[72:73], a[248:249], 0
    v_exp_f32 v32, v32
    v_exp_f32 v33, v33
    v_exp_f32 v34, v34
    v_exp_f32 v35, v35
    v_mfma_f32_32x32x16_bf16 v[48:63], a[32:35], a[240:243], v[48:63]
    s_waitcnt vmcnt(14) lgkmcnt(0)
    v_exp_f32 v36, v36
    v_exp_f32 v37, v37
    v_exp_f32 v38, v38
    v_smfmac_f32_16x16x64_bf16 v[176:179], v[228:231], v[64:71], v3
    global_load_dwordx4 v[64:67], v6, s[40:41] offset:-4096 sc1
    global_load_dwordx4 v[68:71], v6, s[40:41] offset:-3072 sc1
    v_exp_f32 v39, v39
    v_smfmac_f32_32x32x32_bf16 a[208:223], a[128:131], v[16:23], v2
    ds_read2_b32 a[244:245], v4 offset0:252 offset1:253
    v_exp_f32 v40, v40
    v_exp_f32 v41, v41
    v_exp_f32 v42, v42
    v_exp_f32 v43, v43
    v_smfmac_f32_32x32x32_bf16 a[208:223], a[132:135], v[24:31], v2
    ds_read2_b32 a[246:247], v4 offset0:254 offset1:255
    v_exp_f32 v44, v44
    v_exp_f32 v45, v45
    v_exp_f32 v46, v46
    v_exp_f32 v47, v47
    v_mfma_f32_32x32x8_bf16 v[16:31], a[72:73], a[250:251], 0
    v_exp_f32 v48, v48
    v_exp_f32 v49, v49
    v_exp_f32 v50, v50
    v_exp_f32 v51, v51
    v_mfma_f32_32x32x16_bf16 v[16:31], a[36:39], a[240:243], v[16:31]
    ds_read_b32 a252, v5 offset:1008
    v_exp_f32 v52, v52
    v_exp_f32 v53, v53
    v_exp_f32 v54, v54
    v_smfmac_f32_16x16x64_bf16 v[180:183], v[228:231], v[72:79], v3
    global_load_dwordx4 v[72:75], v6, s[40:41] offset:-2048 sc1
    global_load_dwordx4 v[76:79], v6, s[40:41] offset:-1024 sc1
    v_exp_f32 v55, v55
    v_smfmac_f32_32x32x32_bf16 a[208:223], a[136:139], v[32:39], v2
    ds_read_b32 a255, v5 offset:1008
    v_exp_f32 v56, v56
    v_exp_f32 v57, v57
    v_exp_f32 v58, v58
    v_exp_f32 v59, v59
    v_smfmac_f32_32x32x32_bf16 a[208:223], a[140:143], v[40:47], v2
    s_add_u32 s68, s68, s8
    s_addc_u32 s69, s69, 0
    v_exp_f32 v60, v60
    v_exp_f32 v61, v61
    v_exp_f32 v62, v62
    v_exp_f32 v63, v63
    v_mfma_f32_32x32x8_bf16 v[32:47], a[74:75], a[248:249], 0
    v_exp_f32 v16, v16
    v_exp_f32 v17, v17
    v_exp_f32 v18, v18
    v_exp_f32 v19, v19
    v_mfma_f32_32x32x16_bf16 v[32:47], a[40:43], a[240:243], v[32:47]
    v_exp_f32 v20, v20
    v_exp_f32 v21, v21
    v_exp_f32 v22, v22
    v_smfmac_f32_16x16x64_bf16 v[184:187], v[228:231], v[80:87], v3
    global_load_dwordx4 v[80:83], v6, s[40:41] offset:0 sc1
    global_load_dwordx4 v[84:87], v6, s[40:41] offset:1024 sc1
    v_exp_f32 v23, v23
    v_smfmac_f32_32x32x32_bf16 a[208:223], a[144:147], v[48:55], v2
    v_exp_f32 v24, v24
    v_exp_f32 v25, v25
    v_exp_f32 v26, v26
    v_exp_f32 v27, v27
    v_smfmac_f32_32x32x32_bf16 a[208:223], a[148:151], v[56:63], v2
    v_exp_f32 v28, v28
    v_exp_f32 v29, v29
    v_exp_f32 v30, v30
    v_exp_f32 v31, v31
    v_mfma_f32_32x32x8_bf16 v[48:63], a[74:75], a[250:251], 0
    v_exp_f32 v32, v32
    v_exp_f32 v33, v33
    v_exp_f32 v34, v34
    v_exp_f32 v35, v35
    v_mfma_f32_32x32x16_bf16 v[48:63], a[44:47], a[240:243], v[48:63]
    s_waitcnt vmcnt(14)
    v_exp_f32 v36, v36
    v_exp_f32 v37, v37
    v_exp_f32 v38, v38
    v_smfmac_f32_16x16x64_bf16 v[188:191], v[228:231], v[88:95], v3
    global_load_dwordx4 v[88:91], v6, s[40:41] offset:2048 sc1
    global_load_dwordx4 v[92:95], v6, s[40:41] offset:3072 sc1
    v_exp_f32 v39, v39
    v_smfmac_f32_32x32x32_bf16 a[208:223], a[152:155], v[16:23], v2
    s_add_u32 s40, s16, 2981888
    s_addc_u32 s41, s17, 0
    v_exp_f32 v40, v40
    v_exp_f32 v41, v41
    v_exp_f32 v42, v42
    v_exp_f32 v43, v43
    v_smfmac_f32_32x32x32_bf16 a[208:223], a[156:159], v[24:31], v2
    v_exp_f32 v44, v44
    v_exp_f32 v45, v45
    v_exp_f32 v46, v46
    v_exp_f32 v47, v47
    v_mfma_f32_32x32x8_bf16 v[16:31], a[76:77], a[248:249], 0
    v_exp_f32 v48, v48
    v_exp_f32 v49, v49
    v_exp_f32 v50, v50
    v_exp_f32 v51, v51
    v_mfma_f32_32x32x16_bf16 v[16:31], a[48:51], a[240:243], v[16:31]
L_padb3:
    s_cbranch_execz L_padb7
    v_exp_f32 v52, v52
    v_exp_f32 v53, v53
    v_exp_f32 v54, v54
    v_smfmac_f32_16x16x64_bf16 v[192:195], v[228:231], v[96:103], v3
    global_load_dwordx4 v[96:99], v6, s[40:41] offset:-4096 sc1
    global_load_dwordx4 v[100:103], v6, s[40:41] offset:-3072 sc1
    v_exp_f32 v55, v55
    v_smfmac_f32_32x32x32_bf16 a[208:223], a[160:163], v[32:39], v2
    v_exp_f32 v56, v56
    v_exp_f32 v57, v57
    v_exp_f32 v58, v58
    v_exp_f32 v59, v59
    v_smfmac_f32_32x32x32_bf16 a[208:223], a[164:167], v[40:47], v2
    v_exp_f32 v60, v60
    v_exp_f32 v61, v61
    v_exp_f32 v62, v62
    v_exp_f32 v63, v63
    v_mfma_f32_32x32x8_bf16 v[32:47], a[76:77], a[250:251], 0
    v_exp_f32 v16, v16
    v_exp_f32 v17, v17
    v_exp_f32 v18, v18
    v_exp_f32 v19, v19
    v_mfma_f32_32x32x16_bf16 v[32:47], a[52:55], a[240:243], v[32:47]
    v_exp_f32 v20, v20
    v_exp_f32 v21, v21
    v_exp_f32 v22, v22
    v_smfmac_f32_16x16x64_bf16 v[196:199], v[228:231], v[104:111], v3
    global_load_dwordx4 v[104:107], v6, s[40:41] offset:-2048 sc1
    global_load_dwordx4 v[108:111], v6, s[40:41] offset:-1024 sc1
    v_exp_f32 v23, v23
    v_smfmac_f32_32x32x32_bf16 a[208:223], a[168:171], v[48:55], v2
    v_exp_f32 v24, v24
    v_exp_f32 v25, v25
    v_exp_f32 v26, v26
    v_exp_f32 v27, v27
    v_smfmac_f32_32x32x32_bf16 a[208:223], a[172:175], v[56:63], v2
    v_exp_f32 v28, v28
    v_exp_f32 v29, v29
    v_exp_f32 v30, v30
    v_exp_f32 v31, v31
    v_mfma_f32_32x32x8_bf16 v[48:63], a[78:79], a[248:249], 0
    v_exp_f32 v32, v32
    v_exp_f32 v33, v33
    v_exp_f32 v34, v34
    v_exp_f32 v35, v35
    v_mfma_f32_32x32x16_bf16 v[48:63], a[56:59], a[240:243], v[48:63]
    s_waitcnt vmcnt(14)
    v_exp_f32 v36, v36
    v_exp_f32 v37, v37
    v_exp_f32 v38, v38
    v_smfmac_f32_16x16x64_bf16 v[200:203], v[228:231], v[112:119], v3
    global_load_dwordx4 v[112:115], v6, s[40:41] offset:0 sc1
    global_load_dwordx4 v[116:119], v6, s[40:41] offset:1024 sc1
    v_exp_f32 v39, v39
    v_smfmac_f32_32x32x32_bf16 a[208:223], a[176:179], v[16:23], v2
    v_exp_f32 v40, v40
    v_exp_f32 v41, v41
    v_exp_f32 v42, v42
    v_exp_f32 v43, v43
    v_smfmac_f32_32x32x32_bf16 a[208:223], a[180:183], v[24:31], v2
    v_exp_f32 v44, v44
    v_exp_f32 v45, v45
    v_exp_f32 v46, v46
    v_exp_f32 v47, v47
    v_mfma_f32_32x32x8_bf16 v[16:31], a[78:79], a[250:251], 0
    v_exp_f32 v48, v48
    v_exp_f32 v49, v49
    v_exp_f32 v50, v50
    v_exp_f32 v51, v51
    v_mfma_f32_32x32x16_bf16 v[16:31], a[60:63], a[240:243], v[16:31]
    v_exp_f32 v52, v52
    v_exp_f32 v53, v53
    v_exp_f32 v54, v54
    v_smfmac_f32_16x16x64_bf16 v[204:207], v[228:231], v[120:127], v3
    global_load_dwordx4 v[120:123], v6, s[40:41] offset:2048 sc1
    global_load_dwordx4 v[124:127], v6, s[40:41] offset:3072 sc1
    v_exp_f32 v55, v55
    v_smfmac_f32_32x32x32_bf16 a[208:223], a[184:187], v[32:39], v2
    s_add_u32 s40, s16, 2990080
    s_addc_u32 s41, s17, 0
    v_exp_f32 v56, v56
    v_exp_f32 v57, v57
    v_exp_f32 v58, v58
    v_exp_f32 v59, v59
    v_smfmac_f32_32x32x32_bf16 a[208:223], a[188:191], v[40:47], v2
    s_waitcnt lgkmcnt(0)
    v_exp_f32 v60, v60
    v_exp_f32 v61, v61
    v_exp_f32 v62, v62
    v_exp_f32 v63, v63
    v_mfma_f32_32x32x8_bf16 v[32:47], a[64:65], a[252:253], 0
    v_exp_f32 v16, v16
    v_exp_f32 v17, v17
    v_exp_f32 v18, v18
    v_exp_f32 v19, v19
    v_mfma_f32_32x32x16_bf16 v[32:47], a[0:3], a[244:247], v[32:47]
    v_exp_f32 v20, v20
    v_exp_f32 v21, v21
    v_exp_f32 v22, v22
    v_smfmac_f32_16x16x64_bf16 v[208:211], v[228:231], v[128:135], v3
    global_load_dwordx4 v[128:131], v6, s[40:41] offset:-4096 sc1
    global_load_dwordx4 v[132:135], v6, s[40:41] offset:-3072 sc1
    v_exp_f32 v23, v23
    v_smfmac_f32_32x32x32_bf16 a[208:223], a[192:195], v[48:55], v2
    v_exp_f32 v24, v24
    v_exp_f32 v25, v25
    v_exp_f32 v26, v26
    v_exp_f32 v27, v27
    v_smfmac_f32_32x32x32_bf16 a[208:223], a[196:199], v[56:63], v2
    v_exp_f32 v28, v28
    v_exp_f32 v29, v29
    v_exp_f32 v30, v30
    v_exp_f32 v31, v31
    v_mfma_f32_32x32x8_bf16 v[48:63], a[64:65], a[254:255], 0
    v_exp_f32 v32, v32
    v_exp_f32 v33, v33
    v_exp_f32 v34, v34
    v_exp_f32 v35, v35
    v_mfma_f32_32x32x16_bf16 v[48:63], a[4:7], a[244:247], v[48:63]
    v_exp_f32 v36, v36
    v_exp_f32 v37, v37
    v_exp_f32 v38, v38
    v_exp_f32 v39, v39
    v_smfmac_f32_32x32x32_bf16 a[208:223], a[200:203], v[16:23], v2
    v_exp_f32 v40, v40
    v_exp_f32 v41, v41
    v_exp_f32 v42, v42
    v_exp_f32 v43, v43
    v_smfmac_f32_32x32x32_bf16 a[208:223], a[204:207], v[24:31], v2
    s_add_u32 m0, s50, 49152
    s_cbranch_vccz L_skip12
    buffer_load_dwordx4 v248, s[12:15], 0 offen lds
    buffer_load_dwordx4 v248, s[68:71], 0 offen offset:1024 lds
L_skip12:
    v_exp_f32 v44, v44
    v_exp_f32 v45, v45
    v_exp_f32 v46, v46
    v_exp_f32 v47, v47
    v_mfma_f32_32x32x8_bf16 v[16:31], a[66:67], a[252:253], 0
    v_exp_f32 v48, v48
    v_exp_f32 v49, v49
    v_exp_f32 v50, v50
    v_exp_f32 v51, v51
    v_mfma_f32_32x32x16_bf16 v[16:31], a[8:11], a[244:247], v[16:31]
    v_exp_f32 v52, v52
    v_exp_f32 v53, v53
    v_exp_f32 v54, v54
    v_exp_f32 v55, v55
    v_smfmac_f32_32x32x32_bf16 a[224:239], a[80:83], v[32:39], v2
    ds_write_b128 v7, a[208:211]
    v_exp_f32 v56, v56
    v_exp_f32 v57, v57
    v_exp_f32 v58, v58
    v_exp_f32 v59, v59
    v_smfmac_f32_32x32x32_bf16 a[224:239], a[84:87], v[40:47], v2
    ds_write_b128 v7, a[212:215] offset:1024
    s_add_u32 m0, s50, 57344
    s_cbranch_vccz L_skip13
    buffer_load_dwordx4 v252, s[12:15], 0 offen lds
    buffer_load_dwordx4 v252, s[68:71], 0 offen offset:1024 lds
L_skip13:
    v_exp_f32 v60, v60
    v_exp_f32 v61, v61
    v_exp_f32 v62, v62
    v_exp_f32 v63, v63
    v_mfma_f32_32x32x8_bf16 v[32:47], a[66:67], a[254:255], 0
    s_add_u32 s68, s68, s8
    s_addc_u32 s69, s69, 0
    v_exp_f32 v16, v16
    v_exp_f32 v17, v17
    v_exp_f32 v18, v18
    v_exp_f32 v19, v19
    v_mfma_f32_32x32x16_bf16 v[32:47], a[12:15], a[244:247], v[32:47]
    s_add_u32 s12, s12, s8
    s_addc_u32 s13, s13, 0
    ds_write_b64 v8, a[216:217]
    v_exp_f32 v20, v20
    v_exp_f32 v21, v21
    v_exp_f32 v22, v22
    v_exp_f32 v23, v23
    v_smfmac_f32_32x32x32_bf16 a[224:239], a[88:91], v[48:55], v2
    s_add_u32 m0, s50, 65536
    s_cbranch_vccz L_skip14
    buffer_load_dwordx4 v248, s[12:15], 0 offen lds
    buffer_load_dwordx4 v248, s[68:71], 0 offen offset:1024 lds
L_skip14:
    v_exp_f32 v24, v24
    v_exp_f32 v25, v25
    v_exp_f32 v26, v26
    v_exp_f32 v27, v27
    v_smfmac_f32_32x32x32_bf16 a[224:239], a[92:95], v[56:63], v2
    s_waitcnt lgkmcnt(0)
    s_barrier
    v_exp_f32 v28, v28
    v_exp_f32 v29, v29
    v_exp_f32 v30, v30
    v_exp_f32 v31, v31
    v_mfma_f32_32x32x8_bf16 v[48:63], a[68:69], a[252:253], 0
    v_exp_f32 v32, v32
    v_exp_f32 v33, v33
    v_exp_f32 v34, v34
    v_exp_f32 v35, v35
    v_mfma_f32_32x32x16_bf16 v[48:63], a[16:19], a[244:247], v[48:63]
    ds_read2st64_b64 v[220:223], v10 offset0:4 offset1:9
    v_exp_f32 v36, v36
    v_exp_f32 v37, v37
    v_exp_f32 v38, v38
    v_exp_f32 v39, v39
    v_smfmac_f32_32x32x32_bf16 a[224:239], a[96:99], v[16:23], v2
    global_load_dwordx4 a[80:83], v6, s[38:39] offset:-2048 sc1
    ds_read2st64_b64 v[224:227], v10 offset0:14 offset1:19
    v_exp_f32 v40, v40
    v_exp_f32 v41, v41
    v_exp_f32 v42, v42
    v_exp_f32 v43, v43
    v_smfmac_f32_32x32x32_bf16 a[224:239], a[100:103], v[24:31], v2
    global_load_dwordx4 a[84:87], v6, s[38:39] offset:-1024 sc1
    ds_read2st64_b64 v[212:215], v9 offset0:0 offset1:5
    v_exp_f32 v44, v44
    v_exp_f32 v45, v45
    v_exp_f32 v46, v46
    v_exp_f32 v47, v47
    v_mfma_f32_32x32x8_bf16 v[16:31], a[68:69], a[254:255], 0
    v_exp_f32 v48, v48
    v_exp_f32 v49, v49
    v_exp_f32 v50, v50
    v_exp_f32 v51, v51
    v_mfma_f32_32x32x16_bf16 v[16:31], a[20:23], a[244:247], v[16:31]
    ds_read2st64_b64 v[216:219], v9 offset0:10 offset1:15
    v_exp_f32 v52, v52
    v_exp_f32 v53, v53
    v_exp_f32 v54, v54
    v_exp_f32 v55, v55
    v_smfmac_f32_32x32x32_bf16 a[224:239], a[104:107], v[32:39], v2
    s_waitcnt lgkmcnt(1)
    global_load_dwordx4 a[88:91], v6, s[38:39] offset:0 sc1
    v_exp_f32 v56, v56
    v_exp_f32 v57, v57
    v_exp_f32 v58, v58
    v_exp_f32 v59, v59
    v_pk_add_f32 v[220:221], v[220:221], v[222:223]
    v_pk_add_f32 v[224:225], v[224:225], v[226:227]
    v_pk_add_f32 v[212:213], v[212:213], v[214:215]
    v_pk_add_f32 v[220:221], v[220:221], v[224:225]
    v_smfmac_f32_32x32x32_bf16 a[224:239], a[108:111], v[40:47], v2
    s_waitcnt lgkmcnt(0)
    global_load_dwordx4 a[92:95], v6, s[38:39] offset:1024 sc1
    v_exp_f32 v60, v60
    v_exp_f32 v61, v61
    v_rcp_f32 v222, v221
    v_subrev_u32 v223, s42, v221
    v_exp_f32 v62, v62
    v_exp_f32 v63, v63
    v_pk_add_f32 v[216:217], v[216:217], v[218:219]
    v_mul_f32 v236, v220, v222
    v_pk_add_f32 v[212:213], v[212:213], v[216:217]
    v_max_u32 v13, v13, v223
    v_pk_mul_f32 v[212:213], v[212:213], v[222:223] op_sel_hi:[1,0]
    v_cvt_pk_bf16_f32 v212, v212, v213
    v_mfma_f32_32x32x8_bf16 v[32:47], a[70:71], a[252:253], 0
    v_exp_f32 v16, v16
    v_exp_f32 v17, v17
    v_exp_f32 v18, v18
    v_exp_f32 v19, v19
    v_mfma_f32_32x32x16_bf16 v[32:47], a[24:27], a[244:247], v[32:47]
    ds_write_b32 v11, v212
    v_exp_f32 v20, v20
    v_exp_f32 v21, v21
    v_exp_f32 v22, v22
    v_exp_f32 v23, v23
    v_smfmac_f32_32x32x32_bf16 a[224:239], a[112:115], v[48:55], v2
    v_exp_f32 v24, v24
    v_exp_f32 v25, v25
    v_exp_f32 v26, v26
    v_exp_f32 v27, v27
    v_smfmac_f32_32x32x32_bf16 a[224:239], a[116:119], v[56:63], v2
    s_waitcnt lgkmcnt(0)
    s_barrier
    v_exp_f32 v28, v28
    v_exp_f32 v29, v29
    v_exp_f32 v30, v30
    v_exp_f32 v31, v31
    v_mfma_f32_32x32x8_bf16 v[48:63], a[70:71], a[254:255], 0
    v_exp_f32 v32, v32
    v_exp_f32 v33, v33
    v_exp_f32 v34, v34
    v_exp_f32 v35, v35
    v_mfma_f32_32x32x16_bf16 v[48:63], a[28:31], a[244:247], v[48:63]
    ds_read_b128 v[228:231], v12 offset:10240
    v_exp_f32 v36, v36
    v_exp_f32 v37, v37
    v_exp_f32 v38, v38
    v_exp_f32 v39, v39
    v_smfmac_f32_32x32x32_bf16 a[224:239], a[120:123], v[16:23], v2
    global_load_dwordx4 a[96:99], v6, s[38:39] offset:2048 sc1
    global_load_dwordx4 a[100:103], v6, s[38:39] offset:3072 sc1
    v_exp_f32 v40, v40
    v_exp_f32 v41, v41
    v_exp_f32 v42, v42
    v_exp_f32 v43, v43
    v_smfmac_f32_32x32x32_bf16 a[224:239], a[124:127], v[24:31], v2
    s_add_u32 s40, s16, 3047424
    s_addc_u32 s41, s17, 0
    v_exp_f32 v44, v44
    v_exp_f32 v45, v45
    v_exp_f32 v46, v46
    v_exp_f32 v47, v47
    v_mfma_f32_32x32x8_bf16 v[16:31], a[72:73], a[252:253], 0
    v_exp_f32 v48, v48
    v_exp_f32 v49, v49
    v_exp_f32 v50, v50
    v_exp_f32 v51, v51
    v_mfma_f32_32x32x16_bf16 v[16:31], a[32:35], a[244:247], v[16:31]
    s_waitcnt vmcnt(18) lgkmcnt(0)
    v_exp_f32 v52, v52
    v_exp_f32 v53, v53
    v_exp_f32 v54, v54
    v_smfmac_f32_16x16x64_bf16 v[176:179], v[228:231], v[64:71], v3
    global_load_dwordx4 v[64:67], v6, s[40:41] offset:-4096 sc1
    global_load_dwordx4 v[68:71], v6, s[40:41] offset:-3072 sc1
    v_exp_f32 v55, v55
    v_smfmac_f32_32x32x32_bf16 a[224:239], a[128:131], v[32:39], v2
    s_add_u32 s38, s16, 3137536
    s_addc_u32 s39, s17, 0
    v_exp_f32 v56, v56
    v_exp_f32 v57, v57
    v_exp_f32 v58, v58
    v_exp_f32 v59, v59
    v_smfmac_f32_32x32x32_bf16 a[224:239], a[132:135], v[40:47], v2
    global_load_dwordx4 a[104:107], v6, s[38:39] offset:-4096 sc1
    global_load_dwordx4 a[108:111], v6, s[38:39] offset:-3072 sc1
    v_exp_f32 v60, v60
    v_exp_f32 v61, v61
    v_exp_f32 v62, v62
    v_exp_f32 v63, v63
    v_mfma_f32_32x32x8_bf16 v[32:47], a[72:73], a[254:255], 0
    v_exp_f32 v16, v16
    v_exp_f32 v17, v17
    v_exp_f32 v18, v18
    v_exp_f32 v19, v19
    v_mfma_f32_32x32x16_bf16 v[32:47], a[36:39], a[244:247], v[32:47]
    v_exp_f32 v20, v20
    v_exp_f32 v21, v21
    v_exp_f32 v22, v22
    v_smfmac_f32_16x16x64_bf16 v[180:183], v[228:231], v[72:79], v3
    global_load_dwordx4 v[72:75], v6, s[40:41] offset:-2048 sc1
    global_load_dwordx4 v[76:79], v6, s[40:41] offset:-1024 sc1
    v_exp_f32 v23, v23
    v_smfmac_f32_32x32x32_bf16 a[224:239], a[136:139], v[48:55], v2
    v_exp_f32 v24, v24
    v_exp_f32 v25, v25
    v_exp_f32 v26, v26
    v_exp_f32 v27, v27
    v_smfmac_f32_32x32x32_bf16 a[224:239], a[140:143], v[56:63], v2
    v_exp_f32 v28, v28
    v_exp_f32 v29, v29
    v_exp_f32 v30, v30
    v_exp_f32 v31, v31
    v_mfma_f32_32x32x8_bf16 v[48:63], a[74:75], a[252:253], 0
    v_exp_f32 v32, v32
    v_exp_f32 v33, v33
    v_exp_f32 v34, v34
    v_exp_f32 v35, v35
    v_mfma_f32_32x32x16_bf16 v[48:63], a[40:43], a[244:247], v[48:63]
    v_exp_f32 v36, v36
    v_exp_f32 v37, v37
    v_exp_f32 v38, v38
    v_smfmac_f32_16x16x64_bf16 v[184:187], v[228:231], v[80:87], v3
    global_load_dwordx4 v[80:83], v6, s[40:41] offset:0 sc1
    global_load_dwordx4 v[84:87], v6, s[40:41] offset:1024 sc1
    v_exp_f32 v39, v39
    v_smfmac_f32_32x32x32_bf16 a[224:239], a[144:147], v[16:23], v2
    v_exp_f32 v40, v40
    v_exp_f32 v41, v41
    v_exp_f32 v42, v42
    v_exp_f32 v43, v43
    v_smfmac_f32_32x32x32_bf16 a[224:239], a[148:151], v[24:31], v2
    v_exp_f32 v44, v44
    v_exp_f32 v45, v45
    v_exp_f32 v46, v46
    v_exp_f32 v47, v47
    v_mfma_f32_32x32x8_bf16 v[16:31], a[74:75], a[254:255], 0
    v_exp_f32 v48, v48
    v_exp_f32 v49, v49
    v_exp_f32 v50, v50
    v_exp_f32 v51, v51
    v_mfma_f32_32x32x16_bf16 v[16:31], a[44:47], a[244:247], v[16:31]
    s_waitcnt vmcnt(20)
    v_exp_f32 v52, v52
    v_exp_f32 v53, v53
    v_exp_f32 v54, v54
    v_smfmac_f32_16x16x64_bf16 v[188:191], v[228:231], v[88:95], v3
    global_load_dwordx4 v[88:91], v6, s[40:41] offset:2048 sc1
    global_load_dwordx4 v[92:95], v6, s[40:41] offset:3072 sc1
    v_exp_f32 v55, v55
    v_smfmac_f32_32x32x32_bf16 a[224:239], a[152:155], v[32:39], v2
    s_add_u32 s40, s16, 3055616
    s_addc_u32 s41, s17, 0
    v_exp_f32 v56, v56
    v_exp_f32 v57, v57
    v_exp_f32 v58, v58
    v_exp_f32 v59, v59
    v_smfmac_f32_32x32x32_bf16 a[224:239], a[156:159], v[40:47], v2
    v_exp_f32 v60, v60
    v_exp_f32 v61, v61
    v_exp_f32 v62, v62
    v_exp_f32 v63, v63
    v_mfma_f32_32x32x8_bf16 v[32:47], a[76:77], a[252:253], 0
    v_exp_f32 v16, v16
    v_exp_f32 v17, v17
    v_exp_f32 v18, v18
    v_exp_f32 v19, v19
    v_mfma_f32_32x32x16_bf16 v[32:47], a[48:51], a[244:247], v[32:47]
    v_exp_f32 v20, v20
    v_exp_f32 v21, v21
    v_exp_f32 v22, v22
    v_smfmac_f32_16x16x64_bf16 v[192:195], v[228:231], v[96:103], v3
    global_load_dwordx4 v[96:99], v6, s[40:41] offset:-4096 sc1
    global_load_dwordx4 v[100:103], v6, s[40:41] offset:-3072 sc1
    v_exp_f32 v23, v23
    v_smfmac_f32_32x32x32_bf16 a[224:239], a[160:163], v[48:55], v2
    v_exp_f32 v24, v24
    v_exp_f32 v25, v25
    v_exp_f32 v26, v26
    v_exp_f32 v27, v27
    v_smfmac_f32_32x32x32_bf16 a[224:239], a[164:167], v[56:63], v2
    v_exp_f32 v28, v28
    v_exp_f32 v29, v29
    v_exp_f32 v30, v30
    v_exp_f32 v31, v31
    v_mfma_f32_32x32x8_bf16 v[48:63], a[76:77], a[254:255], 0
    v_exp_f32 v32, v32
    v_exp_f32 v33, v33
    v_exp_f32 v34, v34
    v_exp_f32 v35, v35
    v_mfma_f32_32x32x16_bf16 v[48:63], a[52:55], a[244:247], v[48:63]
    v_exp_f32 v36, v36
    v_exp_f32 v37, v37
    v_exp_f32 v38, v38
    v_smfmac_f32_16x16x64_bf16 v[196:199], v[228:231], v[104:111], v3
    global_load_dwordx4 v[104:107], v6, s[40:41] offset:-2048 sc1
    global_load_dwordx4 v[108:111], v6, s[40:41] offset:-1024 sc1
    v_exp_f32 v39, v39
    v_smfmac_f32_32x32x32_bf16 a[224:239], a[168:171], v[16:23], v2
    v_exp_f32 v40, v40
    v_exp_f32 v41, v41
    v_exp_f32 v42, v42
    v_exp_f32 v43, v43
    v_smfmac_f32_32x32x32_bf16 a[224:239], a[172:175], v[24:31], v2
    v_exp_f32 v44, v44
    v_exp_f32 v45, v45
    v_exp_f32 v46, v46
    v_exp_f32 v47, v47
    v_mfma_f32_32x32x8_bf16 v[16:31], a[78:79], a[252:253], 0
    v_exp_f32 v48, v48
    v_exp_f32 v49, v49
    v_exp_f32 v50, v50
    v_exp_f32 v51, v51
    v_mfma_f32_32x32x16_bf16 v[16:31], a[56:59], a[244:247], v[16:31]
    s_waitcnt vmcnt(20)
    v_exp_f32 v52, v52
    v_exp_f32 v53, v53
    v_exp_f32 v54, v54
    v_smfmac_f32_16x16x64_bf16 v[200:203], v[228:231], v[112:119], v3
    global_load_dwordx4 v[112:115], v6, s[40:41] offset:0 sc1
    global_load_dwordx4 v[116:119], v6, s[40:41] offset:1024 sc1
    v_exp_f32 v55, v55
    v_smfmac_f32_32x32x32_bf16 a[224:239], a[176:179], v[32:39], v2
    v_exp_f32 v56, v56
    v_exp_f32 v57, v57
    v_exp_f32 v58, v58
    v_exp_f32 v59, v59
    v_smfmac_f32_32x32x32_bf16 a[224:239], a[180:183], v[40:47], v2
    v_exp_f32 v60, v60
    v_exp_f32 v61, v61
    v_exp_f32 v62, v62
    v_exp_f32 v63, v63
    v_mfma_f32_32x32x8_bf16 v[32:47], a[78:79], a[254:255], 0
    v_exp_f32 v16, v16
    v_exp_f32 v17, v17
    v_exp_f32 v18, v18
    v_exp_f32 v19, v19
    v_mfma_f32_32x32x16_bf16 v[32:47], a[60:63], a[244:247], v[32:47]
    v_exp_f32 v20, v20
    v_exp_f32 v21, v21
    v_exp_f32 v22, v22
    v_smfmac_f32_16x16x64_bf16 v[204:207], v[228:231], v[120:127], v3
    global_load_dwordx4 v[120:123], v6, s[40:41] offset:2048 sc1
    global_load_dwordx4 v[124:127], v6, s[40:41] offset:3072 sc1
    v_exp_f32 v23, v23
    v_smfmac_f32_32x32x32_bf16 a[224:239], a[184:187], v[48:55], v2
    s_add_u32 s40, s16, 3063808
    s_addc_u32 s41, s17, 0
    v_exp_f32 v24, v24
    v_exp_f32 v25, v25
    v_exp_f32 v26, v26
    v_exp_f32 v27, v27
    v_smfmac_f32_32x32x32_bf16 a[224:239], a[188:191], v[56:63], v2
    v_exp_f32 v28, v28
    v_exp_f32 v29, v29
    v_exp_f32 v30, v30
    v_exp_f32 v31, v31
    v_smfmac_f32_32x32x32_bf16 a[224:239], a[192:195], v[16:23], v2
    v_exp_f32 v32, v32
    v_exp_f32 v33, v33
    v_exp_f32 v34, v34
    v_smfmac_f32_16x16x64_bf16 v[208:211], v[228:231], v[128:135], v3
    global_load_dwordx4 v[128:131], v6, s[40:41] offset:-4096 sc1
    global_load_dwordx4 v[132:135], v6, s[40:41] offset:-3072 sc1
    v_exp_f32 v35, v35
    v_smfmac_f32_32x32x32_bf16 a[224:239], a[196:199], v[24:31], v2
    v_exp_f32 v36, v36
    v_exp_f32 v37, v37
    v_exp_f32 v38, v38
    v_exp_f32 v39, v39
    v_exp_f32 v40, v40
    v_exp_f32 v41, v41
    v_smfmac_f32_32x32x32_bf16 a[224:239], a[200:203], v[32:39], v2
    v_exp_f32 v42, v42
    v_exp_f32 v43, v43
    v_exp_f32 v44, v44
    v_exp_f32 v45, v45
    v_exp_f32 v46, v46
    v_exp_f32 v47, v47
    s_nop 1
    v_smfmac_f32_32x32x32_bf16 a[224:239], a[204:207], v[40:47], v2
    v_subrev_u32 v226, 2048, v8
    s_lshl_b32 s34, s32, 9
    v_add_u32 v227, s34, v10
    v_bfe_u32 v215, v0, 2, 2
    v_bfe_u32 v216, v0, 4, 1
    v_lshrrev_b32 v217, 5, v0
    v_lshl_add_u32 v218, v216, 3, v215
    v_lshlrev_b32 v218, 6, v218
    v_lshl_add_u32 v218, v217, 11, v218
    v_bfe_u32 v219, v0, 1, 1
    v_lshl_add_u32 v218, v219, 10, v218
    v_and_b32 v219, 1, v0
    ds_write_b64 v226, a[232:233] offset:2048
    ds_write_b64 v226, a[224:225] offset:0
    ds_write_b64 v226, a[226:227] offset:512
    ds_write_b64 v226, a[228:229] offset:1024
    ds_write_b64 v226, a[230:231] offset:1536
    v_lshl_add_u32 v218, v219, 3, v218
    v_lshlrev_b32 v219, 1, v216
    v_xor_b32 v219, s32, v219
    v_lshl_add_u32 v218, v219, 4, v218
    v_add_u32 v212, 29824, v218
    v_add_u32 v213, 66688, v218
    v_lshrrev_b32 v62, 3, v0
    s_lshl_b32 s34, s32, 4
    s_add_u32 s34, s34, 11264
    v_mad_u32_u24 v48, v62, 5, 0
    s_waitcnt vmcnt(16) lgkmcnt(0)
    s_barrier
    ds_read_b64 v[16:17], v10 offset:2048
    ds_read_b64 v[18:19], v10 offset:4608
    ds_read_b64 v[20:21], v10 offset:7168
    ds_read_b64 v[22:23], v10 offset:9728
    ds_read_b64 v[24:25], v227 offset:0
    ds_read_b64 v[26:27], v227 offset:2560
    ds_read_b64 v[28:29], v227 offset:5120
    ds_read_b64 v[30:31], v227 offset:7680
    v_lshl_add_u32 v48, v48, 4, s34
    s_lshl_b32 s34, s2, 5
    s_add_u32 s34, s34, 5550108
    v_lshl_add_u32 v51, v62, 13, s34
    s_waitcnt lgkmcnt(4)
    v_pk_add_f32 v[16:17], v[16:17], v[18:19]
    v_pk_add_f32 v[20:21], v[20:21], v[22:23]
    v_pk_add_f32 v[16:17], v[16:17], v[20:21]
    v_rcp_f32 v18, v17
    v_subrev_u32 v19, s42, v17
    v_max_u32 v13, v13, v19
    v_cmp_lt_u32 vcc, 0x62000000, v13
    s_waitcnt lgkmcnt(0)
    v_pk_add_f32 v[24:25], v[24:25], v[26:27]
    v_pk_add_f32 v[28:29], v[28:29], v[30:31]
    v_pk_add_f32 v[24:25], v[24:25], v[28:29]
    v_pk_mul_f32 v[24:25], v[24:25], v[18:19] op_sel_hi:[1,0]
    v_cvt_pk_bf16_f32 v24, v24, v25
    ds_write_b32 v11, v24
    v_mul_f32 v237, v16, v18
    v_cvt_pk_bf16_f32 v235, v236, v237
    s_cbranch_vccnz L_k2_slow
    s_and_b32 s36, s32, 1
    v_smfmac_f32_16x16x64_bf16 v[176:179], v[232:235], v[136:143], v3
    ds_read_b64_tr_b16 a[0:1], v212 offset:0
    v_smfmac_f32_16x16x64_bf16 v[180:183], v[232:235], v[144:151], v3
    ds_read_b64_tr_b16 a[2:3], v212 offset:256
    v_smfmac_f32_16x16x64_bf16 v[184:187], v[232:235], v[152:159], v3
    s_waitcnt lgkmcnt(2)
    s_barrier
    ds_read_b128 v[228:231], v12 offset:10240
    v_smfmac_f32_16x16x64_bf16 v[188:191], v[232:235], v[160:167], v3
    ds_read_b64_tr_b16 a[4:5], v212 offset:4096
    v_smfmac_f32_16x16x64_bf16 v[192:195], v[232:235], v[168:175], v3
    ds_read_b64_tr_b16 a[6:7], v212 offset:4352
    v_smfmac_f32_16x16x64_bf16 v[196:199], v[232:235], a[80:87], v3
    ds_read_b64_tr_b16 a[8:9], v212 offset:8192
    v_smfmac_f32_16x16x64_bf16 v[200:203], v[232:235], a[88:95], v3
    ds_read_b64_tr_b16 a[10:11], v212 offset:8448
    v_smfmac_f32_16x16x64_bf16 v[204:207], v[232:235], a[96:103], v3
    ds_read_b64_tr_b16 a[12:13], v212 offset:12288
    v_smfmac_f32_16x16x64_bf16 v[208:211], v[232:235], a[104:111], v3
    s_waitcnt vmcnt(12) lgkmcnt(5)
    v_smfmac_f32_16x16x64_bf16 v[176:179], v[228:231], v[64:71], v3
    ds_read_b64_tr_b16 a[14:15], v212 offset:12544
    v_smfmac_f32_16x16x64_bf16 v[180:183], v[228:231], v[72:79], v3
    ds_read_b64_tr_b16 a[16:17], v212 offset:16384
    v_smfmac_f32_16x16x64_bf16 v[184:187], v[228:231], v[80:87], v3
    s_waitcnt vmcnt(6)
    v_smfmac_f32_16x16x64_bf16 v[188:191], v[228:231], v[88:95], v3
    ds_read_b64_tr_b16 a[18:19], v212 offset:16640
    v_smfmac_f32_16x16x64_bf16 v[192:195], v[228:231], v[96:103], v3
    ds_read_b64_tr_b16 a[20:21], v212 offset:20480
    v_smfmac_f32_16x16x64_bf16 v[196:199], v[228:231], v[104:111], v3
    s_waitcnt vmcnt(0)
    v_smfmac_f32_16x16x64_bf16 v[200:203], v[228:231], v[112:119], v3
    ds_read_b64_tr_b16 a[22:23], v212 offset:20736
    v_smfmac_f32_16x16x64_bf16 v[204:207], v[228:231], v[120:127], v3
    ds_read_b64_tr_b16 a[24:25], v212 offset:24576
    v_smfmac_f32_16x16x64_bf16 v[208:211], v[228:231], v[128:135], v3
    ds_read_b64_tr_b16 a[26:27], v212 offset:24832
L_k2_ln2:
    v_mov_b32 v255, v254
    s_lshl_b32 s34, s36, 5
    s_add_u32 s34, s34, 19456
    v_lshl_add_u32 v59, v62, 2, s34
    v_pk_add_f32 v[176:177], v[176:177], v[178:179]
    v_pk_add_f32 v[180:181], v[180:181], v[182:183]
    v_pk_mul_f32 v[18:19], v[176:177], v[176:177]
    v_pk_mul_f32 v[20:21], v[176:177], v[238:239] op_sel_hi:[1,0]
    v_pk_add_f32 v[16:17], v[176:177], v[180:181]
    v_pk_fma_f32 v[18:19], v[180:181], v[180:181], v[18:19]
    v_pk_fma_f32 v[20:21], v[180:181], v[238:239], v[20:21] op_sel:[0,1,0] op_sel_hi:[1,1,1]
    v_pk_add_f32 v[184:185], v[184:185], v[186:187]
    v_pk_add_f32 v[16:17], v[16:17], v[184:185]
    v_pk_fma_f32 v[18:19], v[184:185], v[184:185], v[18:19]
    v_pk_fma_f32 v[20:21], v[184:185], v[240:241], v[20:21] op_sel:[0,0,0] op_sel_hi:[1,0,1]
    v_pk_add_f32 v[188:189], v[188:189], v[190:191]
    v_pk_add_f32 v[16:17], v[16:17], v[188:189]
    v_pk_fma_f32 v[18:19], v[188:189], v[188:189], v[18:19]
    v_pk_fma_f32 v[20:21], v[188:189], v[240:241], v[20:21] op_sel:[0,1,0] op_sel_hi:[1,1,1]
    v_pk_add_f32 v[192:193], v[192:193], v[194:195]
    v_pk_add_f32 v[16:17], v[16:17], v[192:193]
    v_pk_fma_f32 v[18:19], v[192:193], v[192:193], v[18:19]
    v_pk_fma_f32 v[20:21], v[192:193], v[242:243], v[20:21] op_sel:[0,0,0] op_sel_hi:[1,0,1]
    v_pk_add_f32 v[196:197], v[196:197], v[198:199]
    v_pk_add_f32 v[16:17], v[16:17], v[196:197]
    v_pk_fma_f32 v[18:19], v[196:197], v[196:197], v[18:19]
    v_pk_fma_f32 v[20:21], v[196:197], v[242:243], v[20:21] op_sel:[0,1,0] op_sel_hi:[1,1,1]
    v_pk_add_f32 v[200:201], v[200:201], v[202:203]
    v_pk_add_f32 v[16:17], v[16:17], v[200:201]
    v_pk_fma_f32 v[18:19], v[200:201], v[200:201], v[18:19]
    v_pk_fma_f32 v[20:21], v[200:201], v[244:245], v[20:21] op_sel:[0,0,0] op_sel_hi:[1,0,1]
    v_pk_add_f32 v[204:205], v[204:205], v[206:207]
    v_pk_add_f32 v[16:17], v[16:17], v[204:205]
    v_pk_fma_f32 v[18:19], v[204:205], v[204:205], v[18:19]
    v_pk_fma_f32 v[20:21], v[204:205], v[244:245], v[20:21] op_sel:[0,1,0] op_sel_hi:[1,1,1]
    v_pk_add_f32 v[208:209], v[208:209], v[210:211]
    v_pk_add_f32 v[16:17], v[16:17], v[208:209]
    v_pk_fma_f32 v[18:19], v[208:209], v[208:209], v[18:19]
    v_pk_fma_f32 v[20:21], v[208:209], v[246:247], v[20:21] op_sel:[0,0,0] op_sel_hi:[1,0,1]
    v_add_f32_dpp v252, v16, v16 row_ror:8 row_mask:0xf bank_mask:0x3
    v_add_f32_dpp v253, v18, v18 row_ror:8 row_mask:0xf bank_mask:0x3
    v_add_f32_dpp v254, v20, v20 row_ror:8 row_mask:0xf bank_mask:0x3
    v_add_f32_dpp v252, v17, v17 row_ror:8 row_mask:0xf bank_mask:0xc
    v_add_f32_dpp v253, v19, v19 row_ror:8 row_mask:0xf bank_mask:0xc
    v_add_f32_dpp v254, v21, v21 row_ror:8 row_mask:0xf bank_mask:0xc
    v_add_f32_dpp v252, v252, v252 row_half_mirror row_mask:0xf bank_mask:0xf
    v_add_f32_dpp v253, v253, v253 row_half_mirror row_mask:0xf bank_mask:0xf
    v_add_f32_dpp v254, v254, v254 row_half_mirror row_mask:0xf bank_mask:0xf
    v_add_f32_dpp v252, v252, v252 quad_perm:[2,3,0,1] row_mask:0xf bank_mask:0xf
    v_add_f32_dpp v253, v253, v253 quad_perm:[2,3,0,1] row_mask:0xf bank_mask:0xf
    v_add_f32_dpp v254, v254, v254 quad_perm:[2,3,0,1] row_mask:0xf bank_mask:0xf
    v_add_f32_dpp v252, v252, v252 quad_perm:[1,0,3,2] row_mask:0xf bank_mask:0xf
    v_add_f32_dpp v253, v253, v253 quad_perm:[1,0,3,2] row_mask:0xf bank_mask:0xf
    v_add_f32_dpp v254, v254, v254 quad_perm:[1,0,3,2] row_mask:0xf bank_mask:0xf
    ds_write_b128 v48, v[252:255]
    v_and_b32 v62, 6, v62
    s_lshl_b32 s34, s4, 3
    v_add_u32 v55, s34, v62
    v_add_u32 v62, v62, v0
    v_and_b32 v62, 7, v62
    v_add_u32 v50, s34, v62
    v_mul_u32_u24 v49, 80, v62
    v_and_b32 v56, 15, v0
    v_lshlrev_b32 v58, 2, v56
    ds_write_b32 v58, v14 offset:19456
    v_and_b32 v52, 1, v0
    s_movk_i32 s34, 1150
    v_mad_u32_u24 v54, v52, s34, v247
    v_sub_u32 v53, 0, v52
    v_and_b32 v53, 0x06060606, v53
    v_xor_b32 v53, 0x05040100, v53
    s_waitcnt lgkmcnt(0)
    s_barrier
    ds_read_b128 v[16:19], v49 offset:11264
    ds_read_b128 v[20:23], v49 offset:11280
    ds_read_b128 v[24:27], v49 offset:11296
    ds_read_b128 v[28:31], v49 offset:11312
    v_mov_b32 v62, 2130706432
    s_and_b32 s48, s2, 7
    s_lshl_b32 s48, s48, 13
    s_add_u32 s48, s48, 5550080
    s_mov_b32 s7, 0x3727c5ac
    s_brev_b32 s8, 1
    s_movk_i32 s9, 0x7ff
    s_cmp_lg_u32 s32, 3
    s_waitcnt lgkmcnt(2)
    v_pk_add_f32 v[16:17], v[16:17], v[20:21]
    v_pk_add_f32 v[18:19], v[18:19], v[22:23]
    s_waitcnt lgkmcnt(0)
    v_pk_add_f32 v[24:25], v[24:25], v[28:29]
    v_pk_add_f32 v[26:27], v[26:27], v[30:31]
    v_pk_add_f32 v[16:17], v[16:17], v[24:25]
L_padb4:
    s_cbranch_execz L_padb8
    v_pk_add_f32 v[18:19], v[18:19], v[26:27]
    v_mul_f32 v16, 0xbae38e39, v16
    v_fma_f32 v20, -v16, v16, s7
    v_fmac_f32 v20, 0x3ae38e39, v17
    v_max_f32 v20, s7, v20
    v_rsq_f32 v20, v20
    v_fmac_f32 v18, v16, v19
    v_mul_f32 v21, v16, v20
    v_mul_f32 v18, v18, v20
    v_ashrrev_i32 v19, 31, v18
    v_or_b32 v19, s8, v19
    v_xor_b32 v18, v18, v19
    v_lshrrev_b32 v18, 1, v18
    v_max_u32 v18, 0x800, v18
    v_bfi_b32 v18, s9, v50, v18
    s_mov_b32 s34, 3190784
    v_mov_b32 v19, 0
    v_sub_u32_dpp v23, v18, v18 row_ror:1 row_mask:0xf bank_mask:0xf
    v_sub_u32_dpp v22, v18, v18 row_ror:2 row_mask:0xf bank_mask:0xf
    v_alignbit_b32 v19, v19, v23, 31
    v_sub_u32_dpp v23, v18, v18 row_ror:3 row_mask:0xf bank_mask:0xf
    v_alignbit_b32 v19, v19, v22, 31
    v_sub_u32_dpp v22, v18, v18 row_ror:4 row_mask:0xf bank_mask:0xf
    v_alignbit_b32 v19, v19, v23, 31
    v_sub_u32_dpp v23, v18, v18 row_ror:5 row_mask:0xf bank_mask:0xf
    v_alignbit_b32 v19, v19, v22, 31
    v_sub_u32_dpp v22, v18, v18 row_ror:6 row_mask:0xf bank_mask:0xf
    v_alignbit_b32 v19, v19, v23, 31
    v_sub_u32_dpp v23, v18, v18 row_ror:7 row_mask:0xf bank_mask:0xf
    v_alignbit_b32 v19, v19, v22, 31
    v_alignbit_b32 v19, v19, v23, 31
    v_bcnt_u32_b32 v19, v19, 0
    s_cbranch_scc1 L_k2_nopub
    v_lshlrev_b32 v22, 2, v19
    v_sub_u32 v22, v51, v22
    buffer_store_dword v18, v22, s[16:19], 0 offen sc1
L_k2_nopub:
    v_cmp_gt_u32 vcc, 6, v19
    v_mov_b32_dpp v24, v20 row_newbcast:0 row_mask:0xf bank_mask:0xf
    v_mov_b32_dpp v25, v20 row_newbcast:1 row_mask:0xf bank_mask:0xf
    v_mov_b32_dpp v26, v21 row_newbcast:0 row_mask:0xf bank_mask:0xf
    v_mov_b32_dpp v27, v21 row_newbcast:1 row_mask:0xf bank_mask:0xf
    v_cndmask_b32 v19, 0, v62, vcc
    v_cmp_eq_u32 vcc, 1, v52
    v_pk_fma_f32 v[178:179], v[176:177], v[24:25], v[26:27]
    v_pk_fma_f32 v[182:183], v[180:181], v[24:25], v[26:27]
    v_pk_fma_f32 v[186:187], v[184:185], v[24:25], v[26:27]
    v_pk_fma_f32 v[190:191], v[188:189], v[24:25], v[26:27]
    v_pk_fma_f32 v[194:195], v[192:193], v[24:25], v[26:27]
    v_pk_fma_f32 v[198:199], v[196:197], v[24:25], v[26:27]
    v_pk_fma_f32 v[202:203], v[200:201], v[24:25], v[26:27]
    v_pk_fma_f32 v[206:207], v[204:205], v[24:25], v[26:27]
    v_pk_fma_f32 v[210:211], v[208:209], v[24:25], v[26:27]
    v_mov_b32_dpp v28, v19 row_newbcast:0 row_mask:0xf bank_mask:0xf
    v_mov_b32_dpp v29, v19 row_newbcast:1 row_mask:0xf bank_mask:0xf
    v_cndmask_b32 v30, v28, v29, vcc
    v_or_b32 v28, v28, v1
    v_or_b32 v29, v29, v1
    v_or_b32 v30, v30, v54
    v_cvt_pk_bf16_f32 v40, v210, v211
    v_cvt_pk_bf16_f32 v32, v178, v182
    v_cvt_pk_bf16_f32 v33, v186, v190
    v_cvt_pk_bf16_f32 v34, v194, v198
    v_cvt_pk_bf16_f32 v35, v202, v206
    v_min_u32 v32, -2, v32
    buffer_store_dwordx4 v[32:35], v28, s[16:19], s34 offen sc1
    v_cvt_pk_bf16_f32 v36, v179, v183
    v_cvt_pk_bf16_f32 v37, v187, v191
    v_cvt_pk_bf16_f32 v38, v195, v199
    v_cvt_pk_bf16_f32 v39, v203, v207
    v_min_u32 v36, -2, v36
    buffer_store_dwordx4 v[36:39], v29, s[16:19], s34 offen offset:1152 sc1
    v_mov_b32_dpp v41, v40 quad_perm:[1,0,3,2] row_mask:0xf bank_mask:0xf
    v_perm_b32 v40, v41, v40, v53
    v_min_u32 v40, -2, v40
    buffer_store_dword v40, v30, s[16:19], s34 offen sc1
    s_cmp_lg_u32 s32, 0
    s_cbranch_scc1 L_k2_nokey
    v_lshlrev_b32 v9, 5, v0
    s_add_u32 s49, s48, 2048
    s_add_u32 s50, s48, 4096
    s_add_u32 s51, s48, 6144
    buffer_load_dwordx4 v[64:67], v9, s[16:19], s48 offen sc1
    buffer_load_dwordx4 v[68:71], v9, s[16:19], s49 offen sc1
    buffer_load_dwordx4 v[72:75], v9, s[16:19], s50 offen sc1
    buffer_load_dwordx4 v[76:79], v9, s[16:19], s51 offen sc1
L_k2_nokey:
    v_lshrrev_b32 v57, 4, v0
    ds_read_b64_tr_b16 a[28:29], v212 offset:28672
    s_lshl_b32 s37, s36, 2
    v_add_u32 v63, s37, v57
    ds_read_b64_tr_b16 a[30:31], v212 offset:28928
    v_and_b32 v60, 7, v0
    v_xor_b32 v60, v60, v63
    ds_read_b64_tr_b16 a[32:33], v212 offset:32768
    v_lshlrev_b32 v60, 4, v60
    v_mov_b32 v61, 1
    ds_read_b64_tr_b16 a[34:35], v212 offset:33024
    s_movk_i32 s6, 1152
    s_lshr_b32 s37, s32, 1
    ds_read_b64_tr_b16 a[36:37], v213 offset:0
    s_lshl_b32 s10, s37, 7
    s_add_u32 s10, s10, 3190784
    ds_read_b64_tr_b16 a[38:39], v213 offset:256
    s_lshl_b32 s11, s37, 11
    s_lshl_b32 s37, s36, 10
    ds_read_b64_tr_b16 a[40:41], v213 offset:4096
    s_add_u32 s11, s11, s37
    s_add_u32 s11, s11, 140416
    ds_read_b64_tr_b16 a[42:43], v213 offset:4352
    v_lshrrev_b32 v218, 1, v215
    v_lshlrev_b32 v218, 3, v218
    ds_read_b64_tr_b16 a[44:45], v213 offset:8192
    v_lshl_add_u32 v218, v216, 2, v218
    v_lshl_add_u32 v218, v217, 1, v218
    ds_read_b64_tr_b16 a[46:47], v213 offset:8448
    v_and_b32 v219, 1, v215
    v_add_u32 v218, v218, v219
    ds_read_b64_tr_b16 a[48:49], v213 offset:12288
    v_mul_u32_u24 v218, 1152, v218
    v_and_b32 v219, 3, v0
    ds_read_b64_tr_b16 a[50:51], v213 offset:12544
    v_lshl_add_u32 v218, v219, 3, v218
    s_mul_i32 s37, s32, 288
    ds_read_b64_tr_b16 a[52:53], v213 offset:16384
    s_add_u32 s37, s37, 103552
    v_add_u32 v214, s37, v218
    ds_read_b64_tr_b16 a[54:55], v213 offset:16640
    v_mov_b32 v105, 2130706432
    v_pk_add_f32 v[176:177], v[176:177], v[178:179]
    s_waitcnt lgkmcnt(6)
    ds_read_b64_tr_b16 a[56:57], v213 offset:20480
    v_pk_add_f32 v[180:181], v[180:181], v[182:183]
    v_pk_add_f32 v[184:185], v[184:185], v[186:187]
    ds_read_b64_tr_b16 a[58:59], v213 offset:20736
    v_pk_add_f32 v[188:189], v[188:189], v[190:191]
    v_pk_add_f32 v[192:193], v[192:193], v[194:195]
    ds_read_b64_tr_b16 a[60:61], v213 offset:24576
    v_pk_add_f32 v[196:197], v[196:197], v[198:199]
    v_pk_add_f32 v[200:201], v[200:201], v[202:203]
    ds_read_b64_tr_b16 a[62:63], v213 offset:24832
    v_pk_add_f32 v[204:205], v[204:205], v[206:207]
    v_pk_add_f32 v[208:209], v[208:209], v[210:211]
    ds_read_b64_tr_b16 a[64:65], v213 offset:28672
    v_cvt_pk_bf16_f32 v224, v208, v209
    v_cvt_pk_bf16_f32 v216, v176, v180
    ds_read_b64_tr_b16 a[66:67], v213 offset:28928
    v_cvt_pk_bf16_f32 v217, v184, v188
    v_cvt_pk_bf16_f32 v218, v192, v196
    ds_read_b64_tr_b16 a[68:69], v213 offset:32768
    v_cvt_pk_bf16_f32 v219, v200, v204
    v_min_u32 v216, -2, v216
    ds_read_b64_tr_b16 a[70:71], v213 offset:33024
    v_cvt_pk_bf16_f32 v220, v177, v181
    v_cvt_pk_bf16_f32 v221, v185, v189
    s_waitcnt lgkmcnt(6)
    ds_read_b64_tr_b16 a[112:113], v214 offset:0
    v_cvt_pk_bf16_f32 v222, v193, v197
    v_cvt_pk_bf16_f32 v223, v201, v205
    ds_read_b64_tr_b16 a[114:115], v214 offset:18432
    v_min_u32 v220, -2, v220
    v_mov_b32_dpp v225, v224 quad_perm:[1,0,3,2] row_mask:0xf bank_mask:0xf
    ds_read_b64_tr_b16 a[116:117], v214 offset:32
    v_perm_b32 v224, v225, v224, v53
    v_min_u32 v224, -2, v224
    ds_read_b64_tr_b16 a[118:119], v214 offset:18464
    v_lshrrev_b32 v97, 1, v56
    v_xor_b32 v97, v97, v57
    ds_read_b64_tr_b16 a[120:121], v214 offset:64
    v_lshlrev_b32 v97, 4, v97
    v_lshl_add_u32 v97, v56, 7, v97
    ds_read_b64_tr_b16 a[122:123], v214 offset:18496
    v_add_u32 v2, 140416, v97
    v_xor_b32 v3, 64, v2
    ds_read_b64_tr_b16 a[124:125], v214 offset:96
    v_and_b32 v97, 1, v57
    v_lshrrev_b32 v98, 1, v57
    ds_read_b64_tr_b16 a[126:127], v214 offset:18528
    v_lshl_add_u32 v98, v97, 1, v98
    v_mul_u32_u24 v4, 20480, v98
    s_waitcnt lgkmcnt(6)
    ds_read_b64_tr_b16 a[128:129], v214 offset:128
    v_mul_lo_u32 v5, v97, v105
    s_mul_i32 s38, s32, 368640
    ds_read_b64_tr_b16 a[130:131], v214 offset:18560
    s_lshl_b32 s39, s3, 7
    s_add_u32 s38, s38, s39
    ds_read_b64_tr_b16 a[132:133], v214 offset:160
    s_add_u32 s38, s38, 5816320
    s_lshl_b32 s39, s32, 6
    ds_read_b64_tr_b16 a[134:135], v214 offset:18592
    v_or_b32 v98, s39, v0
    v_cmp_gt_u32 vcc, 4, v98
    ds_read_b64_tr_b16 a[136:137], v214 offset:192
    v_mul_u32_u24 v98, 20480, v98
    s_lshr_b32 s39, s2, 3
    ds_read_b64_tr_b16 a[138:139], v214 offset:18624
    v_cndmask_b32 v6, v105, v98, vcc
    ds_read_b64_tr_b16 a[140:141], v214 offset:224
    s_mul_i32 s39, s39, 81920
    ds_read_b64_tr_b16 a[142:143], v214 offset:18656
    s_and_b32 s40, s2, 7
    s_waitcnt lgkmcnt(6)
    ds_read_b64_tr_b16 a[144:145], v214 offset:256
    s_lshl_b32 s40, s40, 7
    ds_read_b64_tr_b16 a[146:147], v214 offset:18688
    s_add_u32 s39, s39, s40
    s_add_u32 s39, s39, 5835776
    s_lshl_b32 s40, s32, 4
    v_add_u32 v98, s40, v56
    v_mul_u32_u24 v7, 20480, v98
    s_lshl_b32 s40, s32, 1
    s_add_u32 s40, s40, 64
    v_lshrrev_b32 v98, 3, v56
    v_add_u32 v98, s40, v98
    v_mul_u32_u24 v98, 20480, v98
    v_and_b32 v97, 6, v56
    v_lshl_add_u32 v8, v97, 1, v98
    v_cmp_eq_u32 s[42:43], 1, v52
    s_mov_b32 s41, 5834736
    s_cmp_lg_u32 s32, 0
    s_cbranch_scc1 L_k2_listed
    s_mov_b32 s47, 0
    s_mov_b32 s52, 1
    s_mov_b32 s58, 0
L_k2_poll:
    s_waitcnt vmcnt(0) lgkmcnt(0)
    v_or3_b32 v101, v64, v65, v66
    v_or3_b32 v102, v68, v69, v70
    v_or3_b32 v103, v72, v73, v74
    v_or3_b32 v104, v76, v77, v78
    v_max3_u32 v97, v65, v69, v73
    v_or3_b32 v99, v101, v102, v103
    v_max3_u32 v98, v66, v70, v74
    v_or_b32 v99, v99, v104
    v_cmp_gt_i32 vcc, 0, v99
    v_max_u32 v97, v97, v77
    v_max_u32 v98, v98, v78
    s_cbranch_vccz L_k2_polled
    v_cmp_gt_i32 s[60:61], 0, v101
    v_cmp_gt_i32 s[62:63], 0, v102
    v_cmp_gt_i32 s[64:65], 0, v103
    v_cmp_gt_i32 s[66:67], 0, v104
    v_max3_i32 v96, v64, v68, v72
    v_max3_i32 v96, v96, v76, 0
    s_mov_b64 exec, s[60:61]
    buffer_load_dwordx4 v[64:67], v9, s[16:19], s48 offen sc1
    s_mov_b64 exec, s[62:63]
    buffer_load_dwordx4 v[68:71], v9, s[16:19], s49 offen sc1
    s_mov_b64 exec, s[64:65]
    buffer_load_dwordx4 v[72:75], v9, s[16:19], s50 offen sc1
    s_mov_b64 exec, s[66:67]
    buffer_load_dwordx4 v[76:79], v9, s[16:19], s51 offen sc1
    s_mov_b64 exec, -1
    v_mov_b32 v100, v96
    s_nop 1
    v_permlane16_swap_b32 v100, v96
    s_nop 0
    v_max_u32 v96, v96, v100
    v_mov_b32 v100, v96
    s_nop 1
    v_permlane32_swap_b32 v100, v96
    s_nop 0
    v_max_u32 v96, v96, v100
    s_nop 0
    v_mov_b32 v101, 0
    v_sub_u32_dpp v103, v96, v96 row_ror:1 row_mask:0xf bank_mask:0xf
    v_sub_u32_dpp v102, v96, v96 row_ror:2 row_mask:0xf bank_mask:0xf
    v_alignbit_b32 v101, v101, v103, 31
    v_sub_u32_dpp v103, v96, v96 row_ror:3 row_mask:0xf bank_mask:0xf
    v_alignbit_b32 v101, v101, v102, 31
    v_sub_u32_dpp v102, v96, v96 row_ror:4 row_mask:0xf bank_mask:0xf
    v_alignbit_b32 v101, v101, v103, 31
    v_sub_u32_dpp v103, v96, v96 row_ror:5 row_mask:0xf bank_mask:0xf
    v_alignbit_b32 v101, v101, v102, 31
    v_sub_u32_dpp v102, v96, v96 row_ror:6 row_mask:0xf bank_mask:0xf
    v_alignbit_b32 v101, v101, v103, 31
    v_sub_u32_dpp v103, v96, v96 row_ror:7 row_mask:0xf bank_mask:0xf
    v_alignbit_b32 v101, v101, v102, 31
    v_sub_u32_dpp v102, v96, v96 row_ror:8 row_mask:0xf bank_mask:0xf
    v_alignbit_b32 v101, v101, v103, 31
    v_sub_u32_dpp v103, v96, v96 row_ror:9 row_mask:0xf bank_mask:0xf
    v_alignbit_b32 v101, v101, v102, 31
    v_sub_u32_dpp v102, v96, v96 row_ror:10 row_mask:0xf bank_mask:0xf
    v_alignbit_b32 v101, v101, v103, 31
    v_sub_u32_dpp v103, v96, v96 row_ror:11 row_mask:0xf bank_mask:0xf
    v_alignbit_b32 v101, v101, v102, 31
    v_sub_u32_dpp v102, v96, v96 row_ror:12 row_mask:0xf bank_mask:0xf
    v_alignbit_b32 v101, v101, v103, 31
    v_sub_u32_dpp v103, v96, v96 row_ror:13 row_mask:0xf bank_mask:0xf
    v_alignbit_b32 v101, v101, v102, 31
    v_sub_u32_dpp v102, v96, v96 row_ror:14 row_mask:0xf bank_mask:0xf
    v_alignbit_b32 v101, v101, v103, 31
    v_sub_u32_dpp v103, v96, v96 row_ror:15 row_mask:0xf bank_mask:0xf
    v_alignbit_b32 v101, v101, v102, 31
    v_alignbit_b32 v101, v101, v103, 31
    v_bcnt_u32_b32 v101, v101, 0
    v_cmp_eq_u32 vcc, 8, v101
    s_ff1_i32_b64 s52, vcc
    s_and_b32 s52, s52, 63
    v_readlane_b32 s52, v96, s52
    s_cmp_eq_u64 vcc, 0
    s_cselect_b32 s52, 1, s52
    s_add_u32 s47, s47, 1
    s_cmp_lt_u32 s47, 200000
    s_cbranch_scc1 L_k2_poll
    s_waitcnt vmcnt(0)
L_k2_polled:
    s_mov_b32 s53, 4864
    v_cmp_le_u32 s[60:61], s52, v64
    v_cmp_le_u32 s[62:63], s52, v68
    v_cmp_le_u32 s[64:65], s52, v72
    v_cmp_le_u32 s[66:67], s52, v76
    v_cmp_le_u32 s[44:45], s52, v98
    v_cmp_le_u32 vcc, s52, v97
    s_cmp_lg_u64 s[44:45], 0
    s_cbranch_scc1 L_k2_fresh
    s_bcnt1_i32_b64 s54, s[60:61]
    v_mbcnt_lo_u32_b32 v106, s60, 0
    s_bcnt1_i32_b64 s55, s[62:63]
    v_mbcnt_lo_u32_b32 v107, s62, 0
    s_bcnt1_i32_b64 s56, s[64:65]
    v_mbcnt_lo_u32_b32 v108, s64, 0
    s_bcnt1_i32_b64 s57, s[66:67]
    v_mbcnt_lo_u32_b32 v109, s66, 0
    s_add_u32 s54, s54, s53
    v_mbcnt_hi_u32_b32 v106, s61, v106
    s_add_u32 s55, s55, s54
    v_mbcnt_hi_u32_b32 v107, s63, v107
    s_add_u32 s56, s56, s55
    v_mbcnt_hi_u32_b32 v108, s65, v108
    s_add_u32 s57, s57, s56
    v_mbcnt_hi_u32_b32 v109, s67, v109
    s_cmp_gt_u32 s57, 4880
    s_cbranch_scc1 L_k2_fresh
    v_add_lshl_u32 v106, v106, s53, 2
    v_add_lshl_u32 v107, v107, s54, 2
    v_add_lshl_u32 v108, v108, s55, 2
    v_add_lshl_u32 v109, v109, s56, 2
    s_mov_b64 exec, s[60:61]
    ds_write_b32 v106, v64
    s_mov_b64 exec, s[62:63]
    ds_write_b32 v107, v68
    s_mov_b64 exec, s[64:65]
    ds_write_b32 v108, v72
    s_mov_b64 exec, s[66:67]
    ds_write_b32 v109, v76
    s_mov_b64 exec, -1
    s_cbranch_vccz L_k2_listed
    v_cmp_le_u32 s[60:61], s52, v65
    v_cmp_le_u32 s[62:63], s52, v69
    v_cmp_le_u32 s[64:65], s52, v73
    v_cmp_le_u32 s[66:67], s52, v77
    s_mov_b32 s53, s57
    s_bcnt1_i32_b64 s54, s[60:61]
    v_mbcnt_lo_u32_b32 v106, s60, 0
    s_bcnt1_i32_b64 s55, s[62:63]
    v_mbcnt_lo_u32_b32 v107, s62, 0
    s_bcnt1_i32_b64 s56, s[64:65]
    v_mbcnt_lo_u32_b32 v108, s64, 0
    s_bcnt1_i32_b64 s57, s[66:67]
    v_mbcnt_lo_u32_b32 v109, s66, 0
    s_add_u32 s54, s54, s53
    v_mbcnt_hi_u32_b32 v106, s61, v106
    s_add_u32 s55, s55, s54
    v_mbcnt_hi_u32_b32 v107, s63, v107
    s_add_u32 s56, s56, s55
    v_mbcnt_hi_u32_b32 v108, s65, v108
    s_add_u32 s57, s57, s56
    v_mbcnt_hi_u32_b32 v109, s67, v109
    s_cmp_gt_u32 s57, 4880
    s_cbranch_scc1 L_k2_fresh
    v_add_lshl_u32 v106, v106, s53, 2
    v_add_lshl_u32 v107, v107, s54, 2
    v_add_lshl_u32 v108, v108, s55, 2
    v_add_lshl_u32 v109, v109, s56, 2
    s_mov_b64 exec, s[60:61]
    ds_write_b32 v106, v65
    s_mov_b64 exec, s[62:63]
    ds_write_b32 v107, v69
    s_mov_b64 exec, s[64:65]
    ds_write_b32 v108, v73
    s_mov_b64 exec, s[66:67]
    ds_write_b32 v109, v77
    s_mov_b64 exec, -1
L_k2_listed:
    s_waitcnt lgkmcnt(0)
    s_barrier
    ds_read_b32 v227, v59
    ds_read_b32 v226, v58 offset:19456
    s_cmp_ge_u32 s2, 144
    s_cbranch_scc1 L_k2_nogather
    s_waitcnt lgkmcnt(1)
    v_cmp_eq_u32 vcc, 0, v227
    v_and_b32 v96, 0x7ff, v227
    v_mad_u32_u24 v232, v96, s6, v60
    v_cndmask_b32 v232, v232, v105, vcc
    s_add_u32 m0, s11, 0
    s_add_u32 s54, s10, 0
    buffer_load_dwordx4 v232, s[16:19], s54 offen sc1 lds
    s_add_u32 m0, s11, 4096
    s_add_u32 s54, s10, 256
    buffer_load_dwordx4 v232, s[16:19], s54 offen sc1 lds
    s_add_u32 m0, s11, 8192
    s_add_u32 s54, s10, 512
    buffer_load_dwordx4 v232, s[16:19], s54 offen sc1 lds
    s_add_u32 m0, s11, 12288
    s_add_u32 s54, s10, 768
    buffer_load_dwordx4 v232, s[16:19], s54 offen sc1 lds
    s_add_u32 m0, s11, 16384
    s_mov_b32 s54, 3191808
    buffer_load_dwordx4 v232, s[16:19], s54 offen sc1 lds
L_k2_nogather:
    s_waitcnt lgkmcnt(0)
    v_mov_b32 v101, 0
    v_sub_u32_dpp v103, v226, v226 row_ror:1 row_mask:0xf bank_mask:0xf
    v_sub_u32_dpp v102, v226, v226 row_ror:2 row_mask:0xf bank_mask:0xf
    v_alignbit_b32 v101, v101, v103, 31
    v_sub_u32_dpp v103, v226, v226 row_ror:3 row_mask:0xf bank_mask:0xf
    v_alignbit_b32 v101, v101, v102, 31
    v_sub_u32_dpp v102, v226, v226 row_ror:4 row_mask:0xf bank_mask:0xf
    v_alignbit_b32 v101, v101, v103, 31
    v_sub_u32_dpp v103, v226, v226 row_ror:5 row_mask:0xf bank_mask:0xf
    v_alignbit_b32 v101, v101, v102, 31
    v_sub_u32_dpp v102, v226, v226 row_ror:6 row_mask:0xf bank_mask:0xf
    v_alignbit_b32 v101, v101, v103, 31
    v_sub_u32_dpp v103, v226, v226 row_ror:7 row_mask:0xf bank_mask:0xf
    v_alignbit_b32 v101, v101, v102, 31
    v_sub_u32_dpp v102, v226, v226 row_ror:8 row_mask:0xf bank_mask:0xf
    v_alignbit_b32 v101, v101, v103, 31
    v_sub_u32_dpp v103, v226, v226 row_ror:9 row_mask:0xf bank_mask:0xf
    v_alignbit_b32 v101, v101, v102, 31
    v_sub_u32_dpp v102, v226, v226 row_ror:10 row_mask:0xf bank_mask:0xf
    v_alignbit_b32 v101, v101, v103, 31
    v_sub_u32_dpp v103, v226, v226 row_ror:11 row_mask:0xf bank_mask:0xf
    v_alignbit_b32 v101, v101, v102, 31
    v_sub_u32_dpp v102, v226, v226 row_ror:12 row_mask:0xf bank_mask:0xf
    v_alignbit_b32 v101, v101, v103, 31
    v_sub_u32_dpp v103, v226, v226 row_ror:13 row_mask:0xf bank_mask:0xf
    v_alignbit_b32 v101, v101, v102, 31
    v_sub_u32_dpp v102, v226, v226 row_ror:14 row_mask:0xf bank_mask:0xf
    v_alignbit_b32 v101, v101, v103, 31
    v_sub_u32_dpp v103, v226, v226 row_ror:15 row_mask:0xf bank_mask:0xf
    v_alignbit_b32 v101, v101, v102, 31
    v_alignbit_b32 v101, v101, v103, 31
    v_bcnt_u32_b32 v101, v101, 0
    v_cmp_le_u32 s[60:61], 8, v101
    v_sub_u32 v104, 15, v101
    v_and_b32 v97, 0x7ff, v226
    v_add_u32 v98, 1, v104
    v_sub_u32 v97, v97, v55
    v_cmp_eq_u32 s[62:63], 0, v97
    v_cmp_eq_u32 s[64:65], 1, v97
    v_cndmask_b32 v98, 0, v98, s[60:61]
    v_cndmask_b32 v99, 0, v98, s[62:63]
    v_cndmask_b32 v100, 0, v98, s[64:65]
    v_lshl_or_b32 v99, v100, 8, v99
    v_cmp_ne_u32 vcc, 0, v99
    v_mov_b32 v106, v1
    v_mov_b32 v107, v1
    v_mov_b32 v108, v54
    s_mov_b32 s59, 0
    s_cbranch_vccz L_k2_nobase
    v_or_b32_dpp v99, v99, v99 row_ror:8 row_mask:0xf bank_mask:0xf
    s_nop 1
    v_or_b32_dpp v99, v99, v99 row_ror:4 row_mask:0xf bank_mask:0xf
    s_nop 1
    v_or_b32_dpp v99, v99, v99 row_ror:2 row_mask:0xf bank_mask:0xf
    s_nop 1
    v_or_b32_dpp v99, v99, v99 row_ror:1 row_mask:0xf bank_mask:0xf
    s_nop 1
    v_lshrrev_b32 v100, 8, v99
    v_and_b32 v99, 0xff, v99
    v_cmp_eq_u32 s[62:63], 0, v99
    v_cmp_eq_u32 s[64:65], 0, v100
    v_cndmask_b32 v101, v99, v100, s[42:43]
    v_cmp_eq_u32 s[66:67], 0, v101
    v_lshl_add_u32 v109, v99, 4, v7
    v_lshl_add_u32 v110, v100, 4, v7
    v_lshl_add_u32 v111, v101, 4, v8
    v_xor_b32 v28, v105, v28
    v_cndmask_b32 v28, v28, v105, s[62:63]
    v_xor_b32 v29, v105, v29
    v_cndmask_b32 v29, v29, v105, s[64:65]
    v_xor_b32 v30, v105, v30
    v_cndmask_b32 v30, v30, v105, s[66:67]
    buffer_store_dwordx4 v[32:35], v28, s[16:19], s34 offen sc1
    buffer_store_dwordx4 v[36:39], v29, s[16:19], s34 offen offset:1152 sc1
    buffer_store_dword v40, v30, s[16:19], s34 offen sc1
    v_cndmask_b32 v109, v109, v105, s[62:63]
    v_cndmask_b32 v106, v105, v106, s[62:63]
    v_cndmask_b32 v110, v110, v105, s[64:65]
    v_cndmask_b32 v107, v105, v107, s[64:65]
    v_cndmask_b32 v111, v111, v105, s[66:67]
    v_cndmask_b32 v108, v105, v108, s[66:67]
    buffer_store_dwordx4 v[216:219], v109, s[16:19], s41 offen sc1
    buffer_store_dwordx4 v[220:223], v110, s[16:19], s41 offen sc1
    buffer_store_dword v224, v111, s[16:19], s41 offen sc1
    s_mov_b32 s59, 1
L_k2_nobase:
    s_cmp_ge_u32 s2, 144
    s_cbranch_scc1 L_k2_reduce
    v_lshrrev_b32 v96, 11, v226
    v_lshl_or_b32 v96, v96, 1, 1
    v_lshlrev_b32 v96, 11, v96
    v_ashrrev_i32 v97, 31, v96
    v_not_b32 v97, v97
    v_or_b32 v97, s8, v97
    v_xor_b32 v96, v96, v97
    v_mul_f32 v96, 0xbfb8aa3b, v96
    v_exp_f32 v96, v96
    v_lshl_add_u32 v98, v104, 4, v4
    v_add_f32 v96, 1.0, v96
    v_rcp_f32 v109, v96
    v_cndmask_b32 v112, v105, v98, s[60:61]
    v_or_b32 v113, v112, v5
    s_mov_b32 s47, 0
    s_cmp_eq_u32 s59, 1
    s_waitcnt vmcnt(6) lgkmcnt(0)
    s_cbranch_scc1 L_k2_ffn
    s_waitcnt vmcnt(0)
L_k2_ffn:
    s_barrier
    ds_read_b128 v[128:131], v2 offset:0
    ds_read_b128 v[132:135], v3 offset:0
    ds_read_b128 v[136:139], v2 offset:2048
    ds_read_b128 v[140:143], v3 offset:2048
    ds_read_b128 v[144:147], v2 offset:4096
    ds_read_b128 v[148:151], v3 offset:4096
    ds_read_b128 v[152:155], v2 offset:6144
    ds_read_b128 v[156:159], v3 offset:6144
    v_mov_b32 v114, 0
    s_waitcnt lgkmcnt(6)
    v_mfma_f32_16x16x32_bf16 v[116:119], a[0:3], v[128:131], 0
    ds_read_b128 v[160:163], v2 offset:8192
    v_mfma_f32_16x16x32_bf16 v[116:119], a[4:7], v[132:135], v[116:119]
    ds_read_b128 v[164:167], v3 offset:8192
    v_max3_u32 v114, v114, v128, v132
    s_waitcnt lgkmcnt(6)
    v_mfma_f32_16x16x32_bf16 v[116:119], a[8:11], v[136:139], v[116:119]
    ds_read_b128 v[168:171], v2 offset:10240
    v_mfma_f32_16x16x32_bf16 v[116:119], a[12:15], v[140:143], v[116:119]
    ds_read_b128 v[172:175], v3 offset:10240
    v_max3_u32 v114, v114, v136, v140
    s_waitcnt lgkmcnt(6)
    v_mfma_f32_16x16x32_bf16 v[116:119], a[16:19], v[144:147], v[116:119]
    ds_read_b128 v[176:179], v2 offset:12288
    v_mfma_f32_16x16x32_bf16 v[116:119], a[20:23], v[148:151], v[116:119]
    ds_read_b128 v[180:183], v3 offset:12288
    v_max3_u32 v114, v114, v144, v148
    s_waitcnt lgkmcnt(6)
    v_mfma_f32_16x16x32_bf16 v[116:119], a[24:27], v[152:155], v[116:119]
    ds_read_b128 v[184:187], v2 offset:14336
    v_mfma_f32_16x16x32_bf16 v[116:119], a[28:31], v[156:159], v[116:119]
    ds_read_b128 v[188:191], v3 offset:14336
    v_max3_u32 v114, v114, v152, v156
    s_waitcnt lgkmcnt(6)
    v_mfma_f32_16x16x32_bf16 v[116:119], a[32:35], v[160:163], v[116:119]
    ds_read_b128 v[192:195], v2 offset:16384
    v_mfma_f32_16x16x32_bf16 v[116:119], a[36:39], v[164:167], v[116:119]
    ds_read_b128 v[196:199], v3 offset:16384
    v_max3_u32 v114, v114, v160, v164
    s_waitcnt lgkmcnt(6)
    v_mfma_f32_16x16x32_bf16 v[116:119], a[40:43], v[168:171], v[116:119]
    v_mfma_f32_16x16x32_bf16 v[116:119], a[44:47], v[172:175], v[116:119]
    v_max3_u32 v114, v114, v168, v172
    s_waitcnt lgkmcnt(4)
    v_mfma_f32_16x16x32_bf16 v[116:119], a[48:51], v[176:179], v[116:119]
    v_mfma_f32_16x16x32_bf16 v[116:119], a[52:55], v[180:183], v[116:119]
    v_max3_u32 v114, v114, v176, v180
    s_waitcnt lgkmcnt(2)
    v_mfma_f32_16x16x32_bf16 v[116:119], a[56:59], v[184:187], v[116:119]
    v_mfma_f32_16x16x32_bf16 v[116:119], a[60:63], v[188:191], v[116:119]
    v_max3_u32 v114, v114, v184, v188
    s_waitcnt lgkmcnt(0)
    v_mfma_f32_16x16x32_bf16 v[116:119], a[64:67], v[192:195], v[116:119]
    v_max3_u32 v114, v114, v192, v193
    v_max3_u32 v114, v114, v194, v195
    v_mfma_f32_16x16x32_bf16 v[116:119], a[68:71], v[196:199], v[116:119]
    v_max3_u32 v114, v114, v196, v197
    v_max3_u32 v114, v114, v198, v199
    v_cmp_eq_u32 vcc, -1, v114
    s_nop 3
    s_cbranch_vccnz L_k2_regather
L_k2_ffn2:
    v_permlane32_swap_b32 v116, v118
    v_permlane32_swap_b32 v117, v119
    s_nop 0
    v_mul_f32 v120, 0xbfb8aa3b, v116
    v_mul_f32 v121, 0xbfb8aa3b, v117
    v_exp_f32 v120, v120
    v_exp_f32 v121, v121
    v_mul_f32 v116, v116, v118
    v_mul_f32 v117, v117, v119
    v_add_f32 v120, 1.0, v120
    v_add_f32 v121, 1.0, v121
    v_rcp_f32 v120, v120
    v_rcp_f32 v121, v121
    v_mul_f32 v116, v116, v109
    v_mul_f32 v117, v117, v109
    v_mul_f32 v116, v116, v120
    v_mul_f32 v117, v117, v121
    v_cvt_pk_bf16_f32 v116, v116, v117
    ds_write_b32 v11, v116
    buffer_store_dword v61, v6, s[16:19], s39 offen sc1
    s_waitcnt lgkmcnt(0)
    s_barrier
    ds_read_b128 v[228:231], v12 offset:10240
    s_waitcnt lgkmcnt(0)
    v_mfma_f32_16x16x32_bf16 v[128:131], a[112:115], v[228:231], 0
    v_mfma_f32_16x16x32_bf16 v[132:135], a[116:119], v[228:231], 0
    v_mfma_f32_16x16x32_bf16 v[136:139], a[120:123], v[228:231], 0
    v_mfma_f32_16x16x32_bf16 v[140:143], a[124:127], v[228:231], 0
    v_mfma_f32_16x16x32_bf16 v[144:147], a[128:131], v[228:231], 0
    v_mfma_f32_16x16x32_bf16 v[148:151], a[132:135], v[228:231], 0
    v_mfma_f32_16x16x32_bf16 v[152:155], a[136:139], v[228:231], 0
    v_mfma_f32_16x16x32_bf16 v[156:159], a[140:143], v[228:231], 0
    v_mfma_f32_16x16x32_bf16 v[160:163], a[144:147], v[228:231], 0
    s_nop 0
    v_cvt_pk_bf16_f32 v64, v128, v129
    v_cvt_pk_bf16_f32 v66, v132, v133
    v_cvt_pk_bf16_f32 v65, v130, v131
    v_cvt_pk_bf16_f32 v67, v134, v135
    v_permlane16_swap_b32 v64, v66
    s_nop 0
    v_permlane16_swap_b32 v65, v67
    v_min_u32 v64, -2, v64
    buffer_store_dwordx4 v[64:67], v112, s[16:19], s38 offen sc1
    v_cvt_pk_bf16_f32 v68, v136, v137
    v_cvt_pk_bf16_f32 v70, v140, v141
    v_cvt_pk_bf16_f32 v69, v138, v139
    v_cvt_pk_bf16_f32 v71, v142, v143
    v_permlane16_swap_b32 v68, v70
    s_add_u32 s38, s38, 81920
L_padb5:
    s_cbranch_execz L_warm2_done
    v_permlane16_swap_b32 v69, v71
    v_min_u32 v68, -2, v68
    buffer_store_dwordx4 v[68:71], v112, s[16:19], s38 offen sc1
    v_cvt_pk_bf16_f32 v72, v144, v145
    v_cvt_pk_bf16_f32 v74, v148, v149
    v_cvt_pk_bf16_f32 v73, v146, v147
    v_cvt_pk_bf16_f32 v75, v150, v151
    v_permlane16_swap_b32 v72, v74
    s_add_u32 s38, s38, 81920
    v_permlane16_swap_b32 v73, v75
    v_min_u32 v72, -2, v72
    buffer_store_dwordx4 v[72:75], v112, s[16:19], s38 offen sc1
    v_cvt_pk_bf16_f32 v76, v152, v153
    v_cvt_pk_bf16_f32 v78, v156, v157
    v_cvt_pk_bf16_f32 v77, v154, v155
    v_cvt_pk_bf16_f32 v79, v158, v159
    v_permlane16_swap_b32 v76, v78
    s_add_u32 s38, s38, 81920
    v_permlane16_swap_b32 v77, v79
    v_min_u32 v76, -2, v76
    buffer_store_dwordx4 v[76:79], v112, s[16:19], s38 offen sc1
    v_cvt_pk_bf16_f32 v80, v160, v161
    v_cvt_pk_bf16_f32 v82, v160, v161
    v_cvt_pk_bf16_f32 v81, v162, v163
    v_cvt_pk_bf16_f32 v83, v162, v163
    v_permlane16_swap_b32 v80, v82
    s_add_u32 s38, s38, 81920
    v_permlane16_swap_b32 v81, v83
    v_min_u32 v80, -2, v80
    buffer_store_dwordx4 v[80:83], v113, s[16:19], s38 offen sc1
    buffer_store_dwordx4 v[216:219], v106, s[24:27], 0 offen sc1
    buffer_store_dwordx4 v[220:223], v107, s[24:27], 0 offen offset:1152 sc1
    buffer_store_dword v224, v108, s[24:27], 0 offen sc1
    s_endpgm
L_k2_regather:
    s_add_u32 s47, s47, 1
    s_cmp_ge_u32 s47, 200000
    s_cbranch_scc1 L_k2_ffn2
    s_barrier
    s_add_u32 m0, s11, 0
    s_add_u32 s54, s10, 0
    buffer_load_dwordx4 v232, s[16:19], s54 offen sc1 lds
    s_add_u32 m0, s11, 4096
    s_add_u32 s54, s10, 256
    buffer_load_dwordx4 v232, s[16:19], s54 offen sc1 lds
    s_add_u32 m0, s11, 8192
    s_add_u32 s54, s10, 512
    buffer_load_dwordx4 v232, s[16:19], s54 offen sc1 lds
    s_add_u32 m0, s11, 12288
    s_add_u32 s54, s10, 768
    buffer_load_dwordx4 v232, s[16:19], s54 offen sc1 lds
    s_add_u32 m0, s11, 16384
    s_mov_b32 s54, 3191808
    buffer_load_dwordx4 v232, s[16:19], s54 offen sc1 lds
    s_waitcnt vmcnt(0)
    s_branch L_k2_ffn
L_k2_reduce:
L_padb6:
    s_cbranch_execz L_warm2_done
    buffer_store_dwordx4 v[216:219], v106, s[24:27], 0 offen sc1
    buffer_store_dwordx4 v[220:223], v107, s[24:27], 0 offen offset:1152 sc1
    buffer_store_dword v224, v108, s[24:27], 0 offen sc1
    s_cmp_ge_u32 s2, 216
    s_cselect_b32 s54, 1, s32
    s_cmp_lg_u32 s54, 0
    s_cbranch_scc1 L_k2_done
    v_lshlrev_b32 v96, 2, v104
    s_mov_b64 exec, s[60:61]
    ds_write_b32 v96, v226 offset:19520
    s_mov_b64 exec, -1
    v_and_b32 v96, 7, v0
    v_lshlrev_b32 v96, 2, v96
    ds_read_b32 v97, v96 offset:19520
    v_cmp_eq_u32 s[62:63], 0, v56
    v_cmp_eq_u32 s[64:65], 1, v56
    v_mov_b32 v98, 0x3f80
    v_cndmask_b32 v228, 0, v98, s[62:63]
    v_cndmask_b32 v228, v228, 1.0, s[64:65]
    v_cmp_eq_u32 s[62:63], 2, v56
    v_cmp_eq_u32 s[64:65], 3, v56
    v_mov_b32 v98, 0x3f80
    v_cndmask_b32 v229, 0, v98, s[62:63]
    v_cndmask_b32 v229, v229, 1.0, s[64:65]
    v_cmp_eq_u32 s[62:63], 4, v56
    v_cmp_eq_u32 s[64:65], 5, v56
    v_mov_b32 v98, 0x3f80
    v_cndmask_b32 v230, 0, v98, s[62:63]
    v_cndmask_b32 v230, v230, 1.0, s[64:65]
    v_cmp_eq_u32 s[62:63], 6, v56
    v_cmp_eq_u32 s[64:65], 7, v56
    v_mov_b32 v98, 0x3f80
    v_cndmask_b32 v231, 0, v98, s[62:63]
    v_cndmask_b32 v231, v231, 1.0, s[64:65]
    v_cmp_gt_u32 vcc, 8, v0
    s_sub_u32 s54, s2, 144
    s_mul_i32 s55, s54, 20480
    v_cndmask_b32 v99, v105, v12, vcc
    s_add_u32 s55, s55, 5816320
    s_add_u32 s56, s55, 4096
    s_add_u32 s57, s55, 8192
    s_add_u32 s58, s55, 12288
    s_add_u32 s59, s55, 16384
    s_add_u32 s53, s55, 19456
    v_lshlrev_b32 v96, 5, v96
    s_lshl_b32 s54, s54, 4
    v_and_b32 v100, 40, v0
    v_cmp_eq_u32 vcc, 0, v100
    s_waitcnt lgkmcnt(0)
    v_and_b32 v97, 0x7ff, v97
    v_mul_u32_u24 v97, 1152, v97
    v_lshl_add_u32 v97, v57, 3, v97
    v_cndmask_b32 v97, v105, v97, vcc
    s_mov_b32 s47, 0
L_k2_rgate:
    buffer_load_dword v101, v96, s[16:19], s53 offen sc1
    s_waitcnt vmcnt(0)
    v_cmp_eq_u32 vcc, -1, v101
    s_cbranch_vccz L_k2_rpoll0
    s_add_u32 s47, s47, 1
    s_cmp_lt_u32 s47, 200000
    s_cbranch_scc1 L_k2_rgate
L_k2_rpoll0:
L_k2_rpoll:
    buffer_load_dwordx4 v[120:123], v12, s[16:19], s55 offen offset:0 sc1
    buffer_load_dwordx4 v[124:127], v12, s[16:19], s55 offen offset:1024 sc1
    buffer_load_dwordx4 v[128:131], v12, s[16:19], s55 offen offset:2048 sc1
    buffer_load_dwordx4 v[132:135], v12, s[16:19], s55 offen offset:3072 sc1
    buffer_load_dwordx4 v[136:139], v12, s[16:19], s56 offen offset:0 sc1
    buffer_load_dwordx4 v[140:143], v12, s[16:19], s56 offen offset:1024 sc1
    buffer_load_dwordx4 v[144:147], v12, s[16:19], s56 offen offset:2048 sc1
    buffer_load_dwordx4 v[148:151], v12, s[16:19], s56 offen offset:3072 sc1
    buffer_load_dwordx4 v[152:155], v12, s[16:19], s57 offen offset:0 sc1
    buffer_load_dwordx4 v[156:159], v12, s[16:19], s57 offen offset:1024 sc1
    buffer_load_dwordx4 v[160:163], v12, s[16:19], s57 offen offset:2048 sc1
    buffer_load_dwordx4 v[164:167], v12, s[16:19], s57 offen offset:3072 sc1
    buffer_load_dwordx4 v[168:171], v12, s[16:19], s58 offen offset:0 sc1
    buffer_load_dwordx4 v[172:175], v12, s[16:19], s58 offen offset:1024 sc1
    buffer_load_dwordx4 v[176:179], v12, s[16:19], s58 offen offset:2048 sc1
    buffer_load_dwordx4 v[180:183], v12, s[16:19], s58 offen offset:3072 sc1
    buffer_load_dwordx4 v[184:187], v12, s[16:19], s59 offen offset:0 sc1
    buffer_load_dwordx4 v[188:191], v12, s[16:19], s59 offen offset:1024 sc1
    buffer_load_dwordx4 v[192:195], v99, s[16:19], s59 offen offset:2048 sc1
    v_mov_b32 v101, 0
    s_waitcnt vmcnt(18)
    v_mfma_f32_16x16x32_bf16 v[106:109], v[228:231], v[120:123], 0
    s_waitcnt vmcnt(17)
    v_mfma_f32_16x16x32_bf16 v[106:109], v[228:231], v[124:127], v[106:109]
    v_max3_u32 v101, v101, v120, v124
    s_waitcnt vmcnt(16)
    v_mfma_f32_16x16x32_bf16 v[106:109], v[228:231], v[128:131], v[106:109]
    s_waitcnt vmcnt(15)
    v_mfma_f32_16x16x32_bf16 v[106:109], v[228:231], v[132:135], v[106:109]
    v_max3_u32 v101, v101, v128, v132
    s_waitcnt vmcnt(14)
    v_mfma_f32_16x16x32_bf16 v[106:109], v[228:231], v[136:139], v[106:109]
    s_waitcnt vmcnt(13)
    v_mfma_f32_16x16x32_bf16 v[106:109], v[228:231], v[140:143], v[106:109]
    v_max3_u32 v101, v101, v136, v140
    s_waitcnt vmcnt(12)
    v_mfma_f32_16x16x32_bf16 v[106:109], v[228:231], v[144:147], v[106:109]
    s_waitcnt vmcnt(11)
    v_mfma_f32_16x16x32_bf16 v[106:109], v[228:231], v[148:151], v[106:109]
    v_max3_u32 v101, v101, v144, v148
    s_waitcnt vmcnt(10)
    v_mfma_f32_16x16x32_bf16 v[106:109], v[228:231], v[152:155], v[106:109]
    s_waitcnt vmcnt(9)
    v_mfma_f32_16x16x32_bf16 v[106:109], v[228:231], v[156:159], v[106:109]
    v_max3_u32 v101, v101, v152, v156
    s_waitcnt vmcnt(8)
    v_mfma_f32_16x16x32_bf16 v[106:109], v[228:231], v[160:163], v[106:109]
    s_waitcnt vmcnt(7)
    v_mfma_f32_16x16x32_bf16 v[106:109], v[228:231], v[164:167], v[106:109]
    v_max3_u32 v101, v101, v160, v164
    s_waitcnt vmcnt(6)
    v_mfma_f32_16x16x32_bf16 v[106:109], v[228:231], v[168:171], v[106:109]
    s_waitcnt vmcnt(5)
    v_mfma_f32_16x16x32_bf16 v[106:109], v[228:231], v[172:175], v[106:109]
    v_max3_u32 v101, v101, v168, v172
    s_waitcnt vmcnt(4)
    v_mfma_f32_16x16x32_bf16 v[106:109], v[228:231], v[176:179], v[106:109]
    s_waitcnt vmcnt(3)
    v_mfma_f32_16x16x32_bf16 v[106:109], v[228:231], v[180:183], v[106:109]
    v_max3_u32 v101, v101, v176, v180
    s_waitcnt vmcnt(2)
    v_mfma_f32_16x16x32_bf16 v[106:109], v[228:231], v[184:187], v[106:109]
    s_waitcnt vmcnt(1)
    v_mfma_f32_16x16x32_bf16 v[106:109], v[228:231], v[188:191], v[106:109]
    v_max3_u32 v101, v101, v184, v188
    s_waitcnt vmcnt(0)
    v_mfma_f32_16x16x32_bf16 v[106:109], v[228:231], v[192:195], v[106:109]
    v_max3_u32 v101, v101, v192, v193
    v_max3_u32 v101, v101, v194, v195
    v_cmp_eq_u32 vcc, -1, v101
    s_nop 3
    s_cbranch_vccz L_k2_rdone
    s_add_u32 s47, s47, 1
    s_cmp_lt_u32 s47, 200000
    s_cbranch_scc1 L_k2_rpoll
L_k2_rdone:
    s_nop 0
    v_add_f32_dpp v106, v106, v106 row_ror:8 row_mask:0xf bank_mask:0xf
    v_add_f32_dpp v107, v107, v107 row_ror:8 row_mask:0xf bank_mask:0xf
    v_add_f32_dpp v108, v108, v108 row_ror:8 row_mask:0xf bank_mask:0xf
    v_add_f32_dpp v109, v109, v109 row_ror:8 row_mask:0xf bank_mask:0xf
    v_cvt_pk_bf16_f32 v106, v106, v107
    v_cvt_pk_bf16_f32 v107, v108, v109
    buffer_store_dwordx2 v[106:107], v97, s[24:27], s54 offen
L_k2_done:
    s_endpgm
L_qspin:
L_padb7:
    s_cbranch_execz L_warm2_done
    s_mov_b32 s47, 0
L_qspin1:
    buffer_load_dwordx4 v[112:115], v227, s[16:19], s5 offen sc1
    s_waitcnt vmcnt(0)
    v_cmp_eq_u32 vcc, -1, v112
    s_cbranch_vccz L_qok
    s_add_u32 s47, s47, 1
    s_cmp_lt_u32 s47, 200000
    s_cbranch_scc1 L_qspin1
    s_branch L_qok
L_k2_fresh:
L_padb8:
    s_cbranch_execz L_warm2_done
    s_cmp_eq_u32 s58, 1
    s_cbranch_scc1 L_k2_selslow
    s_mov_b32 s58, 1
    ds_write_b32 v58, v14 offset:19456
    v_max3_i32 v96, v64, v68, v72
    v_max3_i32 v96, v96, v76, 0
    v_mov_b32 v100, v96
    s_nop 1
    v_permlane16_swap_b32 v100, v96
    s_nop 0
    v_max_u32 v96, v96, v100
    v_mov_b32 v100, v96
    s_nop 1
    v_permlane32_swap_b32 v100, v96
    s_nop 0
    v_max_u32 v96, v96, v100
    s_nop 0
    v_mov_b32 v101, 0
    v_sub_u32_dpp v103, v96, v96 row_ror:1 row_mask:0xf bank_mask:0xf
    v_sub_u32_dpp v102, v96, v96 row_ror:2 row_mask:0xf bank_mask:0xf
    v_alignbit_b32 v101, v101, v103, 31
    v_sub_u32_dpp v103, v96, v96 row_ror:3 row_mask:0xf bank_mask:0xf
    v_alignbit_b32 v101, v101, v102, 31
    v_sub_u32_dpp v102, v96, v96 row_ror:4 row_mask:0xf bank_mask:0xf
    v_alignbit_b32 v101, v101, v103, 31
    v_sub_u32_dpp v103, v96, v96 row_ror:5 row_mask:0xf bank_mask:0xf
    v_alignbit_b32 v101, v101, v102, 31
    v_sub_u32_dpp v102, v96, v96 row_ror:6 row_mask:0xf bank_mask:0xf
    v_alignbit_b32 v101, v101, v103, 31
    v_sub_u32_dpp v103, v96, v96 row_ror:7 row_mask:0xf bank_mask:0xf
    v_alignbit_b32 v101, v101, v102, 31
    v_sub_u32_dpp v102, v96, v96 row_ror:8 row_mask:0xf bank_mask:0xf
    v_alignbit_b32 v101, v101, v103, 31
    v_sub_u32_dpp v103, v96, v96 row_ror:9 row_mask:0xf bank_mask:0xf
    v_alignbit_b32 v101, v101, v102, 31
    v_sub_u32_dpp v102, v96, v96 row_ror:10 row_mask:0xf bank_mask:0xf
    v_alignbit_b32 v101, v101, v103, 31
    v_sub_u32_dpp v103, v96, v96 row_ror:11 row_mask:0xf bank_mask:0xf
    v_alignbit_b32 v101, v101, v102, 31
    v_sub_u32_dpp v102, v96, v96 row_ror:12 row_mask:0xf bank_mask:0xf
    v_alignbit_b32 v101, v101, v103, 31
    v_sub_u32_dpp v103, v96, v96 row_ror:13 row_mask:0xf bank_mask:0xf
    v_alignbit_b32 v101, v101, v102, 31
    v_sub_u32_dpp v102, v96, v96 row_ror:14 row_mask:0xf bank_mask:0xf
    v_alignbit_b32 v101, v101, v103, 31
    v_sub_u32_dpp v103, v96, v96 row_ror:15 row_mask:0xf bank_mask:0xf
    v_alignbit_b32 v101, v101, v102, 31
    v_alignbit_b32 v101, v101, v103, 31
    v_bcnt_u32_b32 v101, v101, 0
    v_cmp_eq_u32 vcc, 8, v101
    s_ff1_i32_b64 s52, vcc
    s_and_b32 s52, s52, 63
    v_readlane_b32 s52, v96, s52
    s_cmp_eq_u64 vcc, 0
    s_cselect_b32 s52, 1, s52
    s_branch L_k2_polled
L_k2_selslow:
    s_mov_b32 s47, 0
L_k2_poll2:
    buffer_load_dwordx4 v[64:67], v9, s[16:19], s48 offen offset:0 sc1
    buffer_load_dwordx4 v[68:71], v9, s[16:19], s49 offen offset:0 sc1
    buffer_load_dwordx4 v[72:75], v9, s[16:19], s50 offen offset:0 sc1
    buffer_load_dwordx4 v[76:79], v9, s[16:19], s51 offen offset:0 sc1
    buffer_load_dwordx4 v[80:83], v9, s[16:19], s48 offen offset:16 sc1
    buffer_load_dwordx4 v[84:87], v9, s[16:19], s49 offen offset:16 sc1
    buffer_load_dwordx4 v[88:91], v9, s[16:19], s50 offen offset:16 sc1
    buffer_load_dwordx4 v[92:95], v9, s[16:19], s51 offen offset:16 sc1
    s_waitcnt vmcnt(0) lgkmcnt(0)
    v_max_u32 v128, v64, v65
    v_max3_u32 v128, v128, v66, v67
    v_max3_u32 v128, v128, v68, v69
    v_max3_u32 v128, v128, v70, v71
    v_max3_u32 v128, v128, v72, v73
    v_max3_u32 v128, v128, v74, v75
    v_max3_u32 v128, v128, v76, v77
    v_max3_u32 v128, v128, v78, v79
    v_max3_u32 v128, v128, v80, v81
    v_max3_u32 v128, v128, v82, v83
    v_max3_u32 v128, v128, v84, v85
    v_max3_u32 v128, v128, v86, v87
    v_max3_u32 v128, v128, v88, v89
    v_max3_u32 v128, v128, v90, v91
    v_max3_u32 v128, v128, v92, v93
    v_max3_u32 v128, v128, v94, v95
    v_cmp_gt_i32 vcc, 0, v128
    s_nop 3
    s_cbranch_vccz L_k2_polled2
    s_add_u32 s47, s47, 1
    s_cmp_lt_u32 s47, 200000
    s_cbranch_scc1 L_k2_poll2
L_k2_polled2:
    s_mov_b32 s52, -1
    s_mov_b32 s53, 0
    v_mov_b32 v226, 0
L_k2_selround:
    v_sub_u32 v128, s52, v64
    v_sub_u32 v129, s52, v65
    v_sub_u32 v130, s52, v66
    v_sub_u32 v131, s52, v67
    v_sub_u32 v132, s52, v68
    v_sub_u32 v133, s52, v69
    v_sub_u32 v134, s52, v70
    v_sub_u32 v135, s52, v71
    v_sub_u32 v136, s52, v72
    v_sub_u32 v137, s52, v73
    v_sub_u32 v138, s52, v74
    v_sub_u32 v139, s52, v75
    v_sub_u32 v140, s52, v76
    v_sub_u32 v141, s52, v77
    v_sub_u32 v142, s52, v78
    v_sub_u32 v143, s52, v79
    v_sub_u32 v144, s52, v80
    v_sub_u32 v145, s52, v81
    v_sub_u32 v146, s52, v82
    v_sub_u32 v147, s52, v83
    v_sub_u32 v148, s52, v84
    v_sub_u32 v149, s52, v85
    v_sub_u32 v150, s52, v86
    v_sub_u32 v151, s52, v87
    v_sub_u32 v152, s52, v88
    v_sub_u32 v153, s52, v89
    v_sub_u32 v154, s52, v90
    v_sub_u32 v155, s52, v91
    v_sub_u32 v156, s52, v92
    v_sub_u32 v157, s52, v93
    v_sub_u32 v158, s52, v94
    v_sub_u32 v159, s52, v95
    v_min_u32 v128, v128, v129
    v_min3_u32 v128, v128, v130, v131
    v_min3_u32 v128, v128, v132, v133
    v_min3_u32 v128, v128, v134, v135
    v_min3_u32 v128, v128, v136, v137
    v_min3_u32 v128, v128, v138, v139
    v_min3_u32 v128, v128, v140, v141
    v_min3_u32 v128, v128, v142, v143
    v_min3_u32 v128, v128, v144, v145
    v_min3_u32 v128, v128, v146, v147
    v_min3_u32 v128, v128, v148, v149
    v_min3_u32 v128, v128, v150, v151
    v_min3_u32 v128, v128, v152, v153
    v_min3_u32 v128, v128, v154, v155
    v_min3_u32 v128, v128, v156, v157
    v_min3_u32 v128, v128, v158, v159
    s_nop 1
    v_min_u32_dpp v128, v128, v128 row_ror:8 row_mask:0xf bank_mask:0xf
    s_nop 1
    v_min_u32_dpp v128, v128, v128 row_ror:4 row_mask:0xf bank_mask:0xf
    s_nop 1
    v_min_u32_dpp v128, v128, v128 row_ror:2 row_mask:0xf bank_mask:0xf
    s_nop 1
    v_min_u32_dpp v128, v128, v128 row_ror:1 row_mask:0xf bank_mask:0xf
    s_nop 0
    v_readlane_b32 s54, v128, 0
    v_readlane_b32 s55, v128, 16
    v_readlane_b32 s56, v128, 32
    v_readlane_b32 s57, v128, 48
    v_cmp_eq_u32 vcc, s53, v56
    s_min_u32 s54, s54, s55
    s_min_u32 s56, s56, s57
    s_min_u32 s54, s54, s56
    s_sub_u32 s54, s52, s54
    v_mov_b32 v128, s54
    v_cndmask_b32 v226, v226, v128, vcc
    s_sub_u32 s52, s54, 1
    s_add_u32 s53, s53, 1
    s_cmp_lt_u32 s53, 8
    s_cbranch_scc1 L_k2_selround
    ds_write_b32 v58, v226 offset:19456
    s_branch L_k2_listed
L_wospin:
    s_mov_b32 s47, 0
L_wospin1:
    s_sleep 2
    buffer_load_dword v222, v220, s[16:19], 0 offen sc1
    buffer_load_dword v213, v255, s[16:19], 0 offen sc1
    s_waitcnt vmcnt(0)
    v_min_u32 v212, v213, v222
    v_cmp_eq_u32 s[10:11], 0, v212
    s_cmp_eq_u64 s[10:11], 0
    s_cbranch_scc1 L_wook
    s_add_u32 s47, s47, 1
    s_cmp_lt_u32 s47, 200000
    s_cbranch_scc1 L_wospin1
    s_branch L_wook
L_k2_slow:
    s_waitcnt vmcnt(0) lgkmcnt(0)
    s_barrier
    v_and_b32 v214, 31, v0
    v_lshrrev_b32 v215, 5, v0
    v_cmp_gt_u32 vcc, 18, v214
    v_and_b32 v217, 30, v214
    v_cmp_eq_u32 s[6:7], 20, v217
    v_mov_b32 v217, 133169152
    v_subrev_u32 v216, 2, v214
    v_cndmask_b32 v217, v217, v214, vcc
    v_cndmask_b32 v217, v217, v216, s[6:7]
    v_mul_u32_u24 v216, 320, v215
    v_lshl_add_u32 v136, v217, 4, v216
    v_add_u32 v137, 2560, v136
    v_add_u32 v138, 5120, v12
    v_add_u32 v139, 9216, v12
    buffer_load_dwordx4 v[212:215], v1, s[20:23], 0 offen
    buffer_load_dwordx4 v[216:219], v1, s[20:23], 0 offen offset:1152
    buffer_load_ushort v30, v247, s[20:23], 0 offen
    buffer_load_ushort v31, v247, s[20:23], 0 offen offset:1152
    s_mov_b32 s43, 0xffff0000
    buffer_load_dwordx4 a[64:67], v139, s[52:55], 0 offen sc1
    buffer_load_dwordx4 a[0:3], v138, s[52:55], 0 offen offset:0 sc1
    buffer_load_dwordx4 a[4:7], v138, s[52:55], 0 offen offset:1024 sc1
    buffer_load_dwordx4 a[80:83], v136, s[52:55], 0 offen offset:0 sc1
    buffer_load_dwordx4 a[84:87], v136, s[52:55], 0 offen offset:640 sc1
    buffer_load_dwordx4 a[8:11], v138, s[52:55], 0 offen offset:2048 sc1
    buffer_load_dwordx4 a[88:91], v136, s[52:55], 0 offen offset:1280 sc1
    buffer_load_dwordx4 a[92:95], v136, s[52:55], 0 offen offset:1920 sc1
    buffer_load_dwordx4 a[12:15], v138, s[52:55], 0 offen offset:3072 sc1
    buffer_load_dwordx4 a[96:99], v137, s[52:55], 0 offen offset:0 sc1
    buffer_load_dwordx4 a[100:103], v137, s[52:55], 0 offen offset:640 sc1
    buffer_load_dwordx4 a[68:71], v139, s[56:59], 0 offen sc1
    buffer_load_dwordx4 a[16:19], v138, s[56:59], 0 offen offset:0 sc1
    buffer_load_dwordx4 a[104:107], v137, s[52:55], 0 offen offset:1280 sc1
    buffer_load_dwordx4 a[108:111], v137, s[52:55], 0 offen offset:1920 sc1
    buffer_load_dwordx4 a[20:23], v138, s[56:59], 0 offen offset:1024 sc1
    buffer_load_dwordx4 a[112:115], v136, s[56:59], 0 offen offset:0 sc1
    buffer_load_dwordx4 a[116:119], v136, s[56:59], 0 offen offset:640 sc1
    buffer_load_dwordx4 a[24:27], v138, s[56:59], 0 offen offset:2048 sc1
    buffer_load_dwordx4 a[120:123], v136, s[56:59], 0 offen offset:1280 sc1
    buffer_load_dwordx4 a[124:127], v136, s[56:59], 0 offen offset:1920 sc1
    buffer_load_dwordx4 a[28:31], v138, s[56:59], 0 offen offset:3072 sc1
    buffer_load_dwordx4 a[128:131], v137, s[56:59], 0 offen offset:0 sc1
    buffer_load_dwordx4 a[132:135], v137, s[56:59], 0 offen offset:640 sc1
    buffer_load_dwordx4 a[72:75], v139, s[60:63], 0 offen sc1
    buffer_load_dwordx4 a[32:35], v138, s[60:63], 0 offen offset:0 sc1
    buffer_load_dwordx4 a[136:139], v137, s[56:59], 0 offen offset:1280 sc1
    buffer_load_dwordx4 a[140:143], v137, s[56:59], 0 offen offset:1920 sc1
    buffer_load_dwordx4 a[36:39], v138, s[60:63], 0 offen offset:1024 sc1
    buffer_load_dwordx4 a[144:147], v136, s[60:63], 0 offen offset:0 sc1
    buffer_load_dwordx4 a[148:151], v136, s[60:63], 0 offen offset:640 sc1
    buffer_load_dwordx4 a[40:43], v138, s[60:63], 0 offen offset:2048 sc1
    buffer_load_dwordx4 a[152:155], v136, s[60:63], 0 offen offset:1280 sc1
    buffer_load_dwordx4 a[156:159], v136, s[60:63], 0 offen offset:1920 sc1
    buffer_load_dwordx4 a[44:47], v138, s[60:63], 0 offen offset:3072 sc1
    buffer_load_dwordx4 a[160:163], v137, s[60:63], 0 offen offset:0 sc1
    buffer_load_dwordx4 a[164:167], v137, s[60:63], 0 offen offset:640 sc1
    buffer_load_dwordx4 a[76:79], v139, s[64:67], 0 offen sc1
    buffer_load_dwordx4 a[48:51], v138, s[64:67], 0 offen offset:0 sc1
    buffer_load_dwordx4 a[168:171], v137, s[60:63], 0 offen offset:1280 sc1
    buffer_load_dwordx4 a[172:175], v137, s[60:63], 0 offen offset:1920 sc1
    buffer_load_dwordx4 a[52:55], v138, s[64:67], 0 offen offset:1024 sc1
    buffer_load_dwordx4 a[176:179], v136, s[64:67], 0 offen offset:0 sc1
    buffer_load_dwordx4 a[180:183], v136, s[64:67], 0 offen offset:640 sc1
    buffer_load_dwordx4 a[56:59], v138, s[64:67], 0 offen offset:2048 sc1
    buffer_load_dwordx4 a[184:187], v136, s[64:67], 0 offen offset:1280 sc1
    buffer_load_dwordx4 a[188:191], v136, s[64:67], 0 offen offset:1920 sc1
    buffer_load_dwordx4 a[60:63], v138, s[64:67], 0 offen offset:3072 sc1
    buffer_load_dwordx4 a[192:195], v137, s[64:67], 0 offen offset:0 sc1
    buffer_load_dwordx4 a[196:199], v137, s[64:67], 0 offen offset:640 sc1
    buffer_load_dwordx4 a[200:203], v137, s[64:67], 0 offen offset:1280 sc1
    buffer_load_dwordx4 a[204:207], v137, s[64:67], 0 offen offset:1920 sc1
    v_mov_b32 v178, 0
    v_mov_b32 v179, 0
    v_mov_b32 v182, 0
    v_mov_b32 v183, 0
    v_mov_b32 v186, 0
    v_mov_b32 v187, 0
    v_mov_b32 v190, 0
    v_mov_b32 v191, 0
    v_mov_b32 v194, 0
    v_mov_b32 v195, 0
    v_mov_b32 v198, 0
    v_mov_b32 v199, 0
    v_mov_b32 v202, 0
    v_mov_b32 v203, 0
    v_mov_b32 v206, 0
    v_mov_b32 v207, 0
    v_mov_b32 v210, 0
    v_mov_b32 v211, 0
    s_waitcnt vmcnt(0) lgkmcnt(0)
    v_lshlrev_b32 v176, 16, v212
    v_lshlrev_b32 v177, 16, v216
    v_and_b32 v180, s43, v212
    v_and_b32 v181, s43, v216
    v_lshlrev_b32 v184, 16, v213
    v_lshlrev_b32 v185, 16, v217
    v_and_b32 v188, s43, v213
    v_and_b32 v189, s43, v217
    v_lshlrev_b32 v192, 16, v214
    v_lshlrev_b32 v193, 16, v218
    v_and_b32 v196, s43, v214
    v_and_b32 v197, s43, v218
    v_lshlrev_b32 v200, 16, v215
    v_lshlrev_b32 v201, 16, v219
    v_and_b32 v204, s43, v215
    v_and_b32 v205, s43, v219
    v_lshlrev_b32 v208, 16, v30
    v_lshlrev_b32 v209, 16, v31
    v_lshlrev_b32 v145, 2, v0
    s_lshl_b32 s34, s32, 8
    v_add_u32 v146, s34, v145
    s_mov_b32 s43, 0
    s_mov_b32 s45, 0
L_k2_slow_round:
    ds_read2_b32 a[240:241], v4 offset0:0 offset1:1
    ds_read2_b32 a[242:243], v4 offset0:2 offset1:3
    ds_read_b32 a248, v5 offset:0
    ds_read_b32 a251, v5 offset:0
    v_add_u32 v4, 144, v4
    v_add_u32 v5, 144, v5
    s_add_u32 s39, s45, 2531328
    s_add_u32 s40, s16, s39
    s_addc_u32 s41, s17, 0
    global_load_dwordx4 v[64:67], v6, s[40:41] offset:-4096 sc1
    global_load_dwordx4 v[68:71], v6, s[40:41] offset:-3072 sc1
    global_load_dwordx4 v[72:75], v6, s[40:41] offset:-2048 sc1
    global_load_dwordx4 v[76:79], v6, s[40:41] offset:-1024 sc1
    global_load_dwordx4 v[80:83], v6, s[40:41] offset:0 sc1
    global_load_dwordx4 v[84:87], v6, s[40:41] offset:1024 sc1
    global_load_dwordx4 v[88:91], v6, s[40:41] offset:2048 sc1
    global_load_dwordx4 v[92:95], v6, s[40:41] offset:3072 sc1
    s_add_u32 s39, s45, 2539520
    s_add_u32 s40, s16, s39
    s_addc_u32 s41, s17, 0
    global_load_dwordx4 v[96:99], v6, s[40:41] offset:-4096 sc1
    global_load_dwordx4 v[100:103], v6, s[40:41] offset:-3072 sc1
    global_load_dwordx4 v[104:107], v6, s[40:41] offset:-2048 sc1
    global_load_dwordx4 v[108:111], v6, s[40:41] offset:-1024 sc1
    global_load_dwordx4 v[112:115], v6, s[40:41] offset:0 sc1
    global_load_dwordx4 v[116:119], v6, s[40:41] offset:1024 sc1
    global_load_dwordx4 v[120:123], v6, s[40:41] offset:2048 sc1
    global_load_dwordx4 v[124:127], v6, s[40:41] offset:3072 sc1
    s_add_u32 s39, s45, 2547712
    s_add_u32 s40, s16, s39
    s_addc_u32 s41, s17, 0
    global_load_dwordx4 v[128:131], v6, s[40:41] offset:-4096 sc1
    global_load_dwordx4 v[132:135], v6, s[40:41] offset:-3072 sc1
    v_mfma_f32_32x32x8_bf16 a[208:223], v[14:15], v[14:15], 0
    v_mov_b32 v144, 0xff800000
    s_waitcnt vmcnt(0) lgkmcnt(0)
    v_mfma_f32_32x32x8_bf16 v[16:31], a[64:65], a[248:249], 0
    v_mfma_f32_32x32x16_bf16 v[16:31], a[0:3], a[240:243], v[16:31]
    s_nop 11
    v_max3_f32 v144, v144, v16, v17
    v_max3_f32 v144, v144, v18, v19
    v_max3_f32 v144, v144, v20, v21
    v_max3_f32 v144, v144, v22, v23
    v_max3_f32 v144, v144, v24, v25
    v_max3_f32 v144, v144, v26, v27
    v_max3_f32 v144, v144, v28, v29
    v_max3_f32 v144, v144, v30, v31
    v_mfma_f32_32x32x8_bf16 v[16:31], a[64:65], a[250:251], 0
    v_mfma_f32_32x32x16_bf16 v[16:31], a[4:7], a[240:243], v[16:31]
    s_nop 11
    v_max3_f32 v144, v144, v16, v17
    v_max3_f32 v144, v144, v18, v19
    v_max3_f32 v144, v144, v20, v21
    v_max3_f32 v144, v144, v22, v23
    v_max3_f32 v144, v144, v24, v25
    v_max3_f32 v144, v144, v26, v27
    v_max3_f32 v144, v144, v28, v29
    v_max3_f32 v144, v144, v30, v31
    v_mfma_f32_32x32x8_bf16 v[16:31], a[66:67], a[248:249], 0
    v_mfma_f32_32x32x16_bf16 v[16:31], a[8:11], a[240:243], v[16:31]
    s_nop 11
    v_max3_f32 v144, v144, v16, v17
    v_max3_f32 v144, v144, v18, v19
    v_max3_f32 v144, v144, v20, v21
    v_max3_f32 v144, v144, v22, v23
    v_max3_f32 v144, v144, v24, v25
    v_max3_f32 v144, v144, v26, v27
    v_max3_f32 v144, v144, v28, v29
    v_max3_f32 v144, v144, v30, v31
    v_mfma_f32_32x32x8_bf16 v[16:31], a[66:67], a[250:251], 0
    v_mfma_f32_32x32x16_bf16 v[16:31], a[12:15], a[240:243], v[16:31]
    s_nop 11
    v_max3_f32 v144, v144, v16, v17
    v_max3_f32 v144, v144, v18, v19
    v_max3_f32 v144, v144, v20, v21
    v_max3_f32 v144, v144, v22, v23
    v_max3_f32 v144, v144, v24, v25
    v_max3_f32 v144, v144, v26, v27
    v_max3_f32 v144, v144, v28, v29
    v_max3_f32 v144, v144, v30, v31
    v_mfma_f32_32x32x8_bf16 v[16:31], a[68:69], a[248:249], 0
    v_mfma_f32_32x32x16_bf16 v[16:31], a[16:19], a[240:243], v[16:31]
    s_nop 11
    v_max3_f32 v144, v144, v16, v17
    v_max3_f32 v144, v144, v18, v19
    v_max3_f32 v144, v144, v20, v21
    v_max3_f32 v144, v144, v22, v23
    v_max3_f32 v144, v144, v24, v25
    v_max3_f32 v144, v144, v26, v27
    v_max3_f32 v144, v144, v28, v29
    v_max3_f32 v144, v144, v30, v31
    v_mfma_f32_32x32x8_bf16 v[16:31], a[68:69], a[250:251], 0
    v_mfma_f32_32x32x16_bf16 v[16:31], a[20:23], a[240:243], v[16:31]
    s_nop 11
    v_max3_f32 v144, v144, v16, v17
    v_max3_f32 v144, v144, v18, v19
    v_max3_f32 v144, v144, v20, v21
    v_max3_f32 v144, v144, v22, v23
    v_max3_f32 v144, v144, v24, v25
    v_max3_f32 v144, v144, v26, v27
    v_max3_f32 v144, v144, v28, v29
    v_max3_f32 v144, v144, v30, v31
    v_mfma_f32_32x32x8_bf16 v[16:31], a[70:71], a[248:249], 0
    v_mfma_f32_32x32x16_bf16 v[16:31], a[24:27], a[240:243], v[16:31]
    s_nop 11
    v_max3_f32 v144, v144, v16, v17
    v_max3_f32 v144, v144, v18, v19
    v_max3_f32 v144, v144, v20, v21
    v_max3_f32 v144, v144, v22, v23
    v_max3_f32 v144, v144, v24, v25
    v_max3_f32 v144, v144, v26, v27
    v_max3_f32 v144, v144, v28, v29
    v_max3_f32 v144, v144, v30, v31
    v_mfma_f32_32x32x8_bf16 v[16:31], a[70:71], a[250:251], 0
    v_mfma_f32_32x32x16_bf16 v[16:31], a[28:31], a[240:243], v[16:31]
    s_nop 11
    v_max3_f32 v144, v144, v16, v17
    v_max3_f32 v144, v144, v18, v19
    v_max3_f32 v144, v144, v20, v21
    v_max3_f32 v144, v144, v22, v23
    v_max3_f32 v144, v144, v24, v25
    v_max3_f32 v144, v144, v26, v27
    v_max3_f32 v144, v144, v28, v29
    v_max3_f32 v144, v144, v30, v31
    v_mfma_f32_32x32x8_bf16 v[16:31], a[72:73], a[248:249], 0
    v_mfma_f32_32x32x16_bf16 v[16:31], a[32:35], a[240:243], v[16:31]
    s_nop 11
    v_max3_f32 v144, v144, v16, v17
    v_max3_f32 v144, v144, v18, v19
    v_max3_f32 v144, v144, v20, v21
    v_max3_f32 v144, v144, v22, v23
    v_max3_f32 v144, v144, v24, v25
    v_max3_f32 v144, v144, v26, v27
    v_max3_f32 v144, v144, v28, v29
    v_max3_f32 v144, v144, v30, v31
    v_mfma_f32_32x32x8_bf16 v[16:31], a[72:73], a[250:251], 0
    v_mfma_f32_32x32x16_bf16 v[16:31], a[36:39], a[240:243], v[16:31]
    s_nop 11
    v_max3_f32 v144, v144, v16, v17
    v_max3_f32 v144, v144, v18, v19
    v_max3_f32 v144, v144, v20, v21
    v_max3_f32 v144, v144, v22, v23
    v_max3_f32 v144, v144, v24, v25
    v_max3_f32 v144, v144, v26, v27
    v_max3_f32 v144, v144, v28, v29
    v_max3_f32 v144, v144, v30, v31
    v_mfma_f32_32x32x8_bf16 v[16:31], a[74:75], a[248:249], 0
    v_mfma_f32_32x32x16_bf16 v[16:31], a[40:43], a[240:243], v[16:31]
    s_nop 11
    v_max3_f32 v144, v144, v16, v17
    v_max3_f32 v144, v144, v18, v19
    v_max3_f32 v144, v144, v20, v21
    v_max3_f32 v144, v144, v22, v23
    v_max3_f32 v144, v144, v24, v25
    v_max3_f32 v144, v144, v26, v27
    v_max3_f32 v144, v144, v28, v29
    v_max3_f32 v144, v144, v30, v31
    v_mfma_f32_32x32x8_bf16 v[16:31], a[74:75], a[250:251], 0
    v_mfma_f32_32x32x16_bf16 v[16:31], a[44:47], a[240:243], v[16:31]
    s_nop 11
    v_max3_f32 v144, v144, v16, v17
    v_max3_f32 v144, v144, v18, v19
    v_max3_f32 v144, v144, v20, v21
    v_max3_f32 v144, v144, v22, v23
    v_max3_f32 v144, v144, v24, v25
    v_max3_f32 v144, v144, v26, v27
    v_max3_f32 v144, v144, v28, v29
    v_max3_f32 v144, v144, v30, v31
    v_mfma_f32_32x32x8_bf16 v[16:31], a[76:77], a[248:249], 0
    v_mfma_f32_32x32x16_bf16 v[16:31], a[48:51], a[240:243], v[16:31]
    s_nop 11
    v_max3_f32 v144, v144, v16, v17
    v_max3_f32 v144, v144, v18, v19
    v_max3_f32 v144, v144, v20, v21
    v_max3_f32 v144, v144, v22, v23
    v_max3_f32 v144, v144, v24, v25
    v_max3_f32 v144, v144, v26, v27
    v_max3_f32 v144, v144, v28, v29
    v_max3_f32 v144, v144, v30, v31
    v_mfma_f32_32x32x8_bf16 v[16:31], a[76:77], a[250:251], 0
    v_mfma_f32_32x32x16_bf16 v[16:31], a[52:55], a[240:243], v[16:31]
    s_nop 11
    v_max3_f32 v144, v144, v16, v17
    v_max3_f32 v144, v144, v18, v19
    v_max3_f32 v144, v144, v20, v21
    v_max3_f32 v144, v144, v22, v23
    v_max3_f32 v144, v144, v24, v25
    v_max3_f32 v144, v144, v26, v27
    v_max3_f32 v144, v144, v28, v29
    v_max3_f32 v144, v144, v30, v31
    v_mfma_f32_32x32x8_bf16 v[16:31], a[78:79], a[248:249], 0
    v_mfma_f32_32x32x16_bf16 v[16:31], a[56:59], a[240:243], v[16:31]
    s_nop 11
    v_max3_f32 v144, v144, v16, v17
    v_max3_f32 v144, v144, v18, v19
    v_max3_f32 v144, v144, v20, v21
    v_max3_f32 v144, v144, v22, v23
    v_max3_f32 v144, v144, v24, v25
    v_max3_f32 v144, v144, v26, v27
    v_max3_f32 v144, v144, v28, v29
    v_max3_f32 v144, v144, v30, v31
    v_mfma_f32_32x32x8_bf16 v[16:31], a[78:79], a[250:251], 0
    v_mfma_f32_32x32x16_bf16 v[16:31], a[60:63], a[240:243], v[16:31]
    s_nop 11
    v_max3_f32 v144, v144, v16, v17
    v_max3_f32 v144, v144, v18, v19
    v_max3_f32 v144, v144, v20, v21
    v_max3_f32 v144, v144, v22, v23
    v_max3_f32 v144, v144, v24, v25
    v_max3_f32 v144, v144, v26, v27
    v_max3_f32 v144, v144, v28, v29
    v_max3_f32 v144, v144, v30, v31
    v_mov_b32 v212, v144
    s_nop 1
    v_permlane32_swap_b32 v212, v144
    s_nop 1
    v_max_f32 v144, v144, v212
    ds_write_b32 v146, v144 offset:19456
    s_waitcnt vmcnt(0) lgkmcnt(0)
    s_barrier
    ds_read_b32 v212, v145 offset:19456
    ds_read_b32 v213, v145 offset:19712
    ds_read_b32 v214, v145 offset:19968
    ds_read_b32 v215, v145 offset:20224
    s_waitcnt vmcnt(0) lgkmcnt(0)
    v_max3_f32 v144, v212, v213, v214
    v_max_f32 v144, v144, v215
    v_mfma_f32_32x32x8_bf16 v[16:31], a[64:65], a[248:249], 0
    v_mfma_f32_32x32x16_bf16 v[16:31], a[0:3], a[240:243], v[16:31]
    s_nop 11
    v_sub_f32 v16, v16, v144
    v_sub_f32 v17, v17, v144
    v_sub_f32 v18, v18, v144
    v_sub_f32 v19, v19, v144
    v_sub_f32 v20, v20, v144
    v_sub_f32 v21, v21, v144
    v_sub_f32 v22, v22, v144
    v_sub_f32 v23, v23, v144
    v_sub_f32 v24, v24, v144
    v_sub_f32 v25, v25, v144
    v_sub_f32 v26, v26, v144
    v_sub_f32 v27, v27, v144
    v_sub_f32 v28, v28, v144
    v_sub_f32 v29, v29, v144
    v_sub_f32 v30, v30, v144
    v_sub_f32 v31, v31, v144
    v_exp_f32 v16, v16
    v_exp_f32 v17, v17
    v_exp_f32 v18, v18
    v_exp_f32 v19, v19
    v_exp_f32 v20, v20
    v_exp_f32 v21, v21
    v_exp_f32 v22, v22
    v_exp_f32 v23, v23
    v_exp_f32 v24, v24
    v_exp_f32 v25, v25
    v_exp_f32 v26, v26
    v_exp_f32 v27, v27
    v_exp_f32 v28, v28
    v_exp_f32 v29, v29
    v_exp_f32 v30, v30
    v_exp_f32 v31, v31
    s_nop 1
    v_smfmac_f32_32x32x32_bf16 a[208:223], a[80:83], v[16:23], v2
    v_smfmac_f32_32x32x32_bf16 a[208:223], a[84:87], v[24:31], v2
    v_mfma_f32_32x32x8_bf16 v[16:31], a[64:65], a[250:251], 0
    v_mfma_f32_32x32x16_bf16 v[16:31], a[4:7], a[240:243], v[16:31]
    s_nop 11
    v_sub_f32 v16, v16, v144
    v_sub_f32 v17, v17, v144
    v_sub_f32 v18, v18, v144
    v_sub_f32 v19, v19, v144
    v_sub_f32 v20, v20, v144
    v_sub_f32 v21, v21, v144
    v_sub_f32 v22, v22, v144
    v_sub_f32 v23, v23, v144
    v_sub_f32 v24, v24, v144
    v_sub_f32 v25, v25, v144
    v_sub_f32 v26, v26, v144
    v_sub_f32 v27, v27, v144
    v_sub_f32 v28, v28, v144
    v_sub_f32 v29, v29, v144
    v_sub_f32 v30, v30, v144
    v_sub_f32 v31, v31, v144
    v_exp_f32 v16, v16
    v_exp_f32 v17, v17
    v_exp_f32 v18, v18
    v_exp_f32 v19, v19
    v_exp_f32 v20, v20
    v_exp_f32 v21, v21
    v_exp_f32 v22, v22
    v_exp_f32 v23, v23
    v_exp_f32 v24, v24
    v_exp_f32 v25, v25
    v_exp_f32 v26, v26
    v_exp_f32 v27, v27
    v_exp_f32 v28, v28
    v_exp_f32 v29, v29
    v_exp_f32 v30, v30
    v_exp_f32 v31, v31
    s_nop 1
    v_smfmac_f32_32x32x32_bf16 a[208:223], a[88:91], v[16:23], v2
    v_smfmac_f32_32x32x32_bf16 a[208:223], a[92:95], v[24:31], v2
    v_mfma_f32_32x32x8_bf16 v[16:31], a[66:67], a[248:249], 0
    v_mfma_f32_32x32x16_bf16 v[16:31], a[8:11], a[240:243], v[16:31]
    s_nop 11
    v_sub_f32 v16, v16, v144
    v_sub_f32 v17, v17, v144
    v_sub_f32 v18, v18, v144
    v_sub_f32 v19, v19, v144
    v_sub_f32 v20, v20, v144
    v_sub_f32 v21, v21, v144
    v_sub_f32 v22, v22, v144
    v_sub_f32 v23, v23, v144
    v_sub_f32 v24, v24, v144
    v_sub_f32 v25, v25, v144
    v_sub_f32 v26, v26, v144
    v_sub_f32 v27, v27, v144
    v_sub_f32 v28, v28, v144
    v_sub_f32 v29, v29, v144
    v_sub_f32 v30, v30, v144
    v_sub_f32 v31, v31, v144
    v_exp_f32 v16, v16
    v_exp_f32 v17, v17
    v_exp_f32 v18, v18
    v_exp_f32 v19, v19
    v_exp_f32 v20, v20
    v_exp_f32 v21, v21
    v_exp_f32 v22, v22
    v_exp_f32 v23, v23
    v_exp_f32 v24, v24
    v_exp_f32 v25, v25
    v_exp_f32 v26, v26
    v_exp_f32 v27, v27
    v_exp_f32 v28, v28
    v_exp_f32 v29, v29
    v_exp_f32 v30, v30
    v_exp_f32 v31, v31
    s_nop 1
    v_smfmac_f32_32x32x32_bf16 a[208:223], a[96:99], v[16:23], v2
    v_smfmac_f32_32x32x32_bf16 a[208:223], a[100:103], v[24:31], v2
    v_mfma_f32_32x32x8_bf16 v[16:31], a[66:67], a[250:251], 0
    v_mfma_f32_32x32x16_bf16 v[16:31], a[12:15], a[240:243], v[16:31]
    s_nop 11
    v_sub_f32 v16, v16, v144
    v_sub_f32 v17, v17, v144
    v_sub_f32 v18, v18, v144
    v_sub_f32 v19, v19, v144
    v_sub_f32 v20, v20, v144
    v_sub_f32 v21, v21, v144
    v_sub_f32 v22, v22, v144
    v_sub_f32 v23, v23, v144
    v_sub_f32 v24, v24, v144
    v_sub_f32 v25, v25, v144
    v_sub_f32 v26, v26, v144
    v_sub_f32 v27, v27, v144
    v_sub_f32 v28, v28, v144
    v_sub_f32 v29, v29, v144
    v_sub_f32 v30, v30, v144
    v_sub_f32 v31, v31, v144
    v_exp_f32 v16, v16
    v_exp_f32 v17, v17
    v_exp_f32 v18, v18
    v_exp_f32 v19, v19
    v_exp_f32 v20, v20
    v_exp_f32 v21, v21
    v_exp_f32 v22, v22
    v_exp_f32 v23, v23
    v_exp_f32 v24, v24
    v_exp_f32 v25, v25
    v_exp_f32 v26, v26
    v_exp_f32 v27, v27
    v_exp_f32 v28, v28
    v_exp_f32 v29, v29
    v_exp_f32 v30, v30
    v_exp_f32 v31, v31
    s_nop 1
    v_smfmac_f32_32x32x32_bf16 a[208:223], a[104:107], v[16:23], v2
    v_smfmac_f32_32x32x32_bf16 a[208:223], a[108:111], v[24:31], v2
    v_mfma_f32_32x32x8_bf16 v[16:31], a[68:69], a[248:249], 0
    v_mfma_f32_32x32x16_bf16 v[16:31], a[16:19], a[240:243], v[16:31]
    s_nop 11
    v_sub_f32 v16, v16, v144
    v_sub_f32 v17, v17, v144
    v_sub_f32 v18, v18, v144
    v_sub_f32 v19, v19, v144
    v_sub_f32 v20, v20, v144
    v_sub_f32 v21, v21, v144
    v_sub_f32 v22, v22, v144
    v_sub_f32 v23, v23, v144
    v_sub_f32 v24, v24, v144
    v_sub_f32 v25, v25, v144
    v_sub_f32 v26, v26, v144
    v_sub_f32 v27, v27, v144
    v_sub_f32 v28, v28, v144
    v_sub_f32 v29, v29, v144
    v_sub_f32 v30, v30, v144
    v_sub_f32 v31, v31, v144
    v_exp_f32 v16, v16
    v_exp_f32 v17, v17
    v_exp_f32 v18, v18
    v_exp_f32 v19, v19
    v_exp_f32 v20, v20
    v_exp_f32 v21, v21
    v_exp_f32 v22, v22
    v_exp_f32 v23, v23
    v_exp_f32 v24, v24
    v_exp_f32 v25, v25
    v_exp_f32 v26, v26
    v_exp_f32 v27, v27
    v_exp_f32 v28, v28
    v_exp_f32 v29, v29
    v_exp_f32 v30, v30
    v_exp_f32 v31, v31
    s_nop 1
    v_smfmac_f32_32x32x32_bf16 a[208:223], a[112:115], v[16:23], v2
    v_smfmac_f32_32x32x32_bf16 a[208:223], a[116:119], v[24:31], v2
    v_mfma_f32_32x32x8_bf16 v[16:31], a[68:69], a[250:251], 0
    v_mfma_f32_32x32x16_bf16 v[16:31], a[20:23], a[240:243], v[16:31]
    s_nop 11
    v_sub_f32 v16, v16, v144
    v_sub_f32 v17, v17, v144
    v_sub_f32 v18, v18, v144
    v_sub_f32 v19, v19, v144
    v_sub_f32 v20, v20, v144
    v_sub_f32 v21, v21, v144
    v_sub_f32 v22, v22, v144
    v_sub_f32 v23, v23, v144
    v_sub_f32 v24, v24, v144
    v_sub_f32 v25, v25, v144
    v_sub_f32 v26, v26, v144
    v_sub_f32 v27, v27, v144
    v_sub_f32 v28, v28, v144
    v_sub_f32 v29, v29, v144
    v_sub_f32 v30, v30, v144
    v_sub_f32 v31, v31, v144
    v_exp_f32 v16, v16
    v_exp_f32 v17, v17
    v_exp_f32 v18, v18
    v_exp_f32 v19, v19
    v_exp_f32 v20, v20
    v_exp_f32 v21, v21
    v_exp_f32 v22, v22
    v_exp_f32 v23, v23
    v_exp_f32 v24, v24
    v_exp_f32 v25, v25
    v_exp_f32 v26, v26
    v_exp_f32 v27, v27
    v_exp_f32 v28, v28
    v_exp_f32 v29, v29
    v_exp_f32 v30, v30
    v_exp_f32 v31, v31
    s_nop 1
    v_smfmac_f32_32x32x32_bf16 a[208:223], a[120:123], v[16:23], v2
    v_smfmac_f32_32x32x32_bf16 a[208:223], a[124:127], v[24:31], v2
    v_mfma_f32_32x32x8_bf16 v[16:31], a[70:71], a[248:249], 0
    v_mfma_f32_32x32x16_bf16 v[16:31], a[24:27], a[240:243], v[16:31]
    s_nop 11
    v_sub_f32 v16, v16, v144
    v_sub_f32 v17, v17, v144
    v_sub_f32 v18, v18, v144
    v_sub_f32 v19, v19, v144
    v_sub_f32 v20, v20, v144
    v_sub_f32 v21, v21, v144
    v_sub_f32 v22, v22, v144
    v_sub_f32 v23, v23, v144
    v_sub_f32 v24, v24, v144
    v_sub_f32 v25, v25, v144
    v_sub_f32 v26, v26, v144
    v_sub_f32 v27, v27, v144
    v_sub_f32 v28, v28, v144
    v_sub_f32 v29, v29, v144
    v_sub_f32 v30, v30, v144
    v_sub_f32 v31, v31, v144
    v_exp_f32 v16, v16
    v_exp_f32 v17, v17
    v_exp_f32 v18, v18
    v_exp_f32 v19, v19
    v_exp_f32 v20, v20
    v_exp_f32 v21, v21
    v_exp_f32 v22, v22
    v_exp_f32 v23, v23
    v_exp_f32 v24, v24
    v_exp_f32 v25, v25
    v_exp_f32 v26, v26
    v_exp_f32 v27, v27
    v_exp_f32 v28, v28
    v_exp_f32 v29, v29
    v_exp_f32 v30, v30
    v_exp_f32 v31, v31
    s_nop 1
    v_smfmac_f32_32x32x32_bf16 a[208:223], a[128:131], v[16:23], v2
    v_smfmac_f32_32x32x32_bf16 a[208:223], a[132:135], v[24:31], v2
    v_mfma_f32_32x32x8_bf16 v[16:31], a[70:71], a[250:251], 0
    v_mfma_f32_32x32x16_bf16 v[16:31], a[28:31], a[240:243], v[16:31]
    s_nop 11
    v_sub_f32 v16, v16, v144
    v_sub_f32 v17, v17, v144
    v_sub_f32 v18, v18, v144
    v_sub_f32 v19, v19, v144
    v_sub_f32 v20, v20, v144
    v_sub_f32 v21, v21, v144
    v_sub_f32 v22, v22, v144
    v_sub_f32 v23, v23, v144
    v_sub_f32 v24, v24, v144
    v_sub_f32 v25, v25, v144
    v_sub_f32 v26, v26, v144
    v_sub_f32 v27, v27, v144
    v_sub_f32 v28, v28, v144
    v_sub_f32 v29, v29, v144
    v_sub_f32 v30, v30, v144
    v_sub_f32 v31, v31, v144
    v_exp_f32 v16, v16
    v_exp_f32 v17, v17
    v_exp_f32 v18, v18
    v_exp_f32 v19, v19
    v_exp_f32 v20, v20
    v_exp_f32 v21, v21
    v_exp_f32 v22, v22
    v_exp_f32 v23, v23
    v_exp_f32 v24, v24
    v_exp_f32 v25, v25
    v_exp_f32 v26, v26
    v_exp_f32 v27, v27
    v_exp_f32 v28, v28
    v_exp_f32 v29, v29
    v_exp_f32 v30, v30
    v_exp_f32 v31, v31
    s_nop 1
    v_smfmac_f32_32x32x32_bf16 a[208:223], a[136:139], v[16:23], v2
    v_smfmac_f32_32x32x32_bf16 a[208:223], a[140:143], v[24:31], v2
    v_mfma_f32_32x32x8_bf16 v[16:31], a[72:73], a[248:249], 0
    v_mfma_f32_32x32x16_bf16 v[16:31], a[32:35], a[240:243], v[16:31]
    s_nop 11
    v_sub_f32 v16, v16, v144
    v_sub_f32 v17, v17, v144
    v_sub_f32 v18, v18, v144
    v_sub_f32 v19, v19, v144
    v_sub_f32 v20, v20, v144
    v_sub_f32 v21, v21, v144
    v_sub_f32 v22, v22, v144
    v_sub_f32 v23, v23, v144
    v_sub_f32 v24, v24, v144
    v_sub_f32 v25, v25, v144
    v_sub_f32 v26, v26, v144
    v_sub_f32 v27, v27, v144
    v_sub_f32 v28, v28, v144
    v_sub_f32 v29, v29, v144
    v_sub_f32 v30, v30, v144
    v_sub_f32 v31, v31, v144
    v_exp_f32 v16, v16
    v_exp_f32 v17, v17
    v_exp_f32 v18, v18
    v_exp_f32 v19, v19
    v_exp_f32 v20, v20
    v_exp_f32 v21, v21
    v_exp_f32 v22, v22
    v_exp_f32 v23, v23
    v_exp_f32 v24, v24
    v_exp_f32 v25, v25
    v_exp_f32 v26, v26
    v_exp_f32 v27, v27
    v_exp_f32 v28, v28
    v_exp_f32 v29, v29
    v_exp_f32 v30, v30
    v_exp_f32 v31, v31
    s_nop 1
    v_smfmac_f32_32x32x32_bf16 a[208:223], a[144:147], v[16:23], v2
    v_smfmac_f32_32x32x32_bf16 a[208:223], a[148:151], v[24:31], v2
    v_mfma_f32_32x32x8_bf16 v[16:31], a[72:73], a[250:251], 0
    v_mfma_f32_32x32x16_bf16 v[16:31], a[36:39], a[240:243], v[16:31]
    s_nop 11
    v_sub_f32 v16, v16, v144
    v_sub_f32 v17, v17, v144
    v_sub_f32 v18, v18, v144
    v_sub_f32 v19, v19, v144
    v_sub_f32 v20, v20, v144
    v_sub_f32 v21, v21, v144
    v_sub_f32 v22, v22, v144
    v_sub_f32 v23, v23, v144
    v_sub_f32 v24, v24, v144
    v_sub_f32 v25, v25, v144
    v_sub_f32 v26, v26, v144
    v_sub_f32 v27, v27, v144
    v_sub_f32 v28, v28, v144
    v_sub_f32 v29, v29, v144
    v_sub_f32 v30, v30, v144
    v_sub_f32 v31, v31, v144
    v_exp_f32 v16, v16
    v_exp_f32 v17, v17
    v_exp_f32 v18, v18
    v_exp_f32 v19, v19
    v_exp_f32 v20, v20
    v_exp_f32 v21, v21
    v_exp_f32 v22, v22
    v_exp_f32 v23, v23
    v_exp_f32 v24, v24
    v_exp_f32 v25, v25
    v_exp_f32 v26, v26
    v_exp_f32 v27, v27
    v_exp_f32 v28, v28
    v_exp_f32 v29, v29
    v_exp_f32 v30, v30
    v_exp_f32 v31, v31
    s_nop 1
    v_smfmac_f32_32x32x32_bf16 a[208:223], a[152:155], v[16:23], v2
    v_smfmac_f32_32x32x32_bf16 a[208:223], a[156:159], v[24:31], v2
    v_mfma_f32_32x32x8_bf16 v[16:31], a[74:75], a[248:249], 0
    v_mfma_f32_32x32x16_bf16 v[16:31], a[40:43], a[240:243], v[16:31]
    s_nop 11
    v_sub_f32 v16, v16, v144
    v_sub_f32 v17, v17, v144
    v_sub_f32 v18, v18, v144
    v_sub_f32 v19, v19, v144
    v_sub_f32 v20, v20, v144
    v_sub_f32 v21, v21, v144
    v_sub_f32 v22, v22, v144
    v_sub_f32 v23, v23, v144
    v_sub_f32 v24, v24, v144
    v_sub_f32 v25, v25, v144
    v_sub_f32 v26, v26, v144
    v_sub_f32 v27, v27, v144
    v_sub_f32 v28, v28, v144
    v_sub_f32 v29, v29, v144
    v_sub_f32 v30, v30, v144
    v_sub_f32 v31, v31, v144
    v_exp_f32 v16, v16
    v_exp_f32 v17, v17
    v_exp_f32 v18, v18
    v_exp_f32 v19, v19
    v_exp_f32 v20, v20
    v_exp_f32 v21, v21
    v_exp_f32 v22, v22
    v_exp_f32 v23, v23
    v_exp_f32 v24, v24
    v_exp_f32 v25, v25
    v_exp_f32 v26, v26
    v_exp_f32 v27, v27
    v_exp_f32 v28, v28
    v_exp_f32 v29, v29
    v_exp_f32 v30, v30
    v_exp_f32 v31, v31
    s_nop 1
    v_smfmac_f32_32x32x32_bf16 a[208:223], a[160:163], v[16:23], v2
    v_smfmac_f32_32x32x32_bf16 a[208:223], a[164:167], v[24:31], v2
    v_mfma_f32_32x32x8_bf16 v[16:31], a[74:75], a[250:251], 0
    v_mfma_f32_32x32x16_bf16 v[16:31], a[44:47], a[240:243], v[16:31]
    s_nop 11
    v_sub_f32 v16, v16, v144
    v_sub_f32 v17, v17, v144
    v_sub_f32 v18, v18, v144
    v_sub_f32 v19, v19, v144
    v_sub_f32 v20, v20, v144
    v_sub_f32 v21, v21, v144
    v_sub_f32 v22, v22, v144
    v_sub_f32 v23, v23, v144
    v_sub_f32 v24, v24, v144
    v_sub_f32 v25, v25, v144
    v_sub_f32 v26, v26, v144
    v_sub_f32 v27, v27, v144
    v_sub_f32 v28, v28, v144
    v_sub_f32 v29, v29, v144
    v_sub_f32 v30, v30, v144
    v_sub_f32 v31, v31, v144
    v_exp_f32 v16, v16
    v_exp_f32 v17, v17
    v_exp_f32 v18, v18
    v_exp_f32 v19, v19
    v_exp_f32 v20, v20
    v_exp_f32 v21, v21
    v_exp_f32 v22, v22
    v_exp_f32 v23, v23
    v_exp_f32 v24, v24
    v_exp_f32 v25, v25
    v_exp_f32 v26, v26
    v_exp_f32 v27, v27
    v_exp_f32 v28, v28
    v_exp_f32 v29, v29
    v_exp_f32 v30, v30
    v_exp_f32 v31, v31
    s_nop 1
    v_smfmac_f32_32x32x32_bf16 a[208:223], a[168:171], v[16:23], v2
    v_smfmac_f32_32x32x32_bf16 a[208:223], a[172:175], v[24:31], v2
    v_mfma_f32_32x32x8_bf16 v[16:31], a[76:77], a[248:249], 0
    v_mfma_f32_32x32x16_bf16 v[16:31], a[48:51], a[240:243], v[16:31]
    s_nop 11
    v_sub_f32 v16, v16, v144
    v_sub_f32 v17, v17, v144
    v_sub_f32 v18, v18, v144
    v_sub_f32 v19, v19, v144
    v_sub_f32 v20, v20, v144
    v_sub_f32 v21, v21, v144
    v_sub_f32 v22, v22, v144
    v_sub_f32 v23, v23, v144
    v_sub_f32 v24, v24, v144
    v_sub_f32 v25, v25, v144
    v_sub_f32 v26, v26, v144
    v_sub_f32 v27, v27, v144
    v_sub_f32 v28, v28, v144
    v_sub_f32 v29, v29, v144
    v_sub_f32 v30, v30, v144
    v_sub_f32 v31, v31, v144
    v_exp_f32 v16, v16
    v_exp_f32 v17, v17
    v_exp_f32 v18, v18
    v_exp_f32 v19, v19
    v_exp_f32 v20, v20
    v_exp_f32 v21, v21
    v_exp_f32 v22, v22
    v_exp_f32 v23, v23
    v_exp_f32 v24, v24
    v_exp_f32 v25, v25
    v_exp_f32 v26, v26
    v_exp_f32 v27, v27
    v_exp_f32 v28, v28
    v_exp_f32 v29, v29
    v_exp_f32 v30, v30
    v_exp_f32 v31, v31
    s_nop 1
    v_smfmac_f32_32x32x32_bf16 a[208:223], a[176:179], v[16:23], v2
    v_smfmac_f32_32x32x32_bf16 a[208:223], a[180:183], v[24:31], v2
    v_mfma_f32_32x32x8_bf16 v[16:31], a[76:77], a[250:251], 0
    v_mfma_f32_32x32x16_bf16 v[16:31], a[52:55], a[240:243], v[16:31]
    s_nop 11
    v_sub_f32 v16, v16, v144
    v_sub_f32 v17, v17, v144
    v_sub_f32 v18, v18, v144
    v_sub_f32 v19, v19, v144
    v_sub_f32 v20, v20, v144
    v_sub_f32 v21, v21, v144
    v_sub_f32 v22, v22, v144
    v_sub_f32 v23, v23, v144
    v_sub_f32 v24, v24, v144
    v_sub_f32 v25, v25, v144
    v_sub_f32 v26, v26, v144
    v_sub_f32 v27, v27, v144
    v_sub_f32 v28, v28, v144
    v_sub_f32 v29, v29, v144
    v_sub_f32 v30, v30, v144
    v_sub_f32 v31, v31, v144
    v_exp_f32 v16, v16
    v_exp_f32 v17, v17
    v_exp_f32 v18, v18
    v_exp_f32 v19, v19
    v_exp_f32 v20, v20
    v_exp_f32 v21, v21
    v_exp_f32 v22, v22
    v_exp_f32 v23, v23
    v_exp_f32 v24, v24
    v_exp_f32 v25, v25
    v_exp_f32 v26, v26
    v_exp_f32 v27, v27
    v_exp_f32 v28, v28
    v_exp_f32 v29, v29
    v_exp_f32 v30, v30
    v_exp_f32 v31, v31
    s_nop 1
    v_smfmac_f32_32x32x32_bf16 a[208:223], a[184:187], v[16:23], v2
    v_smfmac_f32_32x32x32_bf16 a[208:223], a[188:191], v[24:31], v2
    v_mfma_f32_32x32x8_bf16 v[16:31], a[78:79], a[248:249], 0
    v_mfma_f32_32x32x16_bf16 v[16:31], a[56:59], a[240:243], v[16:31]
    s_nop 11
    v_sub_f32 v16, v16, v144
    v_sub_f32 v17, v17, v144
    v_sub_f32 v18, v18, v144
    v_sub_f32 v19, v19, v144
    v_sub_f32 v20, v20, v144
    v_sub_f32 v21, v21, v144
    v_sub_f32 v22, v22, v144
    v_sub_f32 v23, v23, v144
    v_sub_f32 v24, v24, v144
    v_sub_f32 v25, v25, v144
    v_sub_f32 v26, v26, v144
    v_sub_f32 v27, v27, v144
    v_sub_f32 v28, v28, v144
    v_sub_f32 v29, v29, v144
    v_sub_f32 v30, v30, v144
    v_sub_f32 v31, v31, v144
    v_exp_f32 v16, v16
    v_exp_f32 v17, v17
    v_exp_f32 v18, v18
    v_exp_f32 v19, v19
    v_exp_f32 v20, v20
    v_exp_f32 v21, v21
    v_exp_f32 v22, v22
    v_exp_f32 v23, v23
    v_exp_f32 v24, v24
    v_exp_f32 v25, v25
    v_exp_f32 v26, v26
    v_exp_f32 v27, v27
    v_exp_f32 v28, v28
    v_exp_f32 v29, v29
    v_exp_f32 v30, v30
    v_exp_f32 v31, v31
    s_nop 1
    v_smfmac_f32_32x32x32_bf16 a[208:223], a[192:195], v[16:23], v2
    v_smfmac_f32_32x32x32_bf16 a[208:223], a[196:199], v[24:31], v2
    v_mfma_f32_32x32x8_bf16 v[16:31], a[78:79], a[250:251], 0
    v_mfma_f32_32x32x16_bf16 v[16:31], a[60:63], a[240:243], v[16:31]
    s_nop 11
    v_sub_f32 v16, v16, v144
    v_sub_f32 v17, v17, v144
    v_sub_f32 v18, v18, v144
    v_sub_f32 v19, v19, v144
    v_sub_f32 v20, v20, v144
    v_sub_f32 v21, v21, v144
    v_sub_f32 v22, v22, v144
    v_sub_f32 v23, v23, v144
    v_sub_f32 v24, v24, v144
    v_sub_f32 v25, v25, v144
    v_sub_f32 v26, v26, v144
    v_sub_f32 v27, v27, v144
    v_sub_f32 v28, v28, v144
    v_sub_f32 v29, v29, v144
    v_sub_f32 v30, v30, v144
    v_sub_f32 v31, v31, v144
    v_exp_f32 v16, v16
    v_exp_f32 v17, v17
    v_exp_f32 v18, v18
    v_exp_f32 v19, v19
    v_exp_f32 v20, v20
    v_exp_f32 v21, v21
    v_exp_f32 v22, v22
    v_exp_f32 v23, v23
    v_exp_f32 v24, v24
    v_exp_f32 v25, v25
    v_exp_f32 v26, v26
    v_exp_f32 v27, v27
    v_exp_f32 v28, v28
    v_exp_f32 v29, v29
    v_exp_f32 v30, v30
    v_exp_f32 v31, v31
    s_nop 1
    v_smfmac_f32_32x32x32_bf16 a[208:223], a[200:203], v[16:23], v2
    v_smfmac_f32_32x32x32_bf16 a[208:223], a[204:207], v[24:31], v2
    s_nop 11
    ds_write_b128 v7, a[208:211]
    ds_write_b128 v7, a[212:215] offset:1024
    ds_write_b64 v8, a[216:217]
    s_waitcnt vmcnt(0) lgkmcnt(0)
    s_barrier
    v_mov_b32 v136, v137
    v_mov_b32 v137, v138
    v_mov_b32 v138, v139
    v_mov_b32 v139, v140
    v_mov_b32 v140, v141
    v_mov_b32 v141, v142
    v_mov_b32 v142, v143
    ds_read2st64_b64 v[220:223], v10 offset0:4 offset1:9
    ds_read2st64_b64 v[224:227], v10 offset0:14 offset1:19
    ds_read_b128 v[16:19], v12 offset:0
    ds_read_b128 v[20:23], v12 offset:1024
    ds_read_b128 v[24:27], v12 offset:2560
    ds_read_b128 v[28:31], v12 offset:3584
    ds_read_b128 v[32:35], v12 offset:5120
    ds_read_b128 v[36:39], v12 offset:6144
    ds_read_b128 v[40:43], v12 offset:7680
    ds_read_b128 v[44:47], v12 offset:8704
    s_waitcnt lgkmcnt(8)
    v_pk_add_f32 v[220:221], v[220:221], v[222:223]
    v_pk_add_f32 v[224:225], v[224:225], v[226:227]
    v_pk_add_f32 v[220:221], v[220:221], v[224:225]
    v_rcp_f32 v222, v221
    v_subrev_u32 v223, 0xf800000, v221
    v_max_u32 v13, v13, v223
    v_mul_f32 v143, v220, v222
    s_waitcnt lgkmcnt(4)
    v_pk_add_f32 v[16:17], v[16:17], v[24:25]
    v_pk_add_f32 v[18:19], v[18:19], v[26:27]
    v_pk_add_f32 v[20:21], v[20:21], v[28:29]
    v_pk_add_f32 v[22:23], v[22:23], v[30:31]
    s_waitcnt lgkmcnt(0)
    v_pk_add_f32 v[32:33], v[32:33], v[40:41]
    v_pk_add_f32 v[34:35], v[34:35], v[42:43]
    v_pk_add_f32 v[36:37], v[36:37], v[44:45]
    v_pk_add_f32 v[38:39], v[38:39], v[46:47]
    v_pk_add_f32 v[16:17], v[16:17], v[32:33]
    v_pk_add_f32 v[18:19], v[18:19], v[34:35]
    v_pk_add_f32 v[20:21], v[20:21], v[36:37]
    v_pk_add_f32 v[22:23], v[22:23], v[38:39]
    v_pk_mul_f32 v[16:17], v[16:17], v[222:223] op_sel_hi:[1,0]
    v_pk_mul_f32 v[18:19], v[18:19], v[222:223] op_sel_hi:[1,0]
    v_pk_mul_f32 v[20:21], v[20:21], v[222:223] op_sel_hi:[1,0]
    v_pk_mul_f32 v[22:23], v[22:23], v[222:223] op_sel_hi:[1,0]
    v_cvt_pk_bf16_f32 v228, v16, v17
    v_cvt_pk_bf16_f32 v229, v18, v19
    v_cvt_pk_bf16_f32 v230, v20, v21
    v_cvt_pk_bf16_f32 v231, v22, v23
    s_nop 1
    v_smfmac_f32_16x16x64_bf16 v[176:179], v[228:231], v[64:71], v3
    v_smfmac_f32_16x16x64_bf16 v[180:183], v[228:231], v[72:79], v3
    v_smfmac_f32_16x16x64_bf16 v[184:187], v[228:231], v[80:87], v3
    v_smfmac_f32_16x16x64_bf16 v[188:191], v[228:231], v[88:95], v3
    v_smfmac_f32_16x16x64_bf16 v[192:195], v[228:231], v[96:103], v3
    v_smfmac_f32_16x16x64_bf16 v[196:199], v[228:231], v[104:111], v3
    v_smfmac_f32_16x16x64_bf16 v[200:203], v[228:231], v[112:119], v3
    v_smfmac_f32_16x16x64_bf16 v[204:207], v[228:231], v[120:127], v3
    v_smfmac_f32_16x16x64_bf16 v[208:211], v[228:231], v[128:135], v3
    s_nop 7
    s_add_u32 s43, s43, 1
    s_add_u32 s45, s45, 73728
    s_cmp_lt_u32 s43, 8
    s_cbranch_scc1 L_k2_slow_round
    s_add_u32 s39, s45, 2531328
    s_add_u32 s40, s16, s39
    s_addc_u32 s41, s17, 0
    global_load_dwordx4 v[64:67], v6, s[40:41] offset:-4096 sc1
    global_load_dwordx4 v[68:71], v6, s[40:41] offset:-3072 sc1
    global_load_dwordx4 v[72:75], v6, s[40:41] offset:-2048 sc1
    global_load_dwordx4 v[76:79], v6, s[40:41] offset:-1024 sc1
    global_load_dwordx4 v[80:83], v6, s[40:41] offset:0 sc1
    global_load_dwordx4 v[84:87], v6, s[40:41] offset:1024 sc1
    global_load_dwordx4 v[88:91], v6, s[40:41] offset:2048 sc1
    global_load_dwordx4 v[92:95], v6, s[40:41] offset:3072 sc1
    s_add_u32 s39, s45, 2539520
    s_add_u32 s40, s16, s39
    s_addc_u32 s41, s17, 0
    global_load_dwordx4 v[96:99], v6, s[40:41] offset:-4096 sc1
    global_load_dwordx4 v[100:103], v6, s[40:41] offset:-3072 sc1
    global_load_dwordx4 v[104:107], v6, s[40:41] offset:-2048 sc1
    global_load_dwordx4 v[108:111], v6, s[40:41] offset:-1024 sc1
    global_load_dwordx4 v[112:115], v6, s[40:41] offset:0 sc1
    global_load_dwordx4 v[116:119], v6, s[40:41] offset:1024 sc1
    global_load_dwordx4 v[120:123], v6, s[40:41] offset:2048 sc1
    global_load_dwordx4 v[124:127], v6, s[40:41] offset:3072 sc1
    s_add_u32 s39, s45, 2547712
    s_add_u32 s40, s16, s39
    s_addc_u32 s41, s17, 0
    global_load_dwordx4 v[128:131], v6, s[40:41] offset:-4096 sc1
    global_load_dwordx4 v[132:135], v6, s[40:41] offset:-3072 sc1
    v_cvt_pk_bf16_f32 v232, v136, v137
    v_cvt_pk_bf16_f32 v233, v138, v139
    v_cvt_pk_bf16_f32 v234, v140, v141
    v_cvt_pk_bf16_f32 v235, v142, v143
    s_waitcnt vmcnt(0) lgkmcnt(0)
    s_nop 1
    v_smfmac_f32_16x16x64_bf16 v[176:179], v[232:235], v[64:71], v3
    v_smfmac_f32_16x16x64_bf16 v[180:183], v[232:235], v[72:79], v3
    v_smfmac_f32_16x16x64_bf16 v[184:187], v[232:235], v[80:87], v3
    v_smfmac_f32_16x16x64_bf16 v[188:191], v[232:235], v[88:95], v3
    v_smfmac_f32_16x16x64_bf16 v[192:195], v[232:235], v[96:103], v3
    v_smfmac_f32_16x16x64_bf16 v[196:199], v[232:235], v[104:111], v3
    v_smfmac_f32_16x16x64_bf16 v[200:203], v[232:235], v[112:119], v3
    v_smfmac_f32_16x16x64_bf16 v[204:207], v[232:235], v[120:127], v3
    v_smfmac_f32_16x16x64_bf16 v[208:211], v[232:235], v[128:135], v3
    v_bfe_u32 v215, v0, 2, 2
    v_bfe_u32 v216, v0, 4, 1
    v_lshrrev_b32 v217, 5, v0
    v_lshl_add_u32 v218, v216, 3, v215
    v_lshlrev_b32 v218, 6, v218
    v_lshl_add_u32 v218, v217, 11, v218
    v_bfe_u32 v219, v0, 1, 1
    v_lshl_add_u32 v218, v219, 10, v218
    v_and_b32 v219, 1, v0
    v_lshl_add_u32 v218, v219, 3, v218
    v_lshlrev_b32 v219, 1, v216
    v_xor_b32 v219, s32, v219
    v_lshl_add_u32 v218, v219, 4, v218
    v_add_u32 v212, 29824, v218
    v_add_u32 v213, 66688, v218
    v_lshrrev_b32 v62, 3, v0
    s_lshl_b32 s34, s32, 4
    s_add_u32 s34, s34, 11264
    v_mad_u32_u24 v48, v62, 5, 0
    v_lshl_add_u32 v48, v48, 4, s34
    s_lshl_b32 s34, s2, 5
    s_add_u32 s34, s34, 5550108
    v_lshl_add_u32 v51, v62, 13, s34
    s_and_b32 s36, s32, 1
    ds_read_b64_tr_b16 a[0:1], v212 offset:0
    ds_read_b64_tr_b16 a[2:3], v212 offset:256
    ds_read_b64_tr_b16 a[4:5], v212 offset:4096
    ds_read_b64_tr_b16 a[6:7], v212 offset:4352
    ds_read_b64_tr_b16 a[8:9], v212 offset:8192
    ds_read_b64_tr_b16 a[10:11], v212 offset:8448
    ds_read_b64_tr_b16 a[12:13], v212 offset:12288
    ds_read_b64_tr_b16 a[14:15], v212 offset:12544
    s_waitcnt vmcnt(0) lgkmcnt(0)
    ds_read_b64_tr_b16 a[16:17], v212 offset:16384
    ds_read_b64_tr_b16 a[18:19], v212 offset:16640
    ds_read_b64_tr_b16 a[20:21], v212 offset:20480
    ds_read_b64_tr_b16 a[22:23], v212 offset:20736
    ds_read_b64_tr_b16 a[24:25], v212 offset:24576
    ds_read_b64_tr_b16 a[26:27], v212 offset:24832
    s_waitcnt vmcnt(0) lgkmcnt(0)
    s_branch L_k2_ln2
L_k2_end:
    s_endpgm
.section .rodata,"a"
.p2align 6
.amdhsa_kernel sequential_preLN__grouped_kv_mqa__moe_arch_mod__prompt_kernel
  .amdhsa_next_free_vgpr 512
  .amdhsa_next_free_sgpr 102
  .amdhsa_accum_offset 256
  .amdhsa_group_segment_fixed_size 0
  .amdhsa_kernarg_size 104
  .amdhsa_user_sgpr_count 2
  .amdhsa_user_sgpr_kernarg_segment_ptr 1
  .amdhsa_system_sgpr_workgroup_id_x 1
.end_amdhsa_kernel
```
